```python
import torch

def _softmax(x, axis=-1):
    return torch.softmax(x, dim=axis)

def _gelu(x):
    return torch.nn.functional.gelu(x, approximate='tanh')

def _silu(x):
    return torch.nn.functional.silu(x)

def _sigmoid(x):
    return torch.sigmoid(x)

def _layernorm(x, axis=-1, eps=1e-05):
    m = x.mean(dim=axis, keepdim=True)
    v = x.var(dim=axis, keepdim=True, unbiased=False)
    return (x - m) / torch.sqrt(v + eps)

def _scatter_add(tgt, idx, src, axis=0):
    return tgt.clone().index_add_(axis, idx, src)

def _segment_sum(src, seg, n):
    out = torch.zeros((n,) + src.shape[1:], dtype=src.dtype)
    return out.index_add_(0, seg, src)

def _pad(x, pw):
    flat = tuple((v for pair in reversed(pw) for v in pair))
    return torch.nn.functional.pad(x, flat)
kernel_name = 'sequential_preLN__memory_aug_recurrent_mem_tr__glu_gated_bilinear__prompt'

def setup_inputs():

    _w = lambda a: (lambda t: t.to(torch.bfloat16) if t.is_floating_point() else t)(torch.as_tensor(a))

    def _A_setup():
        B, S, Dm = (1, 2048, 512)
        H, Dh = (32, 128)
        M, seg = (8, 32)
        seg = min(seg, S)
        S = S // seg * seg
        return {'x': _w((lambda *s: torch.randn(*s, dtype=torch.bfloat16) * 0.05)(B, S, Dm)), 'mem0': _w((lambda *s: torch.randn(*s, dtype=torch.bfloat16) * 0.2)(B, M, Dm)), 'Wq': _w((lambda *s: torch.randn(*s, dtype=torch.bfloat16) * 1.6)(Dm, H, Dh) * Dm ** (-0.5)), 'Wk': _w((lambda *s: torch.randn(*s, dtype=torch.bfloat16) * 1.6)(Dm, H, Dh) * Dm ** (-0.5)), 'Wv': _w((lambda *s: torch.randn(*s, dtype=torch.bfloat16) * 0.2)(Dm, H, Dh) * Dm ** (-0.5)), 'Wo': _w((lambda *s: torch.randn(*s, dtype=torch.bfloat16) * 0.2)(H, Dh, Dm) * (H * Dh) ** (-0.5)), 'seg_len': seg}
    _A_in = _A_setup()

    def _B_setup():
        B, S, D, F = (1, 2048, 512, 1792)
        return {'x': _w((lambda *s: torch.randn(*s, dtype=torch.bfloat16) * 0.05)(B, S, D)), 'w_gate': _w((lambda *s: torch.randn(*s, dtype=torch.bfloat16) * 0.2)(D, F) * D ** (-0.5)), 'w_up': _w((lambda *s: torch.randn(*s, dtype=torch.bfloat16) * 0.2)(D, F) * D ** (-0.5)), 'w_down': _w((lambda *s: torch.randn(*s, dtype=torch.bfloat16) * 0.2)(F, D) * F ** (-0.5))}
    _B_in = _B_setup()
    return {'A_x': _A_in['x'], 'A_mem0': _A_in['mem0'], 'A_Wq': _A_in['Wq'], 'A_Wk': _A_in['Wk'], 'A_Wv': _A_in['Wv'], 'A_Wo': _A_in['Wo'], 'A_seg_len': _A_in['seg_len'], 'B_x': _B_in['x'], 'B_w_gate': _B_in['w_gate'], 'B_w_up': _B_in['w_up'], 'B_w_down': _B_in['w_down']}

def reference(A_x, A_mem0, A_Wq, A_Wk, A_Wv, A_Wo, A_seg_len, B_x, B_w_gate, B_w_up, B_w_down):

    def _A_ref(x, mem0, Wq, Wk, Wv, Wo, seg_len):
        B, S, Dm = x.shape
        H, Dh = (Wq.shape[1], Wq.shape[2])
        M = mem0.shape[1]
        scale = Dh ** (-0.5)
        n_seg = S // seg_len
        L = M + seg_len
        idx = torch.arange(L)
        mask = (idx[:, None] < M) | (idx[:, None] >= idx[None, :])
        mem = mem0
        outs = []
        for s in range(n_seg):
            xs = x[:, s * seg_len:(s + 1) * seg_len, :].clone()
            h = torch.concatenate([mem, xs], axis=1)
            q = torch.einsum('btd,dhe->bhte', h, Wq)
            k = torch.einsum('btd,dhe->bhte', h, Wk)
            v = torch.einsum('btd,dhe->bhte', h, Wv)
            scores = torch.einsum('bhqe,bhke->bhqk', q, k) * scale
            scores = torch.where(mask[None, None], scores, -1000000000.0)
            p = _softmax(scores, axis=-1)
            o = torch.einsum('bhqk,bhke->bhqe', p, v)
            o = torch.einsum('bhte,hed->btd', o, Wo)
            mem = o[:, :M, :].clone()
            outs.append(o[:, M:, :])
        return torch.concatenate(outs, axis=1)

    def _B_ref(x, w_gate, w_up, w_down):
        g = torch.einsum('bsd,df->bsf', x, w_gate)
        u = torch.einsum('bsd,df->bsf', x, w_up)
        h = g * u
        return torch.einsum('bsf,fd->bsd', h, w_down)
    x = A_x
    h = x + _A_ref(_layernorm(x, axis=-1), A_mem0, A_Wq, A_Wk, A_Wv, A_Wo, A_seg_len)
    h2 = h + _B_ref(_layernorm(h, axis=-1), B_w_gate, B_w_up, B_w_down)
    return h2
```

```asm
; @launch kernel=prep_kernel grid=(1526,1,1) block=(256,1,1) lds=18432
; @launch kernel=rec_kernel grid=(256,1,1) block=(256,1,1) lds=163840
.amdgcn_target "amdgcn-amd-amdhsa--gfx950"
.text
.globl prep_kernel
.p2align 8
.type prep_kernel,@function
prep_kernel:
    s_load_dwordx4 s[4:7], s[0:1], 16
    s_load_dwordx4 s[12:15], s[0:1], 32
    s_load_dwordx4 s[16:19], s[0:1], 64
    s_load_dwordx2 s[20:21], s[0:1], 80
    s_load_dwordx2 s[22:23], s[0:1], 104
    s_load_dwordx2 s[32:33], s[0:1], 0
    v_lshrrev_b32 v1, 6, v0
    s_nop 0
    v_readfirstlane_b32 s3, v1
    v_and_b32 v1, 63, v0
    v_lshrrev_b32 v2, 4, v1
    v_and_b32 v3, 15, v1
    s_lshl_b32 s31, s2, 2
    s_add_u32 s31, s31, s3
    s_waitcnt lgkmcnt(0)
    s_mov_b32 s40, s22
    s_and_b32 s41, s23, 0xffff
    s_mov_b32 s42, 268435456
    s_mov_b32 s43, 0x00020000
    s_cmp_ge_u32 s31, 6104
    s_cbranch_scc1 prep_end
    s_cmp_ge_u32 s31, 5568
    s_cbranch_scc1 prep_zero
    s_cmp_ge_u32 s31, 5440
    s_cbranch_scc1 prep_ln
    s_cmp_ge_u32 s31, 3072
    s_cbranch_scc1 prep_c1
    s_lshr_b32 s34, s31, 10
    s_mov_b64 s[24:25], s[4:5]
    s_cmp_eq_u32 s34, 1
    s_cselect_b64 s[24:25], s[6:7], s[24:25]
    s_cmp_eq_u32 s34, 2
    s_cselect_b64 s[24:25], s[12:13], s[24:25]
    s_mov_b32 s26, 4194304
    s_mov_b32 s27, 8192
    s_lshr_b32 s35, s31, 4
    s_and_b32 s35, s35, 63
    s_and_b32 s36, s31, 15
    s_mov_b32 s37, 16
    s_mov_b32 s29, 0
    s_lshl_b32 s30, s34, 22
    s_add_u32 s30, s30, 2097152
    s_branch prep_go
prep_c1:
    s_cmp_ge_u32 s31, 4096
    s_cbranch_scc1 prep_c2
    s_sub_u32 s34, s31, 3072
    s_mov_b64 s[24:25], s[14:15]
    s_mov_b32 s26, 4194304
    s_mov_b32 s27, 1024
    s_lshr_b32 s35, s34, 7
    s_and_b32 s36, s34, 127
    s_mov_b32 s37, 128
    s_mov_b32 s29, 1
    s_mov_b32 s30, 14680064
    s_branch prep_go
prep_c2:
    s_cmp_ge_u32 s31, 4992
    s_cbranch_scc1 prep_c3
    s_sub_u32 s34, s31, 4096
    s_mov_b64 s[24:25], s[16:17]
    s_mov_b32 s30, 18874368
    s_cmp_ge_u32 s34, 448
    s_cselect_b64 s[24:25], s[18:19], s[24:25]
    s_cselect_b32 s37, 448, 0
    s_cselect_b32 s38, 1835008, 0
    s_sub_u32 s34, s34, s37
    s_add_u32 s30, s30, s38
    s_mov_b32 s26, 1835008
    s_mov_b32 s27, 3584
    s_lshr_b32 s35, s34, 4
    s_and_b32 s36, s34, 15
    s_mov_b32 s37, 16
    s_mov_b32 s29, 0
    s_branch prep_go
prep_c3:
    s_sub_u32 s34, s31, 4992
    s_mov_b32 s30, 23068672
    s_mov_b64 s[24:25], s[20:21]
    s_mov_b32 s26, 1835008
    s_mov_b32 s27, 1024
    s_mul_hi_u32 s35, s34, 76695845
    s_mul_i32 s37, s35, 56
    s_sub_u32 s36, s34, s37
    s_mov_b32 s37, 56
    s_mov_b32 s29, 1
prep_go:
    s_mul_i32 s28, s36, s27
    s_lshl_b32 s28, s28, 5
    s_lshl_b32 s38, s35, 7
    s_add_u32 s28, s28, s38
    s_mov_b32 s8, s24
    s_and_b32 s9, s25, 0xffff
    s_mov_b32 s10, s26
    s_mov_b32 s11, 0x00020000
    v_lshrrev_b32 v4, 3, v1
    v_mul_lo_u32 v5, v4, s27
    v_and_b32 v6, 7, v1
    v_lshl_add_u32 v5, v6, 4, v5
    s_lshl_b32 s38, s27, 3
    buffer_load_dwordx4 v[16:19], v5, s[8:11], s28 offen
    s_add_u32 s28, s28, s38
    buffer_load_dwordx4 v[20:23], v5, s[8:11], s28 offen
    s_add_u32 s28, s28, s38
    buffer_load_dwordx4 v[24:27], v5, s[8:11], s28 offen
    s_add_u32 s28, s28, s38
    buffer_load_dwordx4 v[28:31], v5, s[8:11], s28 offen
    s_mul_i32 s39, s3, 4608
    v_mul_u32_u24 v7, 144, v4
    v_lshl_add_u32 v7, v6, 4, v7
    v_add_u32 v7, s39, v7
    s_cmp_eq_u32 s29, 1
    s_cselect_b32 s44, 2, 3
    s_cselect_b32 s45, 16, 4
    s_mul_i32 s45, s45, 144
    v_lshlrev_b32 v8, s44, v2
    v_lshrrev_b32 v9, 2, v3
    v_add_u32 v8, v8, v9
    v_mul_u32_u24 v8, 144, v8
    v_and_b32 v9, 3, v1
    v_lshl_add_u32 v8, v9, 3, v8
    v_add_u32 v8, s39, v8
    v_add_u32 v9, s45, v8
    s_lshl_b32 s38, s35, 2
    s_mul_i32 s38, s38, s37
    s_add_u32 s38, s38, s36
    s_lshl_b32 s38, s38, 10
    s_add_u32 s30, s30, s38
    s_lshl_b32 s37, s37, 10
    v_lshlrev_b32 v5, 4, v1
    s_waitcnt vmcnt(3)
    ds_write_b128 v7, v[16:19] offset:0
    s_waitcnt vmcnt(2)
    ds_write_b128 v7, v[20:23] offset:1152
    s_waitcnt vmcnt(1)
    ds_write_b128 v7, v[24:27] offset:2304
    s_waitcnt vmcnt(0)
    ds_write_b128 v7, v[28:31] offset:3456
    s_waitcnt lgkmcnt(0)
    ds_read_b64_tr_b16 v[32:33], v8 offset:0
    ds_read_b64_tr_b16 v[34:35], v9 offset:0
    ds_read_b64_tr_b16 v[36:37], v8 offset:32
    ds_read_b64_tr_b16 v[38:39], v9 offset:32
    ds_read_b64_tr_b16 v[40:41], v8 offset:64
    ds_read_b64_tr_b16 v[42:43], v9 offset:64
    ds_read_b64_tr_b16 v[44:45], v8 offset:96
    ds_read_b64_tr_b16 v[46:47], v9 offset:96
    s_waitcnt lgkmcnt(6)
    buffer_store_dwordx4 v[32:35], v5, s[40:43], s30 offen
    s_add_u32 s30, s30, s37
    s_waitcnt lgkmcnt(4)
    buffer_store_dwordx4 v[36:39], v5, s[40:43], s30 offen
    s_add_u32 s30, s30, s37
    s_waitcnt lgkmcnt(2)
    buffer_store_dwordx4 v[40:43], v5, s[40:43], s30 offen
    s_add_u32 s30, s30, s37
    s_waitcnt lgkmcnt(0)
    buffer_store_dwordx4 v[44:47], v5, s[40:43], s30 offen
    s_branch prep_end
prep_ln:
    s_sub_u32 s34, s31, 5440
    s_mov_b32 s8, s32
    s_and_b32 s9, s33, 0xffff
    s_mov_b32 s10, 2097152
    s_mov_b32 s11, 0x00020000
    v_lshlrev_b32 v4, 10, v3
    v_lshl_add_u32 v4, v2, 4, v4
    s_lshl_b32 s35, s34, 14
    buffer_load_dwordx4 v[16:19], v4, s[8:11], s35 offen offset:0
    buffer_load_dwordx4 v[20:23], v4, s[8:11], s35 offen offset:64
    buffer_load_dwordx4 v[24:27], v4, s[8:11], s35 offen offset:128
    buffer_load_dwordx4 v[28:31], v4, s[8:11], s35 offen offset:192
    buffer_load_dwordx4 v[32:35], v4, s[8:11], s35 offen offset:256
    buffer_load_dwordx4 v[36:39], v4, s[8:11], s35 offen offset:320
    buffer_load_dwordx4 v[40:43], v4, s[8:11], s35 offen offset:384
    buffer_load_dwordx4 v[44:47], v4, s[8:11], s35 offen offset:448
    buffer_load_dwordx4 v[48:51], v4, s[8:11], s35 offen offset:512
    buffer_load_dwordx4 v[52:55], v4, s[8:11], s35 offen offset:576
    buffer_load_dwordx4 v[56:59], v4, s[8:11], s35 offen offset:640
    buffer_load_dwordx4 v[60:63], v4, s[8:11], s35 offen offset:704
    buffer_load_dwordx4 v[64:67], v4, s[8:11], s35 offen offset:768
    buffer_load_dwordx4 v[68:71], v4, s[8:11], s35 offen offset:832
    buffer_load_dwordx4 v[72:75], v4, s[8:11], s35 offen offset:896
    buffer_load_dwordx4 v[76:79], v4, s[8:11], s35 offen offset:960
    v_xor_b32 v5, 16, v1
    v_lshlrev_b32 v5, 2, v5
    v_xor_b32 v6, 32, v1
    v_lshlrev_b32 v6, 2, v6
    s_waitcnt vmcnt(0)
    v_lshlrev_b32 v96, 16, v16
    v_and_b32 v97, 0xffff0000, v16
    v_lshlrev_b32 v98, 16, v17
    v_and_b32 v99, 0xffff0000, v17
    v_lshlrev_b32 v100, 16, v18
    v_and_b32 v101, 0xffff0000, v18
    v_lshlrev_b32 v102, 16, v19
    v_and_b32 v103, 0xffff0000, v19
    v_lshlrev_b32 v104, 16, v20
    v_and_b32 v105, 0xffff0000, v20
    v_lshlrev_b32 v106, 16, v21
    v_and_b32 v107, 0xffff0000, v21
    v_lshlrev_b32 v108, 16, v22
    v_and_b32 v109, 0xffff0000, v22
    v_lshlrev_b32 v110, 16, v23
    v_and_b32 v111, 0xffff0000, v23
    v_lshlrev_b32 v112, 16, v24
    v_and_b32 v113, 0xffff0000, v24
    v_lshlrev_b32 v114, 16, v25
    v_and_b32 v115, 0xffff0000, v25
    v_lshlrev_b32 v116, 16, v26
    v_and_b32 v117, 0xffff0000, v26
    v_lshlrev_b32 v118, 16, v27
    v_and_b32 v119, 0xffff0000, v27
    v_lshlrev_b32 v120, 16, v28
    v_and_b32 v121, 0xffff0000, v28
    v_lshlrev_b32 v122, 16, v29
    v_and_b32 v123, 0xffff0000, v29
    v_lshlrev_b32 v124, 16, v30
    v_and_b32 v125, 0xffff0000, v30
    v_lshlrev_b32 v126, 16, v31
    v_and_b32 v127, 0xffff0000, v31
    v_lshlrev_b32 v128, 16, v32
    v_and_b32 v129, 0xffff0000, v32
    v_lshlrev_b32 v130, 16, v33
    v_and_b32 v131, 0xffff0000, v33
    v_lshlrev_b32 v132, 16, v34
    v_and_b32 v133, 0xffff0000, v34
    v_lshlrev_b32 v134, 16, v35
    v_and_b32 v135, 0xffff0000, v35
    v_lshlrev_b32 v136, 16, v36
    v_and_b32 v137, 0xffff0000, v36
    v_lshlrev_b32 v138, 16, v37
    v_and_b32 v139, 0xffff0000, v37
    v_lshlrev_b32 v140, 16, v38
    v_and_b32 v141, 0xffff0000, v38
    v_lshlrev_b32 v142, 16, v39
    v_and_b32 v143, 0xffff0000, v39
    v_lshlrev_b32 v144, 16, v40
    v_and_b32 v145, 0xffff0000, v40
    v_lshlrev_b32 v146, 16, v41
    v_and_b32 v147, 0xffff0000, v41
    v_lshlrev_b32 v148, 16, v42
    v_and_b32 v149, 0xffff0000, v42
    v_lshlrev_b32 v150, 16, v43
    v_and_b32 v151, 0xffff0000, v43
    v_lshlrev_b32 v152, 16, v44
    v_and_b32 v153, 0xffff0000, v44
    v_lshlrev_b32 v154, 16, v45
    v_and_b32 v155, 0xffff0000, v45
    v_lshlrev_b32 v156, 16, v46
    v_and_b32 v157, 0xffff0000, v46
    v_lshlrev_b32 v158, 16, v47
    v_and_b32 v159, 0xffff0000, v47
    v_lshlrev_b32 v160, 16, v48
    v_and_b32 v161, 0xffff0000, v48
    v_lshlrev_b32 v162, 16, v49
    v_and_b32 v163, 0xffff0000, v49
    v_lshlrev_b32 v164, 16, v50
    v_and_b32 v165, 0xffff0000, v50
    v_lshlrev_b32 v166, 16, v51
    v_and_b32 v167, 0xffff0000, v51
    v_lshlrev_b32 v168, 16, v52
    v_and_b32 v169, 0xffff0000, v52
    v_lshlrev_b32 v170, 16, v53
    v_and_b32 v171, 0xffff0000, v53
    v_lshlrev_b32 v172, 16, v54
    v_and_b32 v173, 0xffff0000, v54
    v_lshlrev_b32 v174, 16, v55
    v_and_b32 v175, 0xffff0000, v55
    v_lshlrev_b32 v176, 16, v56
    v_and_b32 v177, 0xffff0000, v56
    v_lshlrev_b32 v178, 16, v57
    v_and_b32 v179, 0xffff0000, v57
    v_lshlrev_b32 v180, 16, v58
    v_and_b32 v181, 0xffff0000, v58
    v_lshlrev_b32 v182, 16, v59
    v_and_b32 v183, 0xffff0000, v59
    v_lshlrev_b32 v184, 16, v60
    v_and_b32 v185, 0xffff0000, v60
    v_lshlrev_b32 v186, 16, v61
    v_and_b32 v187, 0xffff0000, v61
    v_lshlrev_b32 v188, 16, v62
    v_and_b32 v189, 0xffff0000, v62
    v_lshlrev_b32 v190, 16, v63
    v_and_b32 v191, 0xffff0000, v63
    v_lshlrev_b32 v192, 16, v64
    v_and_b32 v193, 0xffff0000, v64
    v_lshlrev_b32 v194, 16, v65
    v_and_b32 v195, 0xffff0000, v65
    v_lshlrev_b32 v196, 16, v66
    v_and_b32 v197, 0xffff0000, v66
    v_lshlrev_b32 v198, 16, v67
    v_and_b32 v199, 0xffff0000, v67
    v_lshlrev_b32 v200, 16, v68
    v_and_b32 v201, 0xffff0000, v68
    v_lshlrev_b32 v202, 16, v69
    v_and_b32 v203, 0xffff0000, v69
    v_lshlrev_b32 v204, 16, v70
    v_and_b32 v205, 0xffff0000, v70
    v_lshlrev_b32 v206, 16, v71
    v_and_b32 v207, 0xffff0000, v71
    v_lshlrev_b32 v208, 16, v72
    v_and_b32 v209, 0xffff0000, v72
    v_lshlrev_b32 v210, 16, v73
    v_and_b32 v211, 0xffff0000, v73
    v_lshlrev_b32 v212, 16, v74
    v_and_b32 v213, 0xffff0000, v74
    v_lshlrev_b32 v214, 16, v75
    v_and_b32 v215, 0xffff0000, v75
    v_lshlrev_b32 v216, 16, v76
    v_and_b32 v217, 0xffff0000, v76
    v_lshlrev_b32 v218, 16, v77
    v_and_b32 v219, 0xffff0000, v77
    v_lshlrev_b32 v220, 16, v78
    v_and_b32 v221, 0xffff0000, v78
    v_lshlrev_b32 v222, 16, v79
    v_and_b32 v223, 0xffff0000, v79
    v_add_f32 v8, v96, v97
    v_add_f32 v8, v8, v98
    v_add_f32 v8, v8, v99
    v_add_f32 v8, v8, v100
    v_add_f32 v8, v8, v101
    v_add_f32 v8, v8, v102
    v_add_f32 v8, v8, v103
    v_add_f32 v8, v8, v104
    v_add_f32 v8, v8, v105
    v_add_f32 v8, v8, v106
    v_add_f32 v8, v8, v107
    v_add_f32 v8, v8, v108
    v_add_f32 v8, v8, v109
    v_add_f32 v8, v8, v110
    v_add_f32 v8, v8, v111
    v_add_f32 v8, v8, v112
    v_add_f32 v8, v8, v113
    v_add_f32 v8, v8, v114
    v_add_f32 v8, v8, v115
    v_add_f32 v8, v8, v116
    v_add_f32 v8, v8, v117
    v_add_f32 v8, v8, v118
    v_add_f32 v8, v8, v119
    v_add_f32 v8, v8, v120
    v_add_f32 v8, v8, v121
    v_add_f32 v8, v8, v122
    v_add_f32 v8, v8, v123
    v_add_f32 v8, v8, v124
    v_add_f32 v8, v8, v125
    v_add_f32 v8, v8, v126
    v_add_f32 v8, v8, v127
    v_add_f32 v8, v8, v128
    v_add_f32 v8, v8, v129
    v_add_f32 v8, v8, v130
    v_add_f32 v8, v8, v131
    v_add_f32 v8, v8, v132
    v_add_f32 v8, v8, v133
    v_add_f32 v8, v8, v134
    v_add_f32 v8, v8, v135
    v_add_f32 v8, v8, v136
    v_add_f32 v8, v8, v137
    v_add_f32 v8, v8, v138
    v_add_f32 v8, v8, v139
    v_add_f32 v8, v8, v140
    v_add_f32 v8, v8, v141
    v_add_f32 v8, v8, v142
    v_add_f32 v8, v8, v143
    v_add_f32 v8, v8, v144
    v_add_f32 v8, v8, v145
    v_add_f32 v8, v8, v146
    v_add_f32 v8, v8, v147
    v_add_f32 v8, v8, v148
    v_add_f32 v8, v8, v149
    v_add_f32 v8, v8, v150
    v_add_f32 v8, v8, v151
    v_add_f32 v8, v8, v152
    v_add_f32 v8, v8, v153
    v_add_f32 v8, v8, v154
    v_add_f32 v8, v8, v155
    v_add_f32 v8, v8, v156
    v_add_f32 v8, v8, v157
    v_add_f32 v8, v8, v158
    v_add_f32 v8, v8, v159
    v_add_f32 v8, v8, v160
    v_add_f32 v8, v8, v161
    v_add_f32 v8, v8, v162
    v_add_f32 v8, v8, v163
    v_add_f32 v8, v8, v164
    v_add_f32 v8, v8, v165
    v_add_f32 v8, v8, v166
    v_add_f32 v8, v8, v167
    v_add_f32 v8, v8, v168
    v_add_f32 v8, v8, v169
    v_add_f32 v8, v8, v170
    v_add_f32 v8, v8, v171
    v_add_f32 v8, v8, v172
    v_add_f32 v8, v8, v173
    v_add_f32 v8, v8, v174
    v_add_f32 v8, v8, v175
    v_add_f32 v8, v8, v176
    v_add_f32 v8, v8, v177
    v_add_f32 v8, v8, v178
    v_add_f32 v8, v8, v179
    v_add_f32 v8, v8, v180
    v_add_f32 v8, v8, v181
    v_add_f32 v8, v8, v182
    v_add_f32 v8, v8, v183
    v_add_f32 v8, v8, v184
    v_add_f32 v8, v8, v185
    v_add_f32 v8, v8, v186
    v_add_f32 v8, v8, v187
    v_add_f32 v8, v8, v188
    v_add_f32 v8, v8, v189
    v_add_f32 v8, v8, v190
    v_add_f32 v8, v8, v191
    v_add_f32 v8, v8, v192
    v_add_f32 v8, v8, v193
    v_add_f32 v8, v8, v194
    v_add_f32 v8, v8, v195
    v_add_f32 v8, v8, v196
    v_add_f32 v8, v8, v197
    v_add_f32 v8, v8, v198
    v_add_f32 v8, v8, v199
    v_add_f32 v8, v8, v200
    v_add_f32 v8, v8, v201
    v_add_f32 v8, v8, v202
    v_add_f32 v8, v8, v203
    v_add_f32 v8, v8, v204
    v_add_f32 v8, v8, v205
    v_add_f32 v8, v8, v206
    v_add_f32 v8, v8, v207
    v_add_f32 v8, v8, v208
    v_add_f32 v8, v8, v209
    v_add_f32 v8, v8, v210
    v_add_f32 v8, v8, v211
    v_add_f32 v8, v8, v212
    v_add_f32 v8, v8, v213
    v_add_f32 v8, v8, v214
    v_add_f32 v8, v8, v215
    v_add_f32 v8, v8, v216
    v_add_f32 v8, v8, v217
    v_add_f32 v8, v8, v218
    v_add_f32 v8, v8, v219
    v_add_f32 v8, v8, v220
    v_add_f32 v8, v8, v221
    v_add_f32 v8, v8, v222
    v_add_f32 v8, v8, v223
    ds_bpermute_b32 v9, v5, v8
    s_waitcnt lgkmcnt(0)
    v_add_f32 v8, v8, v9
    ds_bpermute_b32 v9, v6, v8
    s_waitcnt lgkmcnt(0)
    v_add_f32 v8, v8, v9
    v_mul_f32 v8, 0x3b000000, v8
    v_mov_b32 v10, 0
    v_sub_f32 v9, v96, v8
    v_fmac_f32 v10, v9, v9
    v_sub_f32 v9, v97, v8
    v_fmac_f32 v10, v9, v9
    v_sub_f32 v9, v98, v8
    v_fmac_f32 v10, v9, v9
    v_sub_f32 v9, v99, v8
    v_fmac_f32 v10, v9, v9
    v_sub_f32 v9, v100, v8
    v_fmac_f32 v10, v9, v9
    v_sub_f32 v9, v101, v8
    v_fmac_f32 v10, v9, v9
    v_sub_f32 v9, v102, v8
    v_fmac_f32 v10, v9, v9
    v_sub_f32 v9, v103, v8
    v_fmac_f32 v10, v9, v9
    v_sub_f32 v9, v104, v8
    v_fmac_f32 v10, v9, v9
    v_sub_f32 v9, v105, v8
    v_fmac_f32 v10, v9, v9
    v_sub_f32 v9, v106, v8
    v_fmac_f32 v10, v9, v9
    v_sub_f32 v9, v107, v8
    v_fmac_f32 v10, v9, v9
    v_sub_f32 v9, v108, v8
    v_fmac_f32 v10, v9, v9
    v_sub_f32 v9, v109, v8
    v_fmac_f32 v10, v9, v9
    v_sub_f32 v9, v110, v8
    v_fmac_f32 v10, v9, v9
    v_sub_f32 v9, v111, v8
    v_fmac_f32 v10, v9, v9
    v_sub_f32 v9, v112, v8
    v_fmac_f32 v10, v9, v9
    v_sub_f32 v9, v113, v8
    v_fmac_f32 v10, v9, v9
    v_sub_f32 v9, v114, v8
    v_fmac_f32 v10, v9, v9
    v_sub_f32 v9, v115, v8
    v_fmac_f32 v10, v9, v9
    v_sub_f32 v9, v116, v8
    v_fmac_f32 v10, v9, v9
    v_sub_f32 v9, v117, v8
    v_fmac_f32 v10, v9, v9
    v_sub_f32 v9, v118, v8
    v_fmac_f32 v10, v9, v9
    v_sub_f32 v9, v119, v8
    v_fmac_f32 v10, v9, v9
    v_sub_f32 v9, v120, v8
    v_fmac_f32 v10, v9, v9
    v_sub_f32 v9, v121, v8
    v_fmac_f32 v10, v9, v9
    v_sub_f32 v9, v122, v8
    v_fmac_f32 v10, v9, v9
    v_sub_f32 v9, v123, v8
    v_fmac_f32 v10, v9, v9
    v_sub_f32 v9, v124, v8
    v_fmac_f32 v10, v9, v9
    v_sub_f32 v9, v125, v8
    v_fmac_f32 v10, v9, v9
    v_sub_f32 v9, v126, v8
    v_fmac_f32 v10, v9, v9
    v_sub_f32 v9, v127, v8
    v_fmac_f32 v10, v9, v9
    v_sub_f32 v9, v128, v8
    v_fmac_f32 v10, v9, v9
    v_sub_f32 v9, v129, v8
    v_fmac_f32 v10, v9, v9
    v_sub_f32 v9, v130, v8
    v_fmac_f32 v10, v9, v9
    v_sub_f32 v9, v131, v8
    v_fmac_f32 v10, v9, v9
    v_sub_f32 v9, v132, v8
    v_fmac_f32 v10, v9, v9
    v_sub_f32 v9, v133, v8
    v_fmac_f32 v10, v9, v9
    v_sub_f32 v9, v134, v8
    v_fmac_f32 v10, v9, v9
    v_sub_f32 v9, v135, v8
    v_fmac_f32 v10, v9, v9
    v_sub_f32 v9, v136, v8
    v_fmac_f32 v10, v9, v9
    v_sub_f32 v9, v137, v8
    v_fmac_f32 v10, v9, v9
    v_sub_f32 v9, v138, v8
    v_fmac_f32 v10, v9, v9
    v_sub_f32 v9, v139, v8
    v_fmac_f32 v10, v9, v9
    v_sub_f32 v9, v140, v8
    v_fmac_f32 v10, v9, v9
    v_sub_f32 v9, v141, v8
    v_fmac_f32 v10, v9, v9
    v_sub_f32 v9, v142, v8
    v_fmac_f32 v10, v9, v9
    v_sub_f32 v9, v143, v8
    v_fmac_f32 v10, v9, v9
    v_sub_f32 v9, v144, v8
    v_fmac_f32 v10, v9, v9
    v_sub_f32 v9, v145, v8
    v_fmac_f32 v10, v9, v9
    v_sub_f32 v9, v146, v8
    v_fmac_f32 v10, v9, v9
    v_sub_f32 v9, v147, v8
    v_fmac_f32 v10, v9, v9
    v_sub_f32 v9, v148, v8
    v_fmac_f32 v10, v9, v9
    v_sub_f32 v9, v149, v8
    v_fmac_f32 v10, v9, v9
    v_sub_f32 v9, v150, v8
    v_fmac_f32 v10, v9, v9
    v_sub_f32 v9, v151, v8
    v_fmac_f32 v10, v9, v9
    v_sub_f32 v9, v152, v8
    v_fmac_f32 v10, v9, v9
    v_sub_f32 v9, v153, v8
    v_fmac_f32 v10, v9, v9
    v_sub_f32 v9, v154, v8
    v_fmac_f32 v10, v9, v9
    v_sub_f32 v9, v155, v8
    v_fmac_f32 v10, v9, v9
    v_sub_f32 v9, v156, v8
    v_fmac_f32 v10, v9, v9
    v_sub_f32 v9, v157, v8
    v_fmac_f32 v10, v9, v9
    v_sub_f32 v9, v158, v8
    v_fmac_f32 v10, v9, v9
    v_sub_f32 v9, v159, v8
    v_fmac_f32 v10, v9, v9
    v_sub_f32 v9, v160, v8
    v_fmac_f32 v10, v9, v9
    v_sub_f32 v9, v161, v8
    v_fmac_f32 v10, v9, v9
    v_sub_f32 v9, v162, v8
    v_fmac_f32 v10, v9, v9
    v_sub_f32 v9, v163, v8
    v_fmac_f32 v10, v9, v9
    v_sub_f32 v9, v164, v8
    v_fmac_f32 v10, v9, v9
    v_sub_f32 v9, v165, v8
    v_fmac_f32 v10, v9, v9
    v_sub_f32 v9, v166, v8
    v_fmac_f32 v10, v9, v9
    v_sub_f32 v9, v167, v8
    v_fmac_f32 v10, v9, v9
    v_sub_f32 v9, v168, v8
    v_fmac_f32 v10, v9, v9
    v_sub_f32 v9, v169, v8
    v_fmac_f32 v10, v9, v9
    v_sub_f32 v9, v170, v8
    v_fmac_f32 v10, v9, v9
    v_sub_f32 v9, v171, v8
    v_fmac_f32 v10, v9, v9
    v_sub_f32 v9, v172, v8
    v_fmac_f32 v10, v9, v9
    v_sub_f32 v9, v173, v8
    v_fmac_f32 v10, v9, v9
    v_sub_f32 v9, v174, v8
    v_fmac_f32 v10, v9, v9
    v_sub_f32 v9, v175, v8
    v_fmac_f32 v10, v9, v9
    v_sub_f32 v9, v176, v8
    v_fmac_f32 v10, v9, v9
    v_sub_f32 v9, v177, v8
    v_fmac_f32 v10, v9, v9
    v_sub_f32 v9, v178, v8
    v_fmac_f32 v10, v9, v9
    v_sub_f32 v9, v179, v8
    v_fmac_f32 v10, v9, v9
    v_sub_f32 v9, v180, v8
    v_fmac_f32 v10, v9, v9
    v_sub_f32 v9, v181, v8
    v_fmac_f32 v10, v9, v9
    v_sub_f32 v9, v182, v8
    v_fmac_f32 v10, v9, v9
    v_sub_f32 v9, v183, v8
    v_fmac_f32 v10, v9, v9
    v_sub_f32 v9, v184, v8
    v_fmac_f32 v10, v9, v9
    v_sub_f32 v9, v185, v8
    v_fmac_f32 v10, v9, v9
    v_sub_f32 v9, v186, v8
    v_fmac_f32 v10, v9, v9
    v_sub_f32 v9, v187, v8
    v_fmac_f32 v10, v9, v9
    v_sub_f32 v9, v188, v8
    v_fmac_f32 v10, v9, v9
    v_sub_f32 v9, v189, v8
    v_fmac_f32 v10, v9, v9
    v_sub_f32 v9, v190, v8
    v_fmac_f32 v10, v9, v9
    v_sub_f32 v9, v191, v8
    v_fmac_f32 v10, v9, v9
    v_sub_f32 v9, v192, v8
    v_fmac_f32 v10, v9, v9
    v_sub_f32 v9, v193, v8
    v_fmac_f32 v10, v9, v9
    v_sub_f32 v9, v194, v8
    v_fmac_f32 v10, v9, v9
    v_sub_f32 v9, v195, v8
    v_fmac_f32 v10, v9, v9
    v_sub_f32 v9, v196, v8
    v_fmac_f32 v10, v9, v9
    v_sub_f32 v9, v197, v8
    v_fmac_f32 v10, v9, v9
    v_sub_f32 v9, v198, v8
    v_fmac_f32 v10, v9, v9
    v_sub_f32 v9, v199, v8
    v_fmac_f32 v10, v9, v9
    v_sub_f32 v9, v200, v8
    v_fmac_f32 v10, v9, v9
    v_sub_f32 v9, v201, v8
    v_fmac_f32 v10, v9, v9
    v_sub_f32 v9, v202, v8
    v_fmac_f32 v10, v9, v9
    v_sub_f32 v9, v203, v8
    v_fmac_f32 v10, v9, v9
    v_sub_f32 v9, v204, v8
    v_fmac_f32 v10, v9, v9
    v_sub_f32 v9, v205, v8
    v_fmac_f32 v10, v9, v9
    v_sub_f32 v9, v206, v8
    v_fmac_f32 v10, v9, v9
    v_sub_f32 v9, v207, v8
    v_fmac_f32 v10, v9, v9
    v_sub_f32 v9, v208, v8
    v_fmac_f32 v10, v9, v9
    v_sub_f32 v9, v209, v8
    v_fmac_f32 v10, v9, v9
    v_sub_f32 v9, v210, v8
    v_fmac_f32 v10, v9, v9
    v_sub_f32 v9, v211, v8
    v_fmac_f32 v10, v9, v9
    v_sub_f32 v9, v212, v8
    v_fmac_f32 v10, v9, v9
    v_sub_f32 v9, v213, v8
    v_fmac_f32 v10, v9, v9
    v_sub_f32 v9, v214, v8
    v_fmac_f32 v10, v9, v9
    v_sub_f32 v9, v215, v8
    v_fmac_f32 v10, v9, v9
    v_sub_f32 v9, v216, v8
    v_fmac_f32 v10, v9, v9
    v_sub_f32 v9, v217, v8
    v_fmac_f32 v10, v9, v9
    v_sub_f32 v9, v218, v8
    v_fmac_f32 v10, v9, v9
    v_sub_f32 v9, v219, v8
    v_fmac_f32 v10, v9, v9
    v_sub_f32 v9, v220, v8
    v_fmac_f32 v10, v9, v9
    v_sub_f32 v9, v221, v8
    v_fmac_f32 v10, v9, v9
    v_sub_f32 v9, v222, v8
    v_fmac_f32 v10, v9, v9
    v_sub_f32 v9, v223, v8
    v_fmac_f32 v10, v9, v9
    ds_bpermute_b32 v9, v5, v10
    s_waitcnt lgkmcnt(0)
    v_add_f32 v10, v10, v9
    ds_bpermute_b32 v9, v6, v10
    s_waitcnt lgkmcnt(0)
    v_add_f32 v10, v10, v9
    v_mul_f32 v10, 0x3b000000, v10
    v_cvt_pk_bf16_f32 v8, v8, v8
    v_lshlrev_b32 v8, 16, v8
    v_cvt_pk_bf16_f32 v10, v10, v10
    v_lshlrev_b32 v10, 16, v10
    v_add_f32 v10, 0x3727c5ac, v10
    v_cvt_pk_bf16_f32 v10, v10, v10
    v_lshlrev_b32 v10, 16, v10
    v_sqrt_f32 v10, v10
    s_nop 0
    v_cvt_pk_bf16_f32 v10, v10, v10
    v_lshlrev_b32 v10, 16, v10
    v_rcp_f32 v11, v10
    s_nop 0
    v_fma_f32 v12, -v10, v11, 2.0
    v_mul_f32 v11, v11, v12
    v_sub_f32 v96, v96, v8
    v_sub_f32 v97, v97, v8
    v_cvt_pk_bf16_f32 v12, v96, v97
    v_lshlrev_b32 v96, 16, v12
    v_and_b32 v97, 0xffff0000, v12
    v_mul_f32 v96, v96, v11
    v_mul_f32 v97, v97, v11
    v_cvt_pk_bf16_f32 v16, v96, v97
    v_sub_f32 v98, v98, v8
    v_sub_f32 v99, v99, v8
    v_cvt_pk_bf16_f32 v12, v98, v99
    v_lshlrev_b32 v98, 16, v12
    v_and_b32 v99, 0xffff0000, v12
    v_mul_f32 v98, v98, v11
    v_mul_f32 v99, v99, v11
    v_cvt_pk_bf16_f32 v17, v98, v99
    v_sub_f32 v100, v100, v8
    v_sub_f32 v101, v101, v8
    v_cvt_pk_bf16_f32 v12, v100, v101
    v_lshlrev_b32 v100, 16, v12
    v_and_b32 v101, 0xffff0000, v12
    v_mul_f32 v100, v100, v11
    v_mul_f32 v101, v101, v11
    v_cvt_pk_bf16_f32 v18, v100, v101
    v_sub_f32 v102, v102, v8
    v_sub_f32 v103, v103, v8
    v_cvt_pk_bf16_f32 v12, v102, v103
    v_lshlrev_b32 v102, 16, v12
    v_and_b32 v103, 0xffff0000, v12
    v_mul_f32 v102, v102, v11
    v_mul_f32 v103, v103, v11
    v_cvt_pk_bf16_f32 v19, v102, v103
    v_sub_f32 v104, v104, v8
    v_sub_f32 v105, v105, v8
    v_cvt_pk_bf16_f32 v12, v104, v105
    v_lshlrev_b32 v104, 16, v12
    v_and_b32 v105, 0xffff0000, v12
    v_mul_f32 v104, v104, v11
    v_mul_f32 v105, v105, v11
    v_cvt_pk_bf16_f32 v20, v104, v105
    v_sub_f32 v106, v106, v8
    v_sub_f32 v107, v107, v8
    v_cvt_pk_bf16_f32 v12, v106, v107
    v_lshlrev_b32 v106, 16, v12
    v_and_b32 v107, 0xffff0000, v12
    v_mul_f32 v106, v106, v11
    v_mul_f32 v107, v107, v11
    v_cvt_pk_bf16_f32 v21, v106, v107
    v_sub_f32 v108, v108, v8
    v_sub_f32 v109, v109, v8
    v_cvt_pk_bf16_f32 v12, v108, v109
    v_lshlrev_b32 v108, 16, v12
    v_and_b32 v109, 0xffff0000, v12
    v_mul_f32 v108, v108, v11
    v_mul_f32 v109, v109, v11
    v_cvt_pk_bf16_f32 v22, v108, v109
    v_sub_f32 v110, v110, v8
    v_sub_f32 v111, v111, v8
    v_cvt_pk_bf16_f32 v12, v110, v111
    v_lshlrev_b32 v110, 16, v12
    v_and_b32 v111, 0xffff0000, v12
    v_mul_f32 v110, v110, v11
    v_mul_f32 v111, v111, v11
    v_cvt_pk_bf16_f32 v23, v110, v111
    v_sub_f32 v112, v112, v8
    v_sub_f32 v113, v113, v8
    v_cvt_pk_bf16_f32 v12, v112, v113
    v_lshlrev_b32 v112, 16, v12
    v_and_b32 v113, 0xffff0000, v12
    v_mul_f32 v112, v112, v11
    v_mul_f32 v113, v113, v11
    v_cvt_pk_bf16_f32 v24, v112, v113
    v_sub_f32 v114, v114, v8
    v_sub_f32 v115, v115, v8
    v_cvt_pk_bf16_f32 v12, v114, v115
    v_lshlrev_b32 v114, 16, v12
    v_and_b32 v115, 0xffff0000, v12
    v_mul_f32 v114, v114, v11
    v_mul_f32 v115, v115, v11
    v_cvt_pk_bf16_f32 v25, v114, v115
    v_sub_f32 v116, v116, v8
    v_sub_f32 v117, v117, v8
    v_cvt_pk_bf16_f32 v12, v116, v117
    v_lshlrev_b32 v116, 16, v12
    v_and_b32 v117, 0xffff0000, v12
    v_mul_f32 v116, v116, v11
    v_mul_f32 v117, v117, v11
    v_cvt_pk_bf16_f32 v26, v116, v117
    v_sub_f32 v118, v118, v8
    v_sub_f32 v119, v119, v8
    v_cvt_pk_bf16_f32 v12, v118, v119
    v_lshlrev_b32 v118, 16, v12
    v_and_b32 v119, 0xffff0000, v12
    v_mul_f32 v118, v118, v11
    v_mul_f32 v119, v119, v11
    v_cvt_pk_bf16_f32 v27, v118, v119
    v_sub_f32 v120, v120, v8
    v_sub_f32 v121, v121, v8
    v_cvt_pk_bf16_f32 v12, v120, v121
    v_lshlrev_b32 v120, 16, v12
    v_and_b32 v121, 0xffff0000, v12
    v_mul_f32 v120, v120, v11
    v_mul_f32 v121, v121, v11
    v_cvt_pk_bf16_f32 v28, v120, v121
    v_sub_f32 v122, v122, v8
    v_sub_f32 v123, v123, v8
    v_cvt_pk_bf16_f32 v12, v122, v123
    v_lshlrev_b32 v122, 16, v12
    v_and_b32 v123, 0xffff0000, v12
    v_mul_f32 v122, v122, v11
    v_mul_f32 v123, v123, v11
    v_cvt_pk_bf16_f32 v29, v122, v123
    v_sub_f32 v124, v124, v8
    v_sub_f32 v125, v125, v8
    v_cvt_pk_bf16_f32 v12, v124, v125
    v_lshlrev_b32 v124, 16, v12
    v_and_b32 v125, 0xffff0000, v12
    v_mul_f32 v124, v124, v11
    v_mul_f32 v125, v125, v11
    v_cvt_pk_bf16_f32 v30, v124, v125
    v_sub_f32 v126, v126, v8
    v_sub_f32 v127, v127, v8
    v_cvt_pk_bf16_f32 v12, v126, v127
    v_lshlrev_b32 v126, 16, v12
    v_and_b32 v127, 0xffff0000, v12
    v_mul_f32 v126, v126, v11
    v_mul_f32 v127, v127, v11
    v_cvt_pk_bf16_f32 v31, v126, v127
    v_sub_f32 v128, v128, v8
    v_sub_f32 v129, v129, v8
    v_cvt_pk_bf16_f32 v12, v128, v129
    v_lshlrev_b32 v128, 16, v12
    v_and_b32 v129, 0xffff0000, v12
    v_mul_f32 v128, v128, v11
    v_mul_f32 v129, v129, v11
    v_cvt_pk_bf16_f32 v32, v128, v129
    v_sub_f32 v130, v130, v8
    v_sub_f32 v131, v131, v8
    v_cvt_pk_bf16_f32 v12, v130, v131
    v_lshlrev_b32 v130, 16, v12
    v_and_b32 v131, 0xffff0000, v12
    v_mul_f32 v130, v130, v11
    v_mul_f32 v131, v131, v11
    v_cvt_pk_bf16_f32 v33, v130, v131
    v_sub_f32 v132, v132, v8
    v_sub_f32 v133, v133, v8
    v_cvt_pk_bf16_f32 v12, v132, v133
    v_lshlrev_b32 v132, 16, v12
    v_and_b32 v133, 0xffff0000, v12
    v_mul_f32 v132, v132, v11
    v_mul_f32 v133, v133, v11
    v_cvt_pk_bf16_f32 v34, v132, v133
    v_sub_f32 v134, v134, v8
    v_sub_f32 v135, v135, v8
    v_cvt_pk_bf16_f32 v12, v134, v135
    v_lshlrev_b32 v134, 16, v12
    v_and_b32 v135, 0xffff0000, v12
    v_mul_f32 v134, v134, v11
    v_mul_f32 v135, v135, v11
    v_cvt_pk_bf16_f32 v35, v134, v135
    v_sub_f32 v136, v136, v8
    v_sub_f32 v137, v137, v8
    v_cvt_pk_bf16_f32 v12, v136, v137
    v_lshlrev_b32 v136, 16, v12
    v_and_b32 v137, 0xffff0000, v12
    v_mul_f32 v136, v136, v11
    v_mul_f32 v137, v137, v11
    v_cvt_pk_bf16_f32 v36, v136, v137
    v_sub_f32 v138, v138, v8
    v_sub_f32 v139, v139, v8
    v_cvt_pk_bf16_f32 v12, v138, v139
    v_lshlrev_b32 v138, 16, v12
    v_and_b32 v139, 0xffff0000, v12
    v_mul_f32 v138, v138, v11
    v_mul_f32 v139, v139, v11
    v_cvt_pk_bf16_f32 v37, v138, v139
    v_sub_f32 v140, v140, v8
    v_sub_f32 v141, v141, v8
    v_cvt_pk_bf16_f32 v12, v140, v141
    v_lshlrev_b32 v140, 16, v12
    v_and_b32 v141, 0xffff0000, v12
    v_mul_f32 v140, v140, v11
    v_mul_f32 v141, v141, v11
    v_cvt_pk_bf16_f32 v38, v140, v141
    v_sub_f32 v142, v142, v8
    v_sub_f32 v143, v143, v8
    v_cvt_pk_bf16_f32 v12, v142, v143
    v_lshlrev_b32 v142, 16, v12
    v_and_b32 v143, 0xffff0000, v12
    v_mul_f32 v142, v142, v11
    v_mul_f32 v143, v143, v11
    v_cvt_pk_bf16_f32 v39, v142, v143
    v_sub_f32 v144, v144, v8
    v_sub_f32 v145, v145, v8
    v_cvt_pk_bf16_f32 v12, v144, v145
    v_lshlrev_b32 v144, 16, v12
    v_and_b32 v145, 0xffff0000, v12
    v_mul_f32 v144, v144, v11
    v_mul_f32 v145, v145, v11
    v_cvt_pk_bf16_f32 v40, v144, v145
    v_sub_f32 v146, v146, v8
    v_sub_f32 v147, v147, v8
    v_cvt_pk_bf16_f32 v12, v146, v147
    v_lshlrev_b32 v146, 16, v12
    v_and_b32 v147, 0xffff0000, v12
    v_mul_f32 v146, v146, v11
    v_mul_f32 v147, v147, v11
    v_cvt_pk_bf16_f32 v41, v146, v147
    v_sub_f32 v148, v148, v8
    v_sub_f32 v149, v149, v8
    v_cvt_pk_bf16_f32 v12, v148, v149
    v_lshlrev_b32 v148, 16, v12
    v_and_b32 v149, 0xffff0000, v12
    v_mul_f32 v148, v148, v11
    v_mul_f32 v149, v149, v11
    v_cvt_pk_bf16_f32 v42, v148, v149
    v_sub_f32 v150, v150, v8
    v_sub_f32 v151, v151, v8
    v_cvt_pk_bf16_f32 v12, v150, v151
    v_lshlrev_b32 v150, 16, v12
    v_and_b32 v151, 0xffff0000, v12
    v_mul_f32 v150, v150, v11
    v_mul_f32 v151, v151, v11
    v_cvt_pk_bf16_f32 v43, v150, v151
    v_sub_f32 v152, v152, v8
    v_sub_f32 v153, v153, v8
    v_cvt_pk_bf16_f32 v12, v152, v153
    v_lshlrev_b32 v152, 16, v12
    v_and_b32 v153, 0xffff0000, v12
    v_mul_f32 v152, v152, v11
    v_mul_f32 v153, v153, v11
    v_cvt_pk_bf16_f32 v44, v152, v153
    v_sub_f32 v154, v154, v8
    v_sub_f32 v155, v155, v8
    v_cvt_pk_bf16_f32 v12, v154, v155
    v_lshlrev_b32 v154, 16, v12
    v_and_b32 v155, 0xffff0000, v12
    v_mul_f32 v154, v154, v11
    v_mul_f32 v155, v155, v11
    v_cvt_pk_bf16_f32 v45, v154, v155
    v_sub_f32 v156, v156, v8
    v_sub_f32 v157, v157, v8
    v_cvt_pk_bf16_f32 v12, v156, v157
    v_lshlrev_b32 v156, 16, v12
    v_and_b32 v157, 0xffff0000, v12
    v_mul_f32 v156, v156, v11
    v_mul_f32 v157, v157, v11
    v_cvt_pk_bf16_f32 v46, v156, v157
    v_sub_f32 v158, v158, v8
    v_sub_f32 v159, v159, v8
    v_cvt_pk_bf16_f32 v12, v158, v159
    v_lshlrev_b32 v158, 16, v12
    v_and_b32 v159, 0xffff0000, v12
    v_mul_f32 v158, v158, v11
    v_mul_f32 v159, v159, v11
    v_cvt_pk_bf16_f32 v47, v158, v159
    v_sub_f32 v160, v160, v8
    v_sub_f32 v161, v161, v8
    v_cvt_pk_bf16_f32 v12, v160, v161
    v_lshlrev_b32 v160, 16, v12
    v_and_b32 v161, 0xffff0000, v12
    v_mul_f32 v160, v160, v11
    v_mul_f32 v161, v161, v11
    v_cvt_pk_bf16_f32 v48, v160, v161
    v_sub_f32 v162, v162, v8
    v_sub_f32 v163, v163, v8
    v_cvt_pk_bf16_f32 v12, v162, v163
    v_lshlrev_b32 v162, 16, v12
    v_and_b32 v163, 0xffff0000, v12
    v_mul_f32 v162, v162, v11
    v_mul_f32 v163, v163, v11
    v_cvt_pk_bf16_f32 v49, v162, v163
    v_sub_f32 v164, v164, v8
    v_sub_f32 v165, v165, v8
    v_cvt_pk_bf16_f32 v12, v164, v165
    v_lshlrev_b32 v164, 16, v12
    v_and_b32 v165, 0xffff0000, v12
    v_mul_f32 v164, v164, v11
    v_mul_f32 v165, v165, v11
    v_cvt_pk_bf16_f32 v50, v164, v165
    v_sub_f32 v166, v166, v8
    v_sub_f32 v167, v167, v8
    v_cvt_pk_bf16_f32 v12, v166, v167
    v_lshlrev_b32 v166, 16, v12
    v_and_b32 v167, 0xffff0000, v12
    v_mul_f32 v166, v166, v11
    v_mul_f32 v167, v167, v11
    v_cvt_pk_bf16_f32 v51, v166, v167
    v_sub_f32 v168, v168, v8
    v_sub_f32 v169, v169, v8
    v_cvt_pk_bf16_f32 v12, v168, v169
    v_lshlrev_b32 v168, 16, v12
    v_and_b32 v169, 0xffff0000, v12
    v_mul_f32 v168, v168, v11
    v_mul_f32 v169, v169, v11
    v_cvt_pk_bf16_f32 v52, v168, v169
    v_sub_f32 v170, v170, v8
    v_sub_f32 v171, v171, v8
    v_cvt_pk_bf16_f32 v12, v170, v171
    v_lshlrev_b32 v170, 16, v12
    v_and_b32 v171, 0xffff0000, v12
    v_mul_f32 v170, v170, v11
    v_mul_f32 v171, v171, v11
    v_cvt_pk_bf16_f32 v53, v170, v171
    v_sub_f32 v172, v172, v8
    v_sub_f32 v173, v173, v8
    v_cvt_pk_bf16_f32 v12, v172, v173
    v_lshlrev_b32 v172, 16, v12
    v_and_b32 v173, 0xffff0000, v12
    v_mul_f32 v172, v172, v11
    v_mul_f32 v173, v173, v11
    v_cvt_pk_bf16_f32 v54, v172, v173
    v_sub_f32 v174, v174, v8
    v_sub_f32 v175, v175, v8
    v_cvt_pk_bf16_f32 v12, v174, v175
    v_lshlrev_b32 v174, 16, v12
    v_and_b32 v175, 0xffff0000, v12
    v_mul_f32 v174, v174, v11
    v_mul_f32 v175, v175, v11
    v_cvt_pk_bf16_f32 v55, v174, v175
    v_sub_f32 v176, v176, v8
    v_sub_f32 v177, v177, v8
    v_cvt_pk_bf16_f32 v12, v176, v177
    v_lshlrev_b32 v176, 16, v12
    v_and_b32 v177, 0xffff0000, v12
    v_mul_f32 v176, v176, v11
    v_mul_f32 v177, v177, v11
    v_cvt_pk_bf16_f32 v56, v176, v177
    v_sub_f32 v178, v178, v8
    v_sub_f32 v179, v179, v8
    v_cvt_pk_bf16_f32 v12, v178, v179
    v_lshlrev_b32 v178, 16, v12
    v_and_b32 v179, 0xffff0000, v12
    v_mul_f32 v178, v178, v11
    v_mul_f32 v179, v179, v11
    v_cvt_pk_bf16_f32 v57, v178, v179
    v_sub_f32 v180, v180, v8
    v_sub_f32 v181, v181, v8
    v_cvt_pk_bf16_f32 v12, v180, v181
    v_lshlrev_b32 v180, 16, v12
    v_and_b32 v181, 0xffff0000, v12
    v_mul_f32 v180, v180, v11
    v_mul_f32 v181, v181, v11
    v_cvt_pk_bf16_f32 v58, v180, v181
    v_sub_f32 v182, v182, v8
    v_sub_f32 v183, v183, v8
    v_cvt_pk_bf16_f32 v12, v182, v183
    v_lshlrev_b32 v182, 16, v12
    v_and_b32 v183, 0xffff0000, v12
    v_mul_f32 v182, v182, v11
    v_mul_f32 v183, v183, v11
    v_cvt_pk_bf16_f32 v59, v182, v183
    v_sub_f32 v184, v184, v8
    v_sub_f32 v185, v185, v8
    v_cvt_pk_bf16_f32 v12, v184, v185
    v_lshlrev_b32 v184, 16, v12
    v_and_b32 v185, 0xffff0000, v12
    v_mul_f32 v184, v184, v11
    v_mul_f32 v185, v185, v11
    v_cvt_pk_bf16_f32 v60, v184, v185
    v_sub_f32 v186, v186, v8
    v_sub_f32 v187, v187, v8
    v_cvt_pk_bf16_f32 v12, v186, v187
    v_lshlrev_b32 v186, 16, v12
    v_and_b32 v187, 0xffff0000, v12
    v_mul_f32 v186, v186, v11
    v_mul_f32 v187, v187, v11
    v_cvt_pk_bf16_f32 v61, v186, v187
    v_sub_f32 v188, v188, v8
    v_sub_f32 v189, v189, v8
    v_cvt_pk_bf16_f32 v12, v188, v189
    v_lshlrev_b32 v188, 16, v12
    v_and_b32 v189, 0xffff0000, v12
    v_mul_f32 v188, v188, v11
    v_mul_f32 v189, v189, v11
    v_cvt_pk_bf16_f32 v62, v188, v189
    v_sub_f32 v190, v190, v8
    v_sub_f32 v191, v191, v8
    v_cvt_pk_bf16_f32 v12, v190, v191
    v_lshlrev_b32 v190, 16, v12
    v_and_b32 v191, 0xffff0000, v12
    v_mul_f32 v190, v190, v11
    v_mul_f32 v191, v191, v11
    v_cvt_pk_bf16_f32 v63, v190, v191
    v_sub_f32 v192, v192, v8
    v_sub_f32 v193, v193, v8
    v_cvt_pk_bf16_f32 v12, v192, v193
    v_lshlrev_b32 v192, 16, v12
    v_and_b32 v193, 0xffff0000, v12
    v_mul_f32 v192, v192, v11
    v_mul_f32 v193, v193, v11
    v_cvt_pk_bf16_f32 v64, v192, v193
    v_sub_f32 v194, v194, v8
    v_sub_f32 v195, v195, v8
    v_cvt_pk_bf16_f32 v12, v194, v195
    v_lshlrev_b32 v194, 16, v12
    v_and_b32 v195, 0xffff0000, v12
    v_mul_f32 v194, v194, v11
    v_mul_f32 v195, v195, v11
    v_cvt_pk_bf16_f32 v65, v194, v195
    v_sub_f32 v196, v196, v8
    v_sub_f32 v197, v197, v8
    v_cvt_pk_bf16_f32 v12, v196, v197
    v_lshlrev_b32 v196, 16, v12
    v_and_b32 v197, 0xffff0000, v12
    v_mul_f32 v196, v196, v11
    v_mul_f32 v197, v197, v11
    v_cvt_pk_bf16_f32 v66, v196, v197
    v_sub_f32 v198, v198, v8
    v_sub_f32 v199, v199, v8
    v_cvt_pk_bf16_f32 v12, v198, v199
    v_lshlrev_b32 v198, 16, v12
    v_and_b32 v199, 0xffff0000, v12
    v_mul_f32 v198, v198, v11
    v_mul_f32 v199, v199, v11
    v_cvt_pk_bf16_f32 v67, v198, v199
    v_sub_f32 v200, v200, v8
    v_sub_f32 v201, v201, v8
    v_cvt_pk_bf16_f32 v12, v200, v201
    v_lshlrev_b32 v200, 16, v12
    v_and_b32 v201, 0xffff0000, v12
    v_mul_f32 v200, v200, v11
    v_mul_f32 v201, v201, v11
    v_cvt_pk_bf16_f32 v68, v200, v201
    v_sub_f32 v202, v202, v8
    v_sub_f32 v203, v203, v8
    v_cvt_pk_bf16_f32 v12, v202, v203
    v_lshlrev_b32 v202, 16, v12
    v_and_b32 v203, 0xffff0000, v12
    v_mul_f32 v202, v202, v11
    v_mul_f32 v203, v203, v11
    v_cvt_pk_bf16_f32 v69, v202, v203
    v_sub_f32 v204, v204, v8
    v_sub_f32 v205, v205, v8
    v_cvt_pk_bf16_f32 v12, v204, v205
    v_lshlrev_b32 v204, 16, v12
    v_and_b32 v205, 0xffff0000, v12
    v_mul_f32 v204, v204, v11
    v_mul_f32 v205, v205, v11
    v_cvt_pk_bf16_f32 v70, v204, v205
    v_sub_f32 v206, v206, v8
    v_sub_f32 v207, v207, v8
    v_cvt_pk_bf16_f32 v12, v206, v207
    v_lshlrev_b32 v206, 16, v12
    v_and_b32 v207, 0xffff0000, v12
    v_mul_f32 v206, v206, v11
    v_mul_f32 v207, v207, v11
    v_cvt_pk_bf16_f32 v71, v206, v207
    v_sub_f32 v208, v208, v8
    v_sub_f32 v209, v209, v8
    v_cvt_pk_bf16_f32 v12, v208, v209
    v_lshlrev_b32 v208, 16, v12
    v_and_b32 v209, 0xffff0000, v12
    v_mul_f32 v208, v208, v11
    v_mul_f32 v209, v209, v11
    v_cvt_pk_bf16_f32 v72, v208, v209
    v_sub_f32 v210, v210, v8
    v_sub_f32 v211, v211, v8
    v_cvt_pk_bf16_f32 v12, v210, v211
    v_lshlrev_b32 v210, 16, v12
    v_and_b32 v211, 0xffff0000, v12
    v_mul_f32 v210, v210, v11
    v_mul_f32 v211, v211, v11
    v_cvt_pk_bf16_f32 v73, v210, v211
    v_sub_f32 v212, v212, v8
    v_sub_f32 v213, v213, v8
    v_cvt_pk_bf16_f32 v12, v212, v213
    v_lshlrev_b32 v212, 16, v12
    v_and_b32 v213, 0xffff0000, v12
    v_mul_f32 v212, v212, v11
    v_mul_f32 v213, v213, v11
    v_cvt_pk_bf16_f32 v74, v212, v213
    v_sub_f32 v214, v214, v8
    v_sub_f32 v215, v215, v8
    v_cvt_pk_bf16_f32 v12, v214, v215
    v_lshlrev_b32 v214, 16, v12
    v_and_b32 v215, 0xffff0000, v12
    v_mul_f32 v214, v214, v11
    v_mul_f32 v215, v215, v11
    v_cvt_pk_bf16_f32 v75, v214, v215
    v_sub_f32 v216, v216, v8
    v_sub_f32 v217, v217, v8
    v_cvt_pk_bf16_f32 v12, v216, v217
    v_lshlrev_b32 v216, 16, v12
    v_and_b32 v217, 0xffff0000, v12
    v_mul_f32 v216, v216, v11
    v_mul_f32 v217, v217, v11
    v_cvt_pk_bf16_f32 v76, v216, v217
    v_sub_f32 v218, v218, v8
    v_sub_f32 v219, v219, v8
    v_cvt_pk_bf16_f32 v12, v218, v219
    v_lshlrev_b32 v218, 16, v12
    v_and_b32 v219, 0xffff0000, v12
    v_mul_f32 v218, v218, v11
    v_mul_f32 v219, v219, v11
    v_cvt_pk_bf16_f32 v77, v218, v219
    v_sub_f32 v220, v220, v8
    v_sub_f32 v221, v221, v8
    v_cvt_pk_bf16_f32 v12, v220, v221
    v_lshlrev_b32 v220, 16, v12
    v_and_b32 v221, 0xffff0000, v12
    v_mul_f32 v220, v220, v11
    v_mul_f32 v221, v221, v11
    v_cvt_pk_bf16_f32 v78, v220, v221
    v_sub_f32 v222, v222, v8
    v_sub_f32 v223, v223, v8
    v_cvt_pk_bf16_f32 v12, v222, v223
    v_lshlrev_b32 v222, 16, v12
    v_and_b32 v223, 0xffff0000, v12
    v_mul_f32 v222, v222, v11
    v_mul_f32 v223, v223, v11
    v_cvt_pk_bf16_f32 v79, v222, v223
    v_lshlrev_b32 v5, 4, v1
    s_add_u32 s35, s35, 0
    buffer_store_dwordx4 v[16:19], v5, s[40:43], s35 offen offset:0
    buffer_store_dwordx4 v[20:23], v5, s[40:43], s35 offen offset:1024
    buffer_store_dwordx4 v[24:27], v5, s[40:43], s35 offen offset:2048
    buffer_store_dwordx4 v[28:31], v5, s[40:43], s35 offen offset:3072
    s_add_u32 s35, s35, 4096
    buffer_store_dwordx4 v[32:35], v5, s[40:43], s35 offen offset:0
    buffer_store_dwordx4 v[36:39], v5, s[40:43], s35 offen offset:1024
    buffer_store_dwordx4 v[40:43], v5, s[40:43], s35 offen offset:2048
    buffer_store_dwordx4 v[44:47], v5, s[40:43], s35 offen offset:3072
    s_add_u32 s35, s35, 4096
    buffer_store_dwordx4 v[48:51], v5, s[40:43], s35 offen offset:0
    buffer_store_dwordx4 v[52:55], v5, s[40:43], s35 offen offset:1024
    buffer_store_dwordx4 v[56:59], v5, s[40:43], s35 offen offset:2048
    buffer_store_dwordx4 v[60:63], v5, s[40:43], s35 offen offset:3072
    s_add_u32 s35, s35, 4096
    buffer_store_dwordx4 v[64:67], v5, s[40:43], s35 offen offset:0
    buffer_store_dwordx4 v[68:71], v5, s[40:43], s35 offen offset:1024
    buffer_store_dwordx4 v[72:75], v5, s[40:43], s35 offen offset:2048
    buffer_store_dwordx4 v[76:79], v5, s[40:43], s35 offen offset:3072
    s_branch prep_end
prep_zero:
    s_sub_u32 s34, s31, 5568
    s_lshl_b32 s35, s34, 10
    s_cmp_ge_u32 s34, 512
    s_cselect_b32 s36, 524288, 0
    s_cmp_ge_u32 s34, 528
    s_cselect_b32 s36, 1556480, s36
    s_add_u32 s36, s36, 130023424
    s_add_u32 s35, s35, s36
    v_mov_b32 v8, 0
    v_mov_b32 v9, 0
    v_mov_b32 v10, 0
    v_mov_b32 v11, 0
    v_lshlrev_b32 v5, 4, v1
    buffer_store_dwordx4 v[8:11], v5, s[40:43], s35 offen
prep_end:
    s_endpgm
.globl rec_kernel
.p2align 8
.type rec_kernel,@function
rec_kernel:
    s_cmp_ge_u32 s2, 256
    s_cbranch_scc1 rec_end2
    s_load_dwordx2 s[22:23], s[0:1], 104
    s_load_dwordx2 s[24:25], s[0:1], 8
    s_load_dwordx2 s[26:27], s[0:1], 96
    v_lshrrev_b32 v1, 6, v0
    s_nop 0
    v_readfirstlane_b32 s3, v1
    v_and_b32 v1, 63, v0
    v_lshrrev_b32 v2, 4, v1
    v_and_b32 v3, 15, v1
    v_lshlrev_b32 v4, 4, v1
    s_waitcnt lgkmcnt(0)
    s_mov_b32 s40, s22
    s_and_b32 s41, s23, 0xffff
    s_mov_b32 s42, 268435456
    s_mov_b32 s43, 0x00020000
    s_mov_b32 s44, s24
    s_and_b32 s45, s25, 0xffff
    s_mov_b32 s46, 8192
    s_mov_b32 s47, 0x00020000
    s_mov_b32 s48, s26
    s_and_b32 s49, s27, 0xffff
    s_mov_b32 s50, 256
    s_mov_b32 s51, 0x00020000
    v_mov_b32 v18, 0
    s_cmp_eq_u32 s3, 0
    s_cbranch_scc0 rec_elect_done
    s_getreg_b32 s5, hwreg(HW_REG_XCC_ID, 0, 4)
    s_and_b32 s5, s5, 7
    s_lshl_b32 s6, s5, 2
    v_mov_b32 v16, 1
    v_mov_b32 v17, s6
    s_mov_b64 exec, 1
    buffer_atomic_add v16, v17, s[48:51], 0 offen sc0
    s_waitcnt vmcnt(0)
    v_readfirstlane_b32 s6, v16
    s_mov_b32 s7, -1
    s_cmp_ge_u32 s6, 32
    s_cbranch_scc1 rec_elect_pub
    s_add_u32 s8, s5, 1
    s_cmp_eq_u32 s6, 31
    s_cbranch_scc0 rec_elect_poll
    v_mov_b32 v16, s8
    v_mov_b32 v17, 0
    buffer_atomic_cmpswap v[16:17], v18, s[48:51], 0 offen offset:64 sc0
    s_waitcnt vmcnt(0)
rec_elect_poll:
    s_sleep 1
    buffer_load_dword v16, v18, s[48:51], 0 offen offset:64 sc0 sc1
    s_waitcnt vmcnt(0)
    v_readfirstlane_b32 s9, v16
    s_cmp_eq_u32 s9, 0
    s_cbranch_scc1 rec_elect_poll
    s_cmp_eq_u32 s9, s8
    s_cselect_b32 s7, s6, -1
rec_elect_pub:
    v_mov_b32 v16, s7
    ds_write_b32 v18, v16
    s_waitcnt lgkmcnt(0)
    s_mov_b64 exec, -1
rec_elect_done:
    s_barrier
    ds_read_b32 v16, v18
    s_waitcnt lgkmcnt(0)
    v_readfirstlane_b32 s2, v16
    s_barrier
    s_cmp_ge_u32 s2, 32
    s_cbranch_scc1 worker_start
    s_lshl_b32 s4, s2, 3
    s_lshl_b32 s5, s3, 1
    s_add_u32 s4, s4, s5
    s_lshl_b32 s4, s4, 14
    s_add_u32 s4, s4, 2097152
    s_add_u32 s6, s4, 0
    buffer_load_dwordx4 a[0:3], v4, s[40:43], s6 offen offset:0
    buffer_load_dwordx4 a[4:7], v4, s[40:43], s6 offen offset:1024
    buffer_load_dwordx4 a[8:11], v4, s[40:43], s6 offen offset:2048
    buffer_load_dwordx4 a[12:15], v4, s[40:43], s6 offen offset:3072
    s_add_u32 s6, s4, 4096
    buffer_load_dwordx4 a[16:19], v4, s[40:43], s6 offen offset:0
    buffer_load_dwordx4 a[20:23], v4, s[40:43], s6 offen offset:1024
    buffer_load_dwordx4 a[24:27], v4, s[40:43], s6 offen offset:2048
    buffer_load_dwordx4 a[28:31], v4, s[40:43], s6 offen offset:3072
    s_add_u32 s6, s4, 8192
    buffer_load_dwordx4 a[32:35], v4, s[40:43], s6 offen offset:0
    buffer_load_dwordx4 a[36:39], v4, s[40:43], s6 offen offset:1024
    buffer_load_dwordx4 a[40:43], v4, s[40:43], s6 offen offset:2048
    buffer_load_dwordx4 a[44:47], v4, s[40:43], s6 offen offset:3072
    s_add_u32 s6, s4, 12288
    buffer_load_dwordx4 a[48:51], v4, s[40:43], s6 offen offset:0
    buffer_load_dwordx4 a[52:55], v4, s[40:43], s6 offen offset:1024
    buffer_load_dwordx4 a[56:59], v4, s[40:43], s6 offen offset:2048
    buffer_load_dwordx4 a[60:63], v4, s[40:43], s6 offen offset:3072
    s_add_u32 s6, s4, 16384
    buffer_load_dwordx4 a[64:67], v4, s[40:43], s6 offen offset:0
    buffer_load_dwordx4 a[68:71], v4, s[40:43], s6 offen offset:1024
    buffer_load_dwordx4 a[72:75], v4, s[40:43], s6 offen offset:2048
    buffer_load_dwordx4 a[76:79], v4, s[40:43], s6 offen offset:3072
    s_add_u32 s6, s4, 20480
    buffer_load_dwordx4 a[80:83], v4, s[40:43], s6 offen offset:0
    buffer_load_dwordx4 a[84:87], v4, s[40:43], s6 offen offset:1024
    buffer_load_dwordx4 a[88:91], v4, s[40:43], s6 offen offset:2048
    buffer_load_dwordx4 a[92:95], v4, s[40:43], s6 offen offset:3072
    s_add_u32 s6, s4, 24576
    buffer_load_dwordx4 a[96:99], v4, s[40:43], s6 offen offset:0
    buffer_load_dwordx4 a[100:103], v4, s[40:43], s6 offen offset:1024
    buffer_load_dwordx4 a[104:107], v4, s[40:43], s6 offen offset:2048
    buffer_load_dwordx4 a[108:111], v4, s[40:43], s6 offen offset:3072
    s_add_u32 s6, s4, 28672
    buffer_load_dwordx4 a[112:115], v4, s[40:43], s6 offen offset:0
    buffer_load_dwordx4 a[116:119], v4, s[40:43], s6 offen offset:1024
    buffer_load_dwordx4 a[120:123], v4, s[40:43], s6 offen offset:2048
    buffer_load_dwordx4 a[124:127], v4, s[40:43], s6 offen offset:3072
    s_add_u32 s6, s4, 4194304
    buffer_load_dwordx4 a[128:131], v4, s[40:43], s6 offen offset:0
    buffer_load_dwordx4 a[132:135], v4, s[40:43], s6 offen offset:1024
    buffer_load_dwordx4 a[136:139], v4, s[40:43], s6 offen offset:2048
    buffer_load_dwordx4 a[140:143], v4, s[40:43], s6 offen offset:3072
    s_add_u32 s6, s4, 4198400
    buffer_load_dwordx4 a[144:147], v4, s[40:43], s6 offen offset:0
    buffer_load_dwordx4 a[148:151], v4, s[40:43], s6 offen offset:1024
    buffer_load_dwordx4 a[152:155], v4, s[40:43], s6 offen offset:2048
    buffer_load_dwordx4 a[156:159], v4, s[40:43], s6 offen offset:3072
    s_add_u32 s6, s4, 4202496
    buffer_load_dwordx4 a[160:163], v4, s[40:43], s6 offen offset:0
    buffer_load_dwordx4 a[164:167], v4, s[40:43], s6 offen offset:1024
    buffer_load_dwordx4 a[168:171], v4, s[40:43], s6 offen offset:2048
    buffer_load_dwordx4 a[172:175], v4, s[40:43], s6 offen offset:3072
    s_add_u32 s6, s4, 4206592
    buffer_load_dwordx4 a[176:179], v4, s[40:43], s6 offen offset:0
    buffer_load_dwordx4 a[180:183], v4, s[40:43], s6 offen offset:1024
    buffer_load_dwordx4 a[184:187], v4, s[40:43], s6 offen offset:2048
    buffer_load_dwordx4 a[188:191], v4, s[40:43], s6 offen offset:3072
    s_add_u32 s6, s4, 4210688
    buffer_load_dwordx4 a[192:195], v4, s[40:43], s6 offen offset:0
    buffer_load_dwordx4 a[196:199], v4, s[40:43], s6 offen offset:1024
    buffer_load_dwordx4 a[200:203], v4, s[40:43], s6 offen offset:2048
    buffer_load_dwordx4 a[204:207], v4, s[40:43], s6 offen offset:3072
    s_add_u32 s6, s4, 4214784
    buffer_load_dwordx4 a[208:211], v4, s[40:43], s6 offen offset:0
    buffer_load_dwordx4 a[212:215], v4, s[40:43], s6 offen offset:1024
    buffer_load_dwordx4 a[216:219], v4, s[40:43], s6 offen offset:2048
    buffer_load_dwordx4 a[220:223], v4, s[40:43], s6 offen offset:3072
    s_add_u32 s6, s4, 4218880
    buffer_load_dwordx4 a[224:227], v4, s[40:43], s6 offen offset:0
    buffer_load_dwordx4 a[228:231], v4, s[40:43], s6 offen offset:1024
    buffer_load_dwordx4 a[232:235], v4, s[40:43], s6 offen offset:2048
    buffer_load_dwordx4 a[236:239], v4, s[40:43], s6 offen offset:3072
    s_add_u32 s6, s4, 4222976
    buffer_load_dwordx4 a[240:243], v4, s[40:43], s6 offen offset:0
    buffer_load_dwordx4 a[244:247], v4, s[40:43], s6 offen offset:1024
    buffer_load_dwordx4 a[248:251], v4, s[40:43], s6 offen offset:2048
    buffer_load_dwordx4 a[252:255], v4, s[40:43], s6 offen offset:3072
    s_lshl_b32 s7, s3, 15
    s_add_u32 s8, s7, 32768
    s_mov_b32 m0, s8
    s_add_u32 s9, s4, 8388608
    buffer_load_dwordx4 v4, s[40:43], s9 offen lds
    s_add_u32 s8, s7, 33792
    s_mov_b32 m0, s8
    s_add_u32 s9, s4, 8389632
    buffer_load_dwordx4 v4, s[40:43], s9 offen lds
    s_add_u32 s8, s7, 34816
    s_mov_b32 m0, s8
    s_add_u32 s9, s4, 8390656
    buffer_load_dwordx4 v4, s[40:43], s9 offen lds
    s_add_u32 s8, s7, 35840
    s_mov_b32 m0, s8
    s_add_u32 s9, s4, 8391680
    buffer_load_dwordx4 v4, s[40:43], s9 offen lds
    s_add_u32 s8, s7, 36864
    s_mov_b32 m0, s8
    s_add_u32 s9, s4, 8392704
    buffer_load_dwordx4 v4, s[40:43], s9 offen lds
    s_add_u32 s8, s7, 37888
    s_mov_b32 m0, s8
    s_add_u32 s9, s4, 8393728
    buffer_load_dwordx4 v4, s[40:43], s9 offen lds
    s_add_u32 s8, s7, 38912
    s_mov_b32 m0, s8
    s_add_u32 s9, s4, 8394752
    buffer_load_dwordx4 v4, s[40:43], s9 offen lds
    s_add_u32 s8, s7, 39936
    s_mov_b32 m0, s8
    s_add_u32 s9, s4, 8395776
    buffer_load_dwordx4 v4, s[40:43], s9 offen lds
    s_add_u32 s8, s7, 40960
    s_mov_b32 m0, s8
    s_add_u32 s9, s4, 8396800
    buffer_load_dwordx4 v4, s[40:43], s9 offen lds
    s_add_u32 s8, s7, 41984
    s_mov_b32 m0, s8
    s_add_u32 s9, s4, 8397824
    buffer_load_dwordx4 v4, s[40:43], s9 offen lds
    s_add_u32 s8, s7, 43008
    s_mov_b32 m0, s8
    s_add_u32 s9, s4, 8398848
    buffer_load_dwordx4 v4, s[40:43], s9 offen lds
    s_add_u32 s8, s7, 44032
    s_mov_b32 m0, s8
    s_add_u32 s9, s4, 8399872
    buffer_load_dwordx4 v4, s[40:43], s9 offen lds
    s_add_u32 s8, s7, 45056
    s_mov_b32 m0, s8
    s_add_u32 s9, s4, 8400896
    buffer_load_dwordx4 v4, s[40:43], s9 offen lds
    s_add_u32 s8, s7, 46080
    s_mov_b32 m0, s8
    s_add_u32 s9, s4, 8401920
    buffer_load_dwordx4 v4, s[40:43], s9 offen lds
    s_add_u32 s8, s7, 47104
    s_mov_b32 m0, s8
    s_add_u32 s9, s4, 8402944
    buffer_load_dwordx4 v4, s[40:43], s9 offen lds
    s_add_u32 s8, s7, 48128
    s_mov_b32 m0, s8
    s_add_u32 s9, s4, 8403968
    buffer_load_dwordx4 v4, s[40:43], s9 offen lds
    s_add_u32 s8, s7, 49152
    s_mov_b32 m0, s8
    s_add_u32 s9, s4, 8404992
    buffer_load_dwordx4 v4, s[40:43], s9 offen lds
    s_add_u32 s8, s7, 50176
    s_mov_b32 m0, s8
    s_add_u32 s9, s4, 8406016
    buffer_load_dwordx4 v4, s[40:43], s9 offen lds
    s_add_u32 s8, s7, 51200
    s_mov_b32 m0, s8
    s_add_u32 s9, s4, 8407040
    buffer_load_dwordx4 v4, s[40:43], s9 offen lds
    s_add_u32 s8, s7, 52224
    s_mov_b32 m0, s8
    s_add_u32 s9, s4, 8408064
    buffer_load_dwordx4 v4, s[40:43], s9 offen lds
    s_add_u32 s8, s7, 53248
    s_mov_b32 m0, s8
    s_add_u32 s9, s4, 8409088
    buffer_load_dwordx4 v4, s[40:43], s9 offen lds
    s_add_u32 s8, s7, 54272
    s_mov_b32 m0, s8
    s_add_u32 s9, s4, 8410112
    buffer_load_dwordx4 v4, s[40:43], s9 offen lds
    s_add_u32 s8, s7, 55296
    s_mov_b32 m0, s8
    s_add_u32 s9, s4, 8411136
    buffer_load_dwordx4 v4, s[40:43], s9 offen lds
    s_add_u32 s8, s7, 56320
    s_mov_b32 m0, s8
    s_add_u32 s9, s4, 8412160
    buffer_load_dwordx4 v4, s[40:43], s9 offen lds
    s_add_u32 s8, s7, 57344
    s_mov_b32 m0, s8
    s_add_u32 s9, s4, 8413184
    buffer_load_dwordx4 v4, s[40:43], s9 offen lds
    s_add_u32 s8, s7, 58368
    s_mov_b32 m0, s8
    s_add_u32 s9, s4, 8414208
    buffer_load_dwordx4 v4, s[40:43], s9 offen lds
    s_add_u32 s8, s7, 59392
    s_mov_b32 m0, s8
    s_add_u32 s9, s4, 8415232
    buffer_load_dwordx4 v4, s[40:43], s9 offen lds
    s_add_u32 s8, s7, 60416
    s_mov_b32 m0, s8
    s_add_u32 s9, s4, 8416256
    buffer_load_dwordx4 v4, s[40:43], s9 offen lds
    s_add_u32 s8, s7, 61440
    s_mov_b32 m0, s8
    s_add_u32 s9, s4, 8417280
    buffer_load_dwordx4 v4, s[40:43], s9 offen lds
    s_add_u32 s8, s7, 62464
    s_mov_b32 m0, s8
    s_add_u32 s9, s4, 8418304
    buffer_load_dwordx4 v4, s[40:43], s9 offen lds
    s_add_u32 s8, s7, 63488
    s_mov_b32 m0, s8
    s_add_u32 s9, s4, 8419328
    buffer_load_dwordx4 v4, s[40:43], s9 offen lds
    s_add_u32 s8, s7, 64512
    s_mov_b32 m0, s8
    s_add_u32 s9, s4, 8420352
    buffer_load_dwordx4 v4, s[40:43], s9 offen lds
    s_lshl_b32 s6, s3, 20
    s_lshl_b32 s7, s2, 12
    s_add_u32 s6, s6, s7
    s_add_u32 s6, s6, 14680064
    buffer_load_dwordx4 v[128:131], v4, s[40:43], s6 offen offset:0
    buffer_load_dwordx4 v[132:135], v4, s[40:43], s6 offen offset:1024
    buffer_load_dwordx4 v[136:139], v4, s[40:43], s6 offen offset:2048
    buffer_load_dwordx4 v[140:143], v4, s[40:43], s6 offen offset:3072
    s_add_u32 s6, s6, 131072
    buffer_load_dwordx4 v[144:147], v4, s[40:43], s6 offen offset:0
    buffer_load_dwordx4 v[148:151], v4, s[40:43], s6 offen offset:1024
    buffer_load_dwordx4 v[152:155], v4, s[40:43], s6 offen offset:2048
    buffer_load_dwordx4 v[156:159], v4, s[40:43], s6 offen offset:3072
    s_add_u32 s6, s6, 131072
    buffer_load_dwordx4 v[160:163], v4, s[40:43], s6 offen offset:0
    buffer_load_dwordx4 v[164:167], v4, s[40:43], s6 offen offset:1024
    buffer_load_dwordx4 v[168:171], v4, s[40:43], s6 offen offset:2048
    buffer_load_dwordx4 v[172:175], v4, s[40:43], s6 offen offset:3072
    s_add_u32 s6, s6, 131072
    buffer_load_dwordx4 v[176:179], v4, s[40:43], s6 offen offset:0
    buffer_load_dwordx4 v[180:183], v4, s[40:43], s6 offen offset:1024
    buffer_load_dwordx4 v[184:187], v4, s[40:43], s6 offen offset:2048
    buffer_load_dwordx4 v[188:191], v4, s[40:43], s6 offen offset:3072
    s_add_u32 s6, s6, 131072
    buffer_load_dwordx4 v[192:195], v4, s[40:43], s6 offen offset:0
    buffer_load_dwordx4 v[196:199], v4, s[40:43], s6 offen offset:1024
    buffer_load_dwordx4 v[200:203], v4, s[40:43], s6 offen offset:2048
    buffer_load_dwordx4 v[204:207], v4, s[40:43], s6 offen offset:3072
    s_add_u32 s6, s6, 131072
    buffer_load_dwordx4 v[208:211], v4, s[40:43], s6 offen offset:0
    buffer_load_dwordx4 v[212:215], v4, s[40:43], s6 offen offset:1024
    buffer_load_dwordx4 v[216:219], v4, s[40:43], s6 offen offset:2048
    buffer_load_dwordx4 v[220:223], v4, s[40:43], s6 offen offset:3072
    s_add_u32 s6, s6, 131072
    buffer_load_dwordx4 v[224:227], v4, s[40:43], s6 offen offset:0
    buffer_load_dwordx4 v[228:231], v4, s[40:43], s6 offen offset:1024
    buffer_load_dwordx4 v[232:235], v4, s[40:43], s6 offen offset:2048
    buffer_load_dwordx4 v[236:239], v4, s[40:43], s6 offen offset:3072
    s_add_u32 s6, s6, 131072
    buffer_load_dwordx4 v[240:243], v4, s[40:43], s6 offen offset:0
    buffer_load_dwordx4 v[244:247], v4, s[40:43], s6 offen offset:1024
    buffer_load_dwordx4 v[248:251], v4, s[40:43], s6 offen offset:2048
    buffer_load_dwordx4 v[252:255], v4, s[40:43], s6 offen offset:3072
    v_mov_b32 v16, 0
    v_mov_b32 v17, 0
    v_mov_b32 v18, 0
    v_mov_b32 v19, 0
    s_lshl_b32 s8, s3, 12
    v_add_u32 v5, s8, v4
    ds_write_b128 v5, v[16:19] offset:16384
    ds_write_b128 v5, v[16:19] offset:17408
    ds_write_b128 v5, v[16:19] offset:18432
    ds_write_b128 v5, v[16:19] offset:19456
    v_mul_u32_u24 v9, 48, v1
    ds_write_b128 v9, v[16:19] offset:0
    ds_write_b128 v9, v[16:19] offset:16
    ds_write_b128 v9, v[16:19] offset:32
    ds_write_b128 v9, v[16:19] offset:3072
    ds_write_b128 v9, v[16:19] offset:3088
    ds_write_b128 v9, v[16:19] offset:3104
    v_lshlrev_b32 v7, 10, v3
    v_lshl_add_u32 v7, v2, 4, v7
    s_lshl_b32 s8, s3, 15
    s_add_u32 s8, s8, 32768
    v_add_u32 v8, s8, v4
    v_mul_u32_u24 v9, 48, v1
    s_mul_i32 s8, s3, 3072
    v_add_u32 v10, s8, v9
    s_lshl_b32 s8, s3, 10
    v_add_u32 v11, s8, v4
    v_lshlrev_b32 v12, 6, v3
    v_lshl_add_u32 v12, v2, 4, v12
    v_and_b32 v13, 7, v3
    v_lshrrev_b32 v14, 3, v3
    s_lshl_b32 s8, s3, 12
    v_add_u32 v15, s8, v4
    v_lshl_add_u32 v13, v2, 4, v13
    v_lshlrev_b32 v13, 4, v13
    v_lshl_add_u32 v13, v14, 10, v13
    s_lshl_b32 s8, s3, 12
    v_add_u32 v13, s8, v13
    v_lshrrev_b32 v14, 2, v1
    v_lshlrev_b32 v14, 4, v14
    v_and_b32 v0, 1, v1
    v_lshl_add_u32 v14, v0, 10, v14
    v_bfe_u32 v0, v1, 1, 1
    v_lshl_add_u32 v14, v0, 8, v14
    s_lshr_b32 s8, s2, 3
    s_lshl_b32 s32, s8, 12
    s_bfe_u32 s8, s2, 0x10002
    s_lshl_b32 s8, s8, 11
    s_add_u32 s32, s32, s8
    s_bfe_u32 s8, s2, 0x10001
    s_lshl_b32 s8, s8, 7
    s_add_u32 s32, s32, s8
    s_and_b32 s8, s2, 1
    s_lshl_b32 s8, s8, 9
    s_add_u32 s32, s32, s8
    s_add_u32 s32, s32, 131072000
    s_mov_b32 s20, 0
    s_mov_b32 s33, 0
    s_lshl_b32 s21, s2, 13
    s_mov_b32 s30, 0xffffff00
    s_mov_b32 s31, 0x07060302
    s_waitcnt vmcnt(0) lgkmcnt(0)
    s_barrier
rec_loop:
    s_lshl_b32 s8, s20, 18
    s_add_u32 s8, s8, s21
    s_lshl_b32 s9, s3, 11
    s_add_u32 s8, s8, s9
    ds_read_b128 v[48:51], v8 offset:0
    ds_read_b128 v[52:55], v8 offset:1024
    ds_read_b128 v[56:59], v8 offset:2048
    ds_read_b128 v[60:63], v8 offset:3072
    s_cmp_eq_u32 s20, 0
    s_cbranch_scc0 rec_poll_ag
    s_add_u32 s80, s20, 1
    s_lshl_b32 s80, s80, 6
    s_add_u32 s80, s80, 132120576
    v_mov_b32 v97, 0
    s_mov_b32 s82, 0
wc_1:
    buffer_load_dword v96, v97, s[40:43], s80 offen sc1
    s_add_u32 s82, s82, 1
    s_waitcnt vmcnt(0)
    v_readfirstlane_b32 s81, v96
    s_cmp_ge_u32 s81, 32
    s_cbranch_scc1 wc_1_ok
    s_cmp_gt_u32 s82, 0x400000
    s_cbranch_scc1 rec_end2
    s_sleep 2
    s_branch wc_1
wc_1_ok:
    s_add_u32 s9, s8, 41943040
    buffer_load_dwordx4 v[16:19], v4, s[40:43], s9 offen sc1
    buffer_load_dwordx4 v[20:23], v4, s[40:43], s9 offen offset:1024 sc1
    s_add_u32 s9, s8, 58720256
    buffer_load_dwordx4 v[24:27], v4, s[40:43], s9 offen sc1
    buffer_load_dwordx4 v[28:31], v4, s[40:43], s9 offen offset:1024 sc1
    buffer_load_dwordx4 v[64:67], v7, s[44:47], 0 offen offset:0
    buffer_load_dwordx4 v[68:71], v7, s[44:47], 0 offen offset:64
    buffer_load_dwordx4 v[72:75], v7, s[44:47], 0 offen offset:128
    buffer_load_dwordx4 v[76:79], v7, s[44:47], 0 offen offset:192
    buffer_load_dwordx4 v[80:83], v7, s[44:47], 0 offen offset:256
    buffer_load_dwordx4 v[84:87], v7, s[44:47], 0 offen offset:320
    buffer_load_dwordx4 v[88:91], v7, s[44:47], 0 offen offset:384
    buffer_load_dwordx4 v[92:95], v7, s[44:47], 0 offen offset:448
    buffer_load_dwordx4 v[96:99], v7, s[44:47], 0 offen offset:512
    buffer_load_dwordx4 v[100:103], v7, s[44:47], 0 offen offset:576
    buffer_load_dwordx4 v[104:107], v7, s[44:47], 0 offen offset:640
    buffer_load_dwordx4 v[108:111], v7, s[44:47], 0 offen offset:704
    buffer_load_dwordx4 v[112:115], v7, s[44:47], 0 offen offset:768
    buffer_load_dwordx4 v[116:119], v7, s[44:47], 0 offen offset:832
    buffer_load_dwordx4 v[120:123], v7, s[44:47], 0 offen offset:896
    buffer_load_dwordx4 v[124:127], v7, s[44:47], 0 offen offset:960
    s_waitcnt vmcnt(0)
    s_branch rec_mem_done
rec_poll_ag:
    s_mov_b32 s10, 0
    s_mov_b32 s9, 131072000
rec_poll_ag_l:
    buffer_load_dwordx4 v[96:99], v15, s[40:43], s9 offen sc1
    buffer_load_dwordx4 v[100:103], v15, s[40:43], s9 offen offset:1024 sc1
    buffer_load_dwordx4 v[104:107], v15, s[40:43], s9 offen offset:2048 sc1
    buffer_load_dwordx4 v[108:111], v15, s[40:43], s9 offen offset:3072 sc1
    s_add_u32 s10, s10, 1
    s_waitcnt vmcnt(0)
    v_xor_b32 v112, s20, v96
    v_xor_b32 v113, s20, v97
    v_xor_b32 v114, s20, v98
    v_xor_b32 v115, s20, v99
    v_xor_b32 v116, s20, v100
    v_xor_b32 v117, s20, v101
    v_xor_b32 v118, s20, v102
    v_xor_b32 v119, s20, v103
    v_xor_b32 v120, s20, v104
    v_xor_b32 v121, s20, v105
    v_xor_b32 v122, s20, v106
    v_xor_b32 v123, s20, v107
    v_xor_b32 v124, s20, v108
    v_xor_b32 v125, s20, v109
    v_xor_b32 v126, s20, v110
    v_xor_b32 v127, s20, v111
    v_or3_b32 v112, v112, v113, v114
    v_or3_b32 v115, v115, v116, v117
    v_or3_b32 v118, v118, v119, v120
    v_or3_b32 v121, v121, v122, v123
    v_or3_b32 v124, v124, v125, v126
    v_or3_b32 v112, v112, v115, v118
    v_or3_b32 v121, v121, v124, v127
    v_or_b32 v112, v112, v121
    v_and_b32 v112, 0xffff, v112
    v_cmp_eq_u32 vcc, 0, v112
    s_cmp_gt_u32 s10, 0x200000
    s_cbranch_scc1 rec_end2
    s_cmp_eq_u64 vcc, exec
    s_cbranch_scc0 rec_poll_ag_l
    v_perm_b32 v112, v97, v96, s31
    v_perm_b32 v113, v99, v98, s31
    v_perm_b32 v114, v101, v100, s31
    v_perm_b32 v115, v103, v102, s31
    v_perm_b32 v116, v105, v104, s31
    v_perm_b32 v117, v107, v106, s31
    v_perm_b32 v118, v109, v108, s31
    v_perm_b32 v119, v111, v110, s31
    ds_write_b128 v13, v[112:115] offset:16384
    ds_write_b128 v13, v[116:119] offset:18432
    s_waitcnt lgkmcnt(0)
    s_barrier
    ds_read_b128 v[64:67], v4 offset:16384
    ds_read_b128 v[68:71], v4 offset:17408
    ds_read_b128 v[72:75], v4 offset:18432
    ds_read_b128 v[76:79], v4 offset:19456
    ds_read_b128 v[80:83], v4 offset:20480
    ds_read_b128 v[84:87], v4 offset:21504
    ds_read_b128 v[88:91], v4 offset:22528
    ds_read_b128 v[92:95], v4 offset:23552
    ds_read_b128 v[96:99], v4 offset:24576
    ds_read_b128 v[100:103], v4 offset:25600
    ds_read_b128 v[104:107], v4 offset:26624
    ds_read_b128 v[108:111], v4 offset:27648
    ds_read_b128 v[112:115], v4 offset:28672
    ds_read_b128 v[116:119], v4 offset:29696
    ds_read_b128 v[120:123], v4 offset:30720
    ds_read_b128 v[124:127], v4 offset:31744
rec_mem_done:
    s_waitcnt lgkmcnt(15)
    v_mfma_f32_16x16x32_bf16 v[32:35], v[64:67], v[48:51], 0
    ds_read_b128 v[48:51], v8 offset:4096
    s_waitcnt lgkmcnt(15)
    v_mfma_f32_16x16x32_bf16 v[32:35], v[68:71], v[52:55], v[32:35]
    ds_read_b128 v[52:55], v8 offset:5120
    s_waitcnt lgkmcnt(15)
    v_mfma_f32_16x16x32_bf16 v[32:35], v[72:75], v[56:59], v[32:35]
    ds_read_b128 v[56:59], v8 offset:6144
    s_waitcnt lgkmcnt(15)
    v_mfma_f32_16x16x32_bf16 v[32:35], v[76:79], v[60:63], v[32:35]
    ds_read_b128 v[60:63], v8 offset:7168
    s_waitcnt lgkmcnt(3)
    v_mfma_f32_16x16x32_bf16 v[32:35], v[80:83], v[48:51], v[32:35]
    ds_read_b128 v[48:51], v8 offset:8192
    s_waitcnt lgkmcnt(3)
    v_mfma_f32_16x16x32_bf16 v[32:35], v[84:87], v[52:55], v[32:35]
    ds_read_b128 v[52:55], v8 offset:9216
    s_waitcnt lgkmcnt(3)
    v_mfma_f32_16x16x32_bf16 v[32:35], v[88:91], v[56:59], v[32:35]
    ds_read_b128 v[56:59], v8 offset:10240
    s_waitcnt lgkmcnt(3)
    v_mfma_f32_16x16x32_bf16 v[32:35], v[92:95], v[60:63], v[32:35]
    ds_read_b128 v[60:63], v8 offset:11264
    s_waitcnt lgkmcnt(3)
    v_mfma_f32_16x16x32_bf16 v[32:35], v[96:99], v[48:51], v[32:35]
    ds_read_b128 v[48:51], v8 offset:12288
    s_waitcnt lgkmcnt(3)
    v_mfma_f32_16x16x32_bf16 v[32:35], v[100:103], v[52:55], v[32:35]
    ds_read_b128 v[52:55], v8 offset:13312
    s_waitcnt lgkmcnt(3)
    v_mfma_f32_16x16x32_bf16 v[32:35], v[104:107], v[56:59], v[32:35]
    ds_read_b128 v[56:59], v8 offset:14336
    s_waitcnt lgkmcnt(3)
    v_mfma_f32_16x16x32_bf16 v[32:35], v[108:111], v[60:63], v[32:35]
    ds_read_b128 v[60:63], v8 offset:15360
    s_waitcnt lgkmcnt(3)
    v_mfma_f32_16x16x32_bf16 v[32:35], v[112:115], v[48:51], v[32:35]
    ds_read_b128 v[48:51], v8 offset:16384
    s_waitcnt lgkmcnt(3)
    v_mfma_f32_16x16x32_bf16 v[32:35], v[116:119], v[52:55], v[32:35]
    ds_read_b128 v[52:55], v8 offset:17408
    s_waitcnt lgkmcnt(3)
    v_mfma_f32_16x16x32_bf16 v[32:35], v[120:123], v[56:59], v[32:35]
    ds_read_b128 v[56:59], v8 offset:18432
    s_waitcnt lgkmcnt(3)
    v_mfma_f32_16x16x32_bf16 v[32:35], v[124:127], v[60:63], v[32:35]
    ds_read_b128 v[60:63], v8 offset:19456
    s_waitcnt lgkmcnt(3)
    v_mfma_f32_16x16x32_bf16 v[36:39], v[64:67], v[48:51], 0
    ds_read_b128 v[48:51], v8 offset:20480
    s_waitcnt lgkmcnt(3)
    v_mfma_f32_16x16x32_bf16 v[36:39], v[68:71], v[52:55], v[36:39]
    ds_read_b128 v[52:55], v8 offset:21504
    s_waitcnt lgkmcnt(3)
    v_mfma_f32_16x16x32_bf16 v[36:39], v[72:75], v[56:59], v[36:39]
    ds_read_b128 v[56:59], v8 offset:22528
    s_waitcnt lgkmcnt(3)
    v_mfma_f32_16x16x32_bf16 v[36:39], v[76:79], v[60:63], v[36:39]
    ds_read_b128 v[60:63], v8 offset:23552
    s_waitcnt lgkmcnt(3)
    v_mfma_f32_16x16x32_bf16 v[36:39], v[80:83], v[48:51], v[36:39]
    ds_read_b128 v[48:51], v8 offset:24576
    s_waitcnt lgkmcnt(3)
    v_mfma_f32_16x16x32_bf16 v[36:39], v[84:87], v[52:55], v[36:39]
    ds_read_b128 v[52:55], v8 offset:25600
    s_waitcnt lgkmcnt(3)
    v_mfma_f32_16x16x32_bf16 v[36:39], v[88:91], v[56:59], v[36:39]
    ds_read_b128 v[56:59], v8 offset:26624
    s_waitcnt lgkmcnt(3)
    v_mfma_f32_16x16x32_bf16 v[36:39], v[92:95], v[60:63], v[36:39]
    ds_read_b128 v[60:63], v8 offset:27648
    s_waitcnt lgkmcnt(3)
    v_mfma_f32_16x16x32_bf16 v[36:39], v[96:99], v[48:51], v[36:39]
    ds_read_b128 v[48:51], v8 offset:28672
    s_waitcnt lgkmcnt(3)
    v_mfma_f32_16x16x32_bf16 v[36:39], v[100:103], v[52:55], v[36:39]
    ds_read_b128 v[52:55], v8 offset:29696
    s_waitcnt lgkmcnt(3)
    v_mfma_f32_16x16x32_bf16 v[36:39], v[104:107], v[56:59], v[36:39]
    ds_read_b128 v[56:59], v8 offset:30720
    s_waitcnt lgkmcnt(3)
    v_mfma_f32_16x16x32_bf16 v[36:39], v[108:111], v[60:63], v[36:39]
    ds_read_b128 v[60:63], v8 offset:31744
    s_waitcnt lgkmcnt(3)
    v_mfma_f32_16x16x32_bf16 v[36:39], v[112:115], v[48:51], v[36:39]
    s_waitcnt lgkmcnt(2)
    v_mfma_f32_16x16x32_bf16 v[36:39], v[116:119], v[52:55], v[36:39]
    s_waitcnt lgkmcnt(1)
    v_mfma_f32_16x16x32_bf16 v[36:39], v[120:123], v[56:59], v[36:39]
    s_waitcnt lgkmcnt(0)
    v_mfma_f32_16x16x32_bf16 v[36:39], v[124:127], v[60:63], v[36:39]
    v_mfma_f32_16x16x32_bf16 v[48:51], a[0:3], v[64:67], 0
    v_mfma_f32_16x16x32_bf16 v[52:55], a[64:67], v[64:67], 0
    v_mfma_f32_16x16x32_bf16 v[56:59], a[128:131], v[64:67], 0
    v_mfma_f32_16x16x32_bf16 v[60:63], a[192:195], v[64:67], 0
    v_mfma_f32_16x16x32_bf16 v[48:51], a[4:7], v[68:71], v[48:51]
    v_mfma_f32_16x16x32_bf16 v[52:55], a[68:71], v[68:71], v[52:55]
    v_mfma_f32_16x16x32_bf16 v[56:59], a[132:135], v[68:71], v[56:59]
    v_mfma_f32_16x16x32_bf16 v[60:63], a[196:199], v[68:71], v[60:63]
    v_mfma_f32_16x16x32_bf16 v[48:51], a[8:11], v[72:75], v[48:51]
    v_mfma_f32_16x16x32_bf16 v[52:55], a[72:75], v[72:75], v[52:55]
    v_mfma_f32_16x16x32_bf16 v[56:59], a[136:139], v[72:75], v[56:59]
    v_mfma_f32_16x16x32_bf16 v[60:63], a[200:203], v[72:75], v[60:63]
    v_mfma_f32_16x16x32_bf16 v[48:51], a[12:15], v[76:79], v[48:51]
    v_mfma_f32_16x16x32_bf16 v[52:55], a[76:79], v[76:79], v[52:55]
    v_mfma_f32_16x16x32_bf16 v[56:59], a[140:143], v[76:79], v[56:59]
    v_mfma_f32_16x16x32_bf16 v[60:63], a[204:207], v[76:79], v[60:63]
    v_mfma_f32_16x16x32_bf16 v[48:51], a[16:19], v[80:83], v[48:51]
    v_mfma_f32_16x16x32_bf16 v[52:55], a[80:83], v[80:83], v[52:55]
    v_mfma_f32_16x16x32_bf16 v[56:59], a[144:147], v[80:83], v[56:59]
    v_mfma_f32_16x16x32_bf16 v[60:63], a[208:211], v[80:83], v[60:63]
    v_mfma_f32_16x16x32_bf16 v[48:51], a[20:23], v[84:87], v[48:51]
    v_mfma_f32_16x16x32_bf16 v[52:55], a[84:87], v[84:87], v[52:55]
    v_mfma_f32_16x16x32_bf16 v[56:59], a[148:151], v[84:87], v[56:59]
    v_mfma_f32_16x16x32_bf16 v[60:63], a[212:215], v[84:87], v[60:63]
    v_mfma_f32_16x16x32_bf16 v[48:51], a[24:27], v[88:91], v[48:51]
    v_mfma_f32_16x16x32_bf16 v[52:55], a[88:91], v[88:91], v[52:55]
    v_mfma_f32_16x16x32_bf16 v[56:59], a[152:155], v[88:91], v[56:59]
    v_mfma_f32_16x16x32_bf16 v[60:63], a[216:219], v[88:91], v[60:63]
    v_mfma_f32_16x16x32_bf16 v[48:51], a[28:31], v[92:95], v[48:51]
    v_mfma_f32_16x16x32_bf16 v[52:55], a[92:95], v[92:95], v[52:55]
    v_mfma_f32_16x16x32_bf16 v[56:59], a[156:159], v[92:95], v[56:59]
    v_mfma_f32_16x16x32_bf16 v[60:63], a[220:223], v[92:95], v[60:63]
    v_mfma_f32_16x16x32_bf16 v[48:51], a[32:35], v[96:99], v[48:51]
    v_mfma_f32_16x16x32_bf16 v[52:55], a[96:99], v[96:99], v[52:55]
    v_mfma_f32_16x16x32_bf16 v[56:59], a[160:163], v[96:99], v[56:59]
    v_mfma_f32_16x16x32_bf16 v[60:63], a[224:227], v[96:99], v[60:63]
    v_mfma_f32_16x16x32_bf16 v[48:51], a[36:39], v[100:103], v[48:51]
    v_mfma_f32_16x16x32_bf16 v[52:55], a[100:103], v[100:103], v[52:55]
    v_mfma_f32_16x16x32_bf16 v[56:59], a[164:167], v[100:103], v[56:59]
    v_mfma_f32_16x16x32_bf16 v[60:63], a[228:231], v[100:103], v[60:63]
    v_mfma_f32_16x16x32_bf16 v[48:51], a[40:43], v[104:107], v[48:51]
    v_mfma_f32_16x16x32_bf16 v[52:55], a[104:107], v[104:107], v[52:55]
    v_mfma_f32_16x16x32_bf16 v[56:59], a[168:171], v[104:107], v[56:59]
    v_mfma_f32_16x16x32_bf16 v[60:63], a[232:235], v[104:107], v[60:63]
    v_mfma_f32_16x16x32_bf16 v[48:51], a[44:47], v[108:111], v[48:51]
    v_mfma_f32_16x16x32_bf16 v[52:55], a[108:111], v[108:111], v[52:55]
    v_mfma_f32_16x16x32_bf16 v[56:59], a[172:175], v[108:111], v[56:59]
    v_mfma_f32_16x16x32_bf16 v[60:63], a[236:239], v[108:111], v[60:63]
    v_mfma_f32_16x16x32_bf16 v[48:51], a[48:51], v[112:115], v[48:51]
    v_mfma_f32_16x16x32_bf16 v[52:55], a[112:115], v[112:115], v[52:55]
    v_mfma_f32_16x16x32_bf16 v[56:59], a[176:179], v[112:115], v[56:59]
    v_mfma_f32_16x16x32_bf16 v[60:63], a[240:243], v[112:115], v[60:63]
    v_mfma_f32_16x16x32_bf16 v[48:51], a[52:55], v[116:119], v[48:51]
    v_mfma_f32_16x16x32_bf16 v[52:55], a[116:119], v[116:119], v[52:55]
    v_mfma_f32_16x16x32_bf16 v[56:59], a[180:183], v[116:119], v[56:59]
    v_mfma_f32_16x16x32_bf16 v[60:63], a[244:247], v[116:119], v[60:63]
    v_mfma_f32_16x16x32_bf16 v[48:51], a[56:59], v[120:123], v[48:51]
    v_mfma_f32_16x16x32_bf16 v[52:55], a[120:123], v[120:123], v[52:55]
    v_mfma_f32_16x16x32_bf16 v[56:59], a[184:187], v[120:123], v[56:59]
    v_mfma_f32_16x16x32_bf16 v[60:63], a[248:251], v[120:123], v[60:63]
    v_mfma_f32_16x16x32_bf16 v[48:51], a[60:63], v[124:127], v[48:51]
    v_mfma_f32_16x16x32_bf16 v[52:55], a[124:127], v[124:127], v[52:55]
    v_mfma_f32_16x16x32_bf16 v[56:59], a[188:191], v[124:127], v[56:59]
    v_mfma_f32_16x16x32_bf16 v[60:63], a[252:255], v[124:127], v[60:63]
    v_cvt_pk_bf16_f32 v40, v32, v33
    v_cvt_pk_bf16_f32 v41, v34, v35
    v_mov_b32 v42, 0
    v_mov_b32 v43, 0
    v_cvt_pk_bf16_f32 v44, v36, v37
    v_cvt_pk_bf16_f32 v45, v38, v39
    v_mov_b32 v46, 0
    v_mov_b32 v47, 0
    s_add_u32 s9, s8, 83886080
    buffer_store_dwordx4 v[40:43], v4, s[40:43], s9 offen sc0 sc1
    buffer_store_dwordx4 v[44:47], v4, s[40:43], s9 offen offset:1024 sc0 sc1
    v_cvt_pk_bf16_f32 v32, v48, v49
    v_cvt_pk_bf16_f32 v33, v50, v51
    v_cvt_pk_bf16_f32 v34, v52, v53
    v_cvt_pk_bf16_f32 v35, v54, v55
    v_cvt_pk_bf16_f32 v36, v56, v57
    v_cvt_pk_bf16_f32 v37, v58, v59
    v_cvt_pk_bf16_f32 v38, v60, v61
    v_cvt_pk_bf16_f32 v39, v62, v63
    s_lshl_b32 s9, s20, 17
    s_lshl_b32 s11, s2, 12
    s_add_u32 s9, s9, s11
    s_lshl_b32 s11, s3, 10
    s_add_u32 s9, s9, s11
    s_add_u32 s9, s9, 75497472
    s_waitcnt vmcnt(4)
    v_mfma_f32_16x16x32_bf16 v[48:51], v[16:19], v[32:35], 0
    v_mfma_f32_16x16x32_bf16 v[52:55], v[20:23], v[32:35], 0
    v_mfma_f32_16x16x32_bf16 v[56:59], v[36:39], v[32:35], 0
    buffer_store_dwordx4 v[36:39], v4, s[40:43], s9 offen sc0 sc1
    s_nop 6
    ds_write_b128 v10, v[48:51] offset:0
    ds_write_b128 v10, v[52:55] offset:16
    ds_write_b128 v10, v[56:59] offset:32
    s_waitcnt lgkmcnt(0)
    s_barrier
    ds_read_b128 v[64:67], v9 offset:0
    ds_read_b128 v[68:71], v9 offset:16
    ds_read_b128 v[72:75], v9 offset:32
    ds_read_b128 v[76:79], v9 offset:3072
    ds_read_b128 v[80:83], v9 offset:3088
    ds_read_b128 v[84:87], v9 offset:3104
    ds_read_b128 v[88:91], v9 offset:6144
    ds_read_b128 v[92:95], v9 offset:6160
    ds_read_b128 v[96:99], v9 offset:6176
    ds_read_b128 v[100:103], v9 offset:9216
    ds_read_b128 v[104:107], v9 offset:9232
    ds_read_b128 v[108:111], v9 offset:9248
    s_mov_b32 s16, 0x3db504f3
    s_mov_b32 s17, 0x3db504f3
    s_waitcnt lgkmcnt(6)
    v_pk_add_f32 v[64:65], v[64:65], v[76:77]
    v_pk_add_f32 v[66:67], v[66:67], v[78:79]
    v_pk_add_f32 v[68:69], v[68:69], v[80:81]
    v_pk_add_f32 v[70:71], v[70:71], v[82:83]
    v_pk_add_f32 v[72:73], v[72:73], v[84:85]
    v_pk_add_f32 v[74:75], v[74:75], v[86:87]
    s_waitcnt lgkmcnt(0)
    v_pk_add_f32 v[88:89], v[88:89], v[100:101]
    v_pk_add_f32 v[90:91], v[90:91], v[102:103]
    v_pk_add_f32 v[92:93], v[92:93], v[104:105]
    v_pk_add_f32 v[94:95], v[94:95], v[106:107]
    v_pk_add_f32 v[96:97], v[96:97], v[108:109]
    v_pk_add_f32 v[98:99], v[98:99], v[110:111]
    v_pk_add_f32 v[64:65], v[64:65], v[88:89]
    v_pk_add_f32 v[66:67], v[66:67], v[90:91]
    v_pk_add_f32 v[68:69], v[68:69], v[92:93]
    v_pk_add_f32 v[70:71], v[70:71], v[94:95]
    v_pk_add_f32 v[72:73], v[72:73], v[96:97]
    v_pk_add_f32 v[74:75], v[74:75], v[98:99]
    v_cvt_pk_bf16_f32 v76, v64, v65
    v_cvt_pk_bf16_f32 v77, v66, v67
    v_cvt_pk_bf16_f32 v78, v68, v69
    v_cvt_pk_bf16_f32 v79, v70, v71
    v_cvt_pk_bf16_f32 v80, v72, v73
    v_cvt_pk_bf16_f32 v81, v74, v75
    v_lshlrev_b32 v64, 16, v76
    v_and_b32 v65, 0xffff0000, v76
    v_lshlrev_b32 v66, 16, v77
    v_and_b32 v67, 0xffff0000, v77
    v_lshlrev_b32 v68, 16, v78
    v_and_b32 v69, 0xffff0000, v78
    v_lshlrev_b32 v70, 16, v79
    v_and_b32 v71, 0xffff0000, v79
    v_lshlrev_b32 v72, 16, v80
    v_and_b32 v73, 0xffff0000, v80
    v_lshlrev_b32 v74, 16, v81
    v_and_b32 v75, 0xffff0000, v81
    v_pk_mul_f32 v[64:65], v[64:65], s[16:17]
    v_pk_mul_f32 v[66:67], v[66:67], s[16:17]
    v_pk_mul_f32 v[68:69], v[68:69], s[16:17]
    v_pk_mul_f32 v[70:71], v[70:71], s[16:17]
    v_pk_mul_f32 v[72:73], v[72:73], s[16:17]
    v_pk_mul_f32 v[74:75], v[74:75], s[16:17]
    v_cvt_pk_bf16_f32 v76, v64, v65
    v_cvt_pk_bf16_f32 v77, v66, v67
    v_cvt_pk_bf16_f32 v78, v68, v69
    v_cvt_pk_bf16_f32 v79, v70, v71
    v_cvt_pk_bf16_f32 v80, v72, v73
    v_cvt_pk_bf16_f32 v81, v74, v75
    v_lshlrev_b32 v64, 16, v76
    v_and_b32 v65, 0xffff0000, v76
    v_lshlrev_b32 v66, 16, v77
    v_and_b32 v67, 0xffff0000, v77
    v_lshlrev_b32 v68, 16, v78
    v_and_b32 v69, 0xffff0000, v78
    v_lshlrev_b32 v70, 16, v79
    v_and_b32 v71, 0xffff0000, v79
    v_lshlrev_b32 v72, 16, v80
    v_and_b32 v73, 0xffff0000, v80
    v_lshlrev_b32 v74, 16, v81
    v_and_b32 v75, 0xffff0000, v81
    v_mov_b32 v80, 0xce6e6b28
    v_cmp_gt_u32 vcc, 2, v2
    s_nop 1
    v_cndmask_b32 v72, v80, v72, vcc
    v_cndmask_b32 v73, v80, v73, vcc
    v_cndmask_b32 v74, v80, v74, vcc
    v_cndmask_b32 v75, v80, v75, vcc
    v_max3_f32 v80, v64, v65, v66
    v_max3_f32 v81, v67, v68, v69
    v_max3_f32 v82, v70, v71, v72
    v_max3_f32 v83, v73, v74, v75
    v_max3_f32 v80, v80, v81, v82
    v_max_f32 v80, v80, v83
    v_mov_b32 v83, v80
    v_mov_b32 v84, v80
    s_nop 1
    v_permlane32_swap_b32 v83, v84
    s_nop 1
    v_max_f32 v80, v83, v84
    v_mov_b32 v83, v80
    v_mov_b32 v84, v80
    s_nop 1
    v_permlane16_swap_b32 v83, v84
    s_nop 1
    v_max_f32 v80, v83, v84
    v_mul_f32 v81, 0xbfb8aa3b, v80
    s_mov_b32 s16, 0x3fb8aa3b
    v_fma_f32 v64, v64, s16, v81
    v_fma_f32 v65, v65, s16, v81
    v_fma_f32 v66, v66, s16, v81
    v_fma_f32 v67, v67, s16, v81
    v_fma_f32 v68, v68, s16, v81
    v_fma_f32 v69, v69, s16, v81
    v_fma_f32 v70, v70, s16, v81
    v_fma_f32 v71, v71, s16, v81
    v_fma_f32 v72, v72, s16, v81
    v_fma_f32 v73, v73, s16, v81
    v_fma_f32 v74, v74, s16, v81
    v_fma_f32 v75, v75, s16, v81
    v_exp_f32 v64, v64
    v_exp_f32 v65, v65
    v_exp_f32 v66, v66
    v_exp_f32 v67, v67
    v_exp_f32 v68, v68
    v_exp_f32 v69, v69
    v_exp_f32 v70, v70
    v_exp_f32 v71, v71
    v_exp_f32 v72, v72
    v_exp_f32 v73, v73
    v_exp_f32 v74, v74
    v_exp_f32 v75, v75
    s_nop 0
    v_pk_add_f32 v[76:77], v[64:65], v[66:67]
    v_pk_add_f32 v[78:79], v[68:69], v[70:71]
    v_pk_add_f32 v[82:83], v[72:73], v[74:75]
    v_pk_add_f32 v[76:77], v[76:77], v[78:79]
    v_pk_add_f32 v[76:77], v[76:77], v[82:83]
    v_add_f32 v82, v76, v77
    v_mov_b32 v83, v82
    v_mov_b32 v84, v82
    s_nop 1
    v_permlane32_swap_b32 v83, v84
    s_nop 1
    v_add_f32 v82, v83, v84
    v_mov_b32 v83, v82
    v_mov_b32 v84, v82
    s_nop 1
    v_permlane16_swap_b32 v83, v84
    s_nop 1
    v_add_f32 v82, v83, v84
    v_rcp_f32 v80, v82
    s_nop 0
    v_fma_f32 v81, -v82, v80, 2.0
    v_mul_f32 v80, v80, v81
    v_mov_b32 v81, v80
    v_pk_mul_f32 v[64:65], v[64:65], v[80:81]
    v_pk_mul_f32 v[66:67], v[66:67], v[80:81]
    v_pk_mul_f32 v[68:69], v[68:69], v[80:81]
    v_pk_mul_f32 v[70:71], v[70:71], v[80:81]
    v_pk_mul_f32 v[72:73], v[72:73], v[80:81]
    v_pk_mul_f32 v[74:75], v[74:75], v[80:81]
    v_cvt_pk_bf16_f32 v88, v64, v65
    v_cvt_pk_bf16_f32 v89, v66, v67
    v_cvt_pk_bf16_f32 v90, v68, v69
    v_cvt_pk_bf16_f32 v91, v70, v71
    v_cvt_pk_bf16_f32 v92, v72, v73
    v_cvt_pk_bf16_f32 v93, v74, v75
    v_mov_b32 v94, 0
    v_mov_b32 v95, 0
    s_waitcnt vmcnt(3)
    s_nop 0
    v_mfma_f32_16x16x32_bf16 v[32:35], v[24:27], v[88:91], 0
    v_mfma_f32_16x16x32_bf16 v[32:35], v[40:43], v[92:95], v[32:35]
    v_mfma_f32_16x16x32_bf16 v[36:39], v[28:31], v[88:91], 0
    v_mfma_f32_16x16x32_bf16 v[36:39], v[44:47], v[92:95], v[36:39]
    s_cmp_eq_u32 s20, 63
    s_cbranch_scc1 rec_end
    s_add_u32 s14, s20, 1
    s_and_b32 s15, s14, 3
    s_or_b32 s15, s15, s33
    s_cmp_eq_u32 s15, 0
    s_cbranch_scc0 rec_kv_ready
    s_lshr_b32 s14, s14, 2
    s_add_u32 s80, s14, 1
    s_lshl_b32 s80, s80, 6
    s_add_u32 s80, s80, 132120576
    v_mov_b32 v97, 0
    s_mov_b32 s82, 0
wc_2:
    buffer_load_dword v96, v97, s[40:43], s80 offen sc1
    s_add_u32 s82, s82, 1
    s_waitcnt vmcnt(0)
    v_readfirstlane_b32 s81, v96
    s_cmp_ge_u32 s81, 32
    s_cbranch_scc1 wc_2_ok
    s_cmp_gt_u32 s82, 0x400000
    s_cbranch_scc1 rec_end2
    s_sleep 2
    s_branch wc_2
wc_2_ok:
    s_mov_b32 s80, 132121600
    buffer_load_dword v96, v97, s[40:43], s80 offen sc1
    s_waitcnt vmcnt(0)
    v_readfirstlane_b32 s81, v96
    s_cmp_ge_u32 s81, 32
    s_cselect_b32 s33, 1, 0
rec_kv_ready:
    s_add_u32 s9, s8, 42205184
    buffer_load_dwordx4 v[16:19], v4, s[40:43], s9 offen sc1
    buffer_load_dwordx4 v[20:23], v4, s[40:43], s9 offen offset:1024 sc1
    s_add_u32 s9, s8, 58982400
    s_nop 3
    buffer_load_dwordx4 v[24:27], v4, s[40:43], s9 offen sc1
    buffer_load_dwordx4 v[28:31], v4, s[40:43], s9 offen offset:1024 sc1
    v_cvt_pk_bf16_f32 v32, v32, v33
    v_cvt_pk_bf16_f32 v33, v34, v35
    v_cvt_pk_bf16_f32 v34, v36, v37
    v_cvt_pk_bf16_f32 v35, v38, v39
    ds_write_b128 v11, v[32:35] offset:12288
    s_waitcnt lgkmcnt(0)
    s_barrier
    ds_read_b128 v[48:51], v4 offset:12288
    ds_read_b128 v[52:55], v4 offset:13312
    ds_read_b128 v[56:59], v4 offset:14336
    ds_read_b128 v[60:63], v4 offset:15360
    s_add_u32 s20, s20, 1
    s_lshl_b32 s9, s3, 17
    s_lshl_b32 s11, s2, 9
    s_add_u32 s9, s9, s11
    s_add_u32 s9, s9, 130023424
    v_mov_b32 v0, s20
    v_cmp_gt_u32 vcc, 8, v3
    s_mov_b64 s[12:13], vcc
    s_waitcnt lgkmcnt(3)
    v_mfma_f32_16x16x32_bf16 v[64:67], v[128:131], v[48:51], 0
    s_waitcnt lgkmcnt(2)
    v_mfma_f32_16x16x32_bf16 v[64:67], v[132:135], v[52:55], v[64:67]
    s_waitcnt lgkmcnt(1)
    v_mfma_f32_16x16x32_bf16 v[64:67], v[136:139], v[56:59], v[64:67]
    s_waitcnt lgkmcnt(0)
    v_mfma_f32_16x16x32_bf16 v[64:67], v[140:143], v[60:63], v[64:67]
    v_mfma_f32_16x16x32_bf16 v[68:71], v[144:147], v[48:51], 0
    v_mfma_f32_16x16x32_bf16 v[68:71], v[148:151], v[52:55], v[68:71]
    v_mfma_f32_16x16x32_bf16 v[68:71], v[152:155], v[56:59], v[68:71]
    v_mfma_f32_16x16x32_bf16 v[68:71], v[156:159], v[60:63], v[68:71]
    v_mfma_f32_16x16x32_bf16 v[72:75], v[160:163], v[48:51], 0
    v_mfma_f32_16x16x32_bf16 v[72:75], v[164:167], v[52:55], v[72:75]
    v_mfma_f32_16x16x32_bf16 v[72:75], v[168:171], v[56:59], v[72:75]
    v_mfma_f32_16x16x32_bf16 v[72:75], v[172:175], v[60:63], v[72:75]
    v_and_or_b32 v64, v64, s30, v0
    v_and_or_b32 v65, v65, s30, v0
    v_and_or_b32 v66, v66, s30, v0
    v_and_or_b32 v67, v67, s30, v0
    s_mov_b64 exec, s[12:13]
    buffer_store_dwordx4 v[64:67], v12, s[40:43], s9 offen
    s_mov_b64 exec, -1
    s_add_u32 s9, s9, 16384
    v_mfma_f32_16x16x32_bf16 v[76:79], v[176:179], v[48:51], 0
    v_mfma_f32_16x16x32_bf16 v[76:79], v[180:183], v[52:55], v[76:79]
    v_mfma_f32_16x16x32_bf16 v[76:79], v[184:187], v[56:59], v[76:79]
    v_mfma_f32_16x16x32_bf16 v[76:79], v[188:191], v[60:63], v[76:79]
    v_and_or_b32 v68, v68, s30, v0
    v_and_or_b32 v69, v69, s30, v0
    v_and_or_b32 v70, v70, s30, v0
    v_and_or_b32 v71, v71, s30, v0
    s_mov_b64 exec, s[12:13]
    buffer_store_dwordx4 v[68:71], v12, s[40:43], s9 offen
    s_mov_b64 exec, -1
    s_add_u32 s9, s9, 16384
    v_mfma_f32_16x16x32_bf16 v[80:83], v[192:195], v[48:51], 0
    v_mfma_f32_16x16x32_bf16 v[80:83], v[196:199], v[52:55], v[80:83]
    v_mfma_f32_16x16x32_bf16 v[80:83], v[200:203], v[56:59], v[80:83]
    v_mfma_f32_16x16x32_bf16 v[80:83], v[204:207], v[60:63], v[80:83]
    v_and_or_b32 v72, v72, s30, v0
    v_and_or_b32 v73, v73, s30, v0
    v_and_or_b32 v74, v74, s30, v0
    v_and_or_b32 v75, v75, s30, v0
    s_mov_b64 exec, s[12:13]
    buffer_store_dwordx4 v[72:75], v12, s[40:43], s9 offen
    s_mov_b64 exec, -1
    s_add_u32 s9, s9, 16384
    v_mfma_f32_16x16x32_bf16 v[84:87], v[208:211], v[48:51], 0
    v_mfma_f32_16x16x32_bf16 v[84:87], v[212:215], v[52:55], v[84:87]
    v_mfma_f32_16x16x32_bf16 v[84:87], v[216:219], v[56:59], v[84:87]
    v_mfma_f32_16x16x32_bf16 v[84:87], v[220:223], v[60:63], v[84:87]
    v_and_or_b32 v76, v76, s30, v0
    v_and_or_b32 v77, v77, s30, v0
    v_and_or_b32 v78, v78, s30, v0
    v_and_or_b32 v79, v79, s30, v0
    s_mov_b64 exec, s[12:13]
    buffer_store_dwordx4 v[76:79], v12, s[40:43], s9 offen
    s_mov_b64 exec, -1
    s_add_u32 s9, s9, 16384
    v_mfma_f32_16x16x32_bf16 v[88:91], v[224:227], v[48:51], 0
    v_mfma_f32_16x16x32_bf16 v[88:91], v[228:231], v[52:55], v[88:91]
    v_mfma_f32_16x16x32_bf16 v[88:91], v[232:235], v[56:59], v[88:91]
    v_mfma_f32_16x16x32_bf16 v[88:91], v[236:239], v[60:63], v[88:91]
    v_and_or_b32 v80, v80, s30, v0
    v_and_or_b32 v81, v81, s30, v0
    v_and_or_b32 v82, v82, s30, v0
    v_and_or_b32 v83, v83, s30, v0
    s_mov_b64 exec, s[12:13]
    buffer_store_dwordx4 v[80:83], v12, s[40:43], s9 offen
    s_mov_b64 exec, -1
    s_add_u32 s9, s9, 16384
    v_mfma_f32_16x16x32_bf16 v[92:95], v[240:243], v[48:51], 0
    v_mfma_f32_16x16x32_bf16 v[92:95], v[244:247], v[52:55], v[92:95]
    v_mfma_f32_16x16x32_bf16 v[92:95], v[248:251], v[56:59], v[92:95]
    v_mfma_f32_16x16x32_bf16 v[92:95], v[252:255], v[60:63], v[92:95]
    v_and_or_b32 v84, v84, s30, v0
    v_and_or_b32 v85, v85, s30, v0
    v_and_or_b32 v86, v86, s30, v0
    v_and_or_b32 v87, v87, s30, v0
    s_mov_b64 exec, s[12:13]
    buffer_store_dwordx4 v[84:87], v12, s[40:43], s9 offen
    s_mov_b64 exec, -1
    s_add_u32 s9, s9, 16384
    s_nop 7
    v_and_or_b32 v88, v88, s30, v0
    v_and_or_b32 v89, v89, s30, v0
    v_and_or_b32 v90, v90, s30, v0
    v_and_or_b32 v91, v91, s30, v0
    s_mov_b64 exec, s[12:13]
    buffer_store_dwordx4 v[88:91], v12, s[40:43], s9 offen
    s_mov_b64 exec, -1
    s_add_u32 s9, s9, 16384
    s_nop 7
    v_and_or_b32 v92, v92, s30, v0
    v_and_or_b32 v93, v93, s30, v0
    v_and_or_b32 v94, v94, s30, v0
    v_and_or_b32 v95, v95, s30, v0
    s_mov_b64 exec, s[12:13]
    buffer_store_dwordx4 v[92:95], v12, s[40:43], s9 offen
    s_mov_b64 exec, -1
    s_add_u32 s9, s9, 16384
    s_mov_b32 s10, 0
    s_lshl_b32 s9, s2, 14
    s_lshl_b32 s11, s3, 12
    s_add_u32 s9, s9, s11
    s_add_u32 s9, s9, 130023424
rec_poll_rs:
    buffer_load_dwordx4 v[64:67], v4, s[40:43], s9 offen offset:0 sc1
    buffer_load_dwordx4 v[68:71], v4, s[40:43], s9 offen offset:1024 sc1
    buffer_load_dwordx4 v[72:75], v4, s[40:43], s9 offen offset:2048 sc1
    buffer_load_dwordx4 v[76:79], v4, s[40:43], s9 offen offset:3072 sc1
    s_add_u32 s10, s10, 1
    v_mov_b32 v48, 0
    s_waitcnt vmcnt(3)
    v_xor_b32 v49, s20, v64
    v_xor_b32 v50, s20, v65
    v_or3_b32 v48, v48, v49, v50
    v_xor_b32 v49, s20, v66
    v_xor_b32 v50, s20, v67
    v_or3_b32 v48, v48, v49, v50
    s_waitcnt vmcnt(2)
    v_xor_b32 v49, s20, v68
    v_xor_b32 v50, s20, v69
    v_or3_b32 v48, v48, v49, v50
    v_xor_b32 v49, s20, v70
    v_xor_b32 v50, s20, v71
    v_or3_b32 v48, v48, v49, v50
    v_pk_add_f32 v[64:65], v[64:65], v[68:69]
    v_pk_add_f32 v[66:67], v[66:67], v[70:71]
    s_waitcnt vmcnt(1)
    v_xor_b32 v49, s20, v72
    v_xor_b32 v50, s20, v73
    v_or3_b32 v48, v48, v49, v50
    v_xor_b32 v49, s20, v74
    v_xor_b32 v50, s20, v75
    v_or3_b32 v48, v48, v49, v50
    v_pk_add_f32 v[64:65], v[64:65], v[72:73]
    v_pk_add_f32 v[66:67], v[66:67], v[74:75]
    s_waitcnt vmcnt(0)
    v_xor_b32 v49, s20, v76
    v_xor_b32 v50, s20, v77
    v_or3_b32 v48, v48, v49, v50
    v_xor_b32 v49, s20, v78
    v_xor_b32 v50, s20, v79
    v_or3_b32 v48, v48, v49, v50
    v_pk_add_f32 v[64:65], v[64:65], v[76:77]
    v_pk_add_f32 v[66:67], v[66:67], v[78:79]
    v_and_b32 v48, 0xff, v48
    v_cmp_eq_u32 vcc, 0, v48
    s_cmp_gt_u32 s10, 0x200000
    s_cbranch_scc1 rec_end2
    s_cmp_eq_u64 vcc, exec
    s_cbranch_scc0 rec_poll_rs
    ds_write_b128 v11, v[64:67] offset:0
    s_waitcnt lgkmcnt(0)
    s_barrier
    s_cmp_eq_u32 s3, 0
    s_cbranch_scc0 rec_wait0
    ds_read_b128 v[64:67], v4 offset:0
    ds_read_b128 v[68:71], v4 offset:1024
    ds_read_b128 v[72:75], v4 offset:2048
    ds_read_b128 v[76:79], v4 offset:3072
    s_waitcnt lgkmcnt(0)
    v_pk_add_f32 v[64:65], v[64:65], v[68:69]
    v_pk_add_f32 v[66:67], v[66:67], v[70:71]
    v_pk_add_f32 v[72:73], v[72:73], v[76:77]
    v_pk_add_f32 v[74:75], v[74:75], v[78:79]
    v_pk_add_f32 v[64:65], v[64:65], v[72:73]
    v_pk_add_f32 v[66:67], v[66:67], v[74:75]
    v_mov_b32 v68, v64
    v_mov_b32 v69, v65
    v_mov_b32 v70, v66
    v_mov_b32 v71, v67
    s_nop 1
    v_permlane32_swap_b32 v64, v68
    v_permlane32_swap_b32 v65, v69
    v_permlane32_swap_b32 v66, v70
    v_permlane32_swap_b32 v67, v71
    s_nop 1
    v_add_f32 v64, v64, v68
    v_add_f32 v65, v65, v69
    v_add_f32 v66, v66, v70
    v_add_f32 v67, v67, v71
    v_cvt_pk_bf16_f32 v64, v64, v64
    v_lshl_or_b32 v64, v64, 16, v0
    v_cvt_pk_bf16_f32 v65, v65, v65
    v_lshl_or_b32 v65, v65, 16, v0
    v_cvt_pk_bf16_f32 v66, v66, v66
    v_lshl_or_b32 v66, v66, 16, v0
    v_cvt_pk_bf16_f32 v67, v67, v67
    v_lshl_or_b32 v67, v67, 16, v0
    s_mov_b32 exec_hi, 0
    buffer_store_dwordx4 v[64:67], v14, s[40:43], s32 offen
    s_mov_b64 exec, -1
rec_wait0:
    s_and_b32 s15, s20, 3
    s_cmp_eq_u32 s15, 0
    s_cbranch_scc1 rec_sig
    s_barrier
    s_branch rec_loop
rec_sig:
    s_lshr_b32 s14, s20, 2
    s_sub_u32 s14, s14, 1
    s_waitcnt vmcnt(0)
    s_barrier
    s_cmp_eq_u32 s3, 0
    s_cbranch_scc0 sg_3
    s_add_u32 s80, s14, 33
    s_lshl_b32 s80, s80, 6
    s_add_u32 s80, s80, 132120576
    v_mov_b32 v96, 1
    v_mov_b32 v97, 0
    s_mov_b64 exec, 1
    buffer_atomic_add v96, v97, s[40:43], s80 offen
    s_mov_b64 exec, -1
sg_3:
    s_branch rec_loop
rec_end:
    s_mov_b32 s14, 15
    s_waitcnt vmcnt(0)
    s_barrier
    s_cmp_eq_u32 s3, 0
    s_cbranch_scc0 sg_4
    s_add_u32 s80, s14, 33
    s_lshl_b32 s80, s80, 6
    s_add_u32 s80, s80, 132120576
    v_mov_b32 v96, 1
    v_mov_b32 v97, 0
    s_mov_b64 exec, 1
    buffer_atomic_add v96, v97, s[40:43], s80 offen
    s_mov_b64 exec, -1
sg_4:
    s_mov_b64 exec, -1
    s_branch worker_start
rec_end2:
    s_endpgm
worker_start:
    s_load_dwordx2 s[24:25], s[0:1], 0
    s_load_dwordx2 s[26:27], s[0:1], 88
    s_waitcnt lgkmcnt(0)
    s_mov_b32 s44, s24
    s_and_b32 s45, s25, 0xffff
    s_mov_b32 s46, 2097152
    s_mov_b32 s47, 0x00020000
    s_mov_b32 s52, s26
    s_and_b32 s53, s27, 0xffff
    s_mov_b32 s54, 2097152
    s_mov_b32 s55, 0x00020000
    s_mov_b32 s90, -1
    v_add_u32 v5, 0x10000, v4
worker_loop:
    v_mov_b32 v18, 163776
    s_cmp_eq_u32 s3, 0
    s_cbranch_scc0 worker_t1
    v_mov_b32 v16, 1
    v_mov_b32 v17, 0
    s_mov_b32 s80, 132120576
    s_mov_b64 exec, 1
    buffer_atomic_add v16, v17, s[40:43], s80 offen sc0
    s_waitcnt vmcnt(0)
    ds_write_b32 v18, v16
    s_waitcnt lgkmcnt(0)
    s_mov_b64 exec, -1
worker_t1:
    s_barrier
    ds_read_b32 v16, v18
    s_waitcnt lgkmcnt(0)
    v_readfirstlane_b32 s91, v16
    s_barrier
    s_cmp_ge_u32 s91, 7304
    s_cbranch_scc1 worker_fin
    s_cmp_ge_u32 s91, 768
    s_cbranch_scc1 worker_stage
    s_mul_hi_u32 s4, s91, 89478486
    s_mul_i32 s5, s4, 48
    s_sub_u32 s5, s91, s5
    s_add_u32 s11, s5, 16
    s_cmp_ge_u32 s11, 48
    s_cselect_b32 s5, 48, 0
    s_sub_u32 s11, s11, s5
    s_cmp_eq_u32 s90, s4
    s_cbranch_scc1 qkv_have_panel
    s_mov_b32 s90, s4
    s_barrier
    s_lshl_b32 s6, s4, 17
    s_lshl_b32 s7, s3, 15
    s_add_u32 s6, s6, s7
    s_add_u32 s8, s7, 0
    s_mov_b32 m0, s8
    s_add_u32 s9, s6, 0
    buffer_load_dwordx4 v4, s[40:43], s9 offen lds
    s_add_u32 s8, s7, 1024
    s_mov_b32 m0, s8
    s_add_u32 s9, s6, 1024
    buffer_load_dwordx4 v4, s[40:43], s9 offen lds
    s_add_u32 s8, s7, 2048
    s_mov_b32 m0, s8
    s_add_u32 s9, s6, 2048
    buffer_load_dwordx4 v4, s[40:43], s9 offen lds
    s_add_u32 s8, s7, 3072
    s_mov_b32 m0, s8
    s_add_u32 s9, s6, 3072
    buffer_load_dwordx4 v4, s[40:43], s9 offen lds
    s_add_u32 s8, s7, 4096
    s_mov_b32 m0, s8
    s_add_u32 s9, s6, 4096
    buffer_load_dwordx4 v4, s[40:43], s9 offen lds
    s_add_u32 s8, s7, 5120
    s_mov_b32 m0, s8
    s_add_u32 s9, s6, 5120
    buffer_load_dwordx4 v4, s[40:43], s9 offen lds
    s_add_u32 s8, s7, 6144
    s_mov_b32 m0, s8
    s_add_u32 s9, s6, 6144
    buffer_load_dwordx4 v4, s[40:43], s9 offen lds
    s_add_u32 s8, s7, 7168
    s_mov_b32 m0, s8
    s_add_u32 s9, s6, 7168
    buffer_load_dwordx4 v4, s[40:43], s9 offen lds
    s_add_u32 s8, s7, 8192
    s_mov_b32 m0, s8
    s_add_u32 s9, s6, 8192
    buffer_load_dwordx4 v4, s[40:43], s9 offen lds
    s_add_u32 s8, s7, 9216
    s_mov_b32 m0, s8
    s_add_u32 s9, s6, 9216
    buffer_load_dwordx4 v4, s[40:43], s9 offen lds
    s_add_u32 s8, s7, 10240
    s_mov_b32 m0, s8
    s_add_u32 s9, s6, 10240
    buffer_load_dwordx4 v4, s[40:43], s9 offen lds
    s_add_u32 s8, s7, 11264
    s_mov_b32 m0, s8
    s_add_u32 s9, s6, 11264
    buffer_load_dwordx4 v4, s[40:43], s9 offen lds
    s_add_u32 s8, s7, 12288
    s_mov_b32 m0, s8
    s_add_u32 s9, s6, 12288
    buffer_load_dwordx4 v4, s[40:43], s9 offen lds
    s_add_u32 s8, s7, 13312
    s_mov_b32 m0, s8
    s_add_u32 s9, s6, 13312
    buffer_load_dwordx4 v4, s[40:43], s9 offen lds
    s_add_u32 s8, s7, 14336
    s_mov_b32 m0, s8
    s_add_u32 s9, s6, 14336
    buffer_load_dwordx4 v4, s[40:43], s9 offen lds
    s_add_u32 s8, s7, 15360
    s_mov_b32 m0, s8
    s_add_u32 s9, s6, 15360
    buffer_load_dwordx4 v4, s[40:43], s9 offen lds
    s_add_u32 s8, s7, 16384
    s_mov_b32 m0, s8
    s_add_u32 s9, s6, 16384
    buffer_load_dwordx4 v4, s[40:43], s9 offen lds
    s_add_u32 s8, s7, 17408
    s_mov_b32 m0, s8
    s_add_u32 s9, s6, 17408
    buffer_load_dwordx4 v4, s[40:43], s9 offen lds
    s_add_u32 s8, s7, 18432
    s_mov_b32 m0, s8
    s_add_u32 s9, s6, 18432
    buffer_load_dwordx4 v4, s[40:43], s9 offen lds
    s_add_u32 s8, s7, 19456
    s_mov_b32 m0, s8
    s_add_u32 s9, s6, 19456
    buffer_load_dwordx4 v4, s[40:43], s9 offen lds
    s_add_u32 s8, s7, 20480
    s_mov_b32 m0, s8
    s_add_u32 s9, s6, 20480
    buffer_load_dwordx4 v4, s[40:43], s9 offen lds
    s_add_u32 s8, s7, 21504
    s_mov_b32 m0, s8
    s_add_u32 s9, s6, 21504
    buffer_load_dwordx4 v4, s[40:43], s9 offen lds
    s_add_u32 s8, s7, 22528
    s_mov_b32 m0, s8
    s_add_u32 s9, s6, 22528
    buffer_load_dwordx4 v4, s[40:43], s9 offen lds
    s_add_u32 s8, s7, 23552
    s_mov_b32 m0, s8
    s_add_u32 s9, s6, 23552
    buffer_load_dwordx4 v4, s[40:43], s9 offen lds
    s_add_u32 s8, s7, 24576
    s_mov_b32 m0, s8
    s_add_u32 s9, s6, 24576
    buffer_load_dwordx4 v4, s[40:43], s9 offen lds
    s_add_u32 s8, s7, 25600
    s_mov_b32 m0, s8
    s_add_u32 s9, s6, 25600
    buffer_load_dwordx4 v4, s[40:43], s9 offen lds
    s_add_u32 s8, s7, 26624
    s_mov_b32 m0, s8
    s_add_u32 s9, s6, 26624
    buffer_load_dwordx4 v4, s[40:43], s9 offen lds
    s_add_u32 s8, s7, 27648
    s_mov_b32 m0, s8
    s_add_u32 s9, s6, 27648
    buffer_load_dwordx4 v4, s[40:43], s9 offen lds
    s_add_u32 s8, s7, 28672
    s_mov_b32 m0, s8
    s_add_u32 s9, s6, 28672
    buffer_load_dwordx4 v4, s[40:43], s9 offen lds
    s_add_u32 s8, s7, 29696
    s_mov_b32 m0, s8
    s_add_u32 s9, s6, 29696
    buffer_load_dwordx4 v4, s[40:43], s9 offen lds
    s_add_u32 s8, s7, 30720
    s_mov_b32 m0, s8
    s_add_u32 s9, s6, 30720
    buffer_load_dwordx4 v4, s[40:43], s9 offen lds
    s_add_u32 s8, s7, 31744
    s_mov_b32 m0, s8
    s_add_u32 s9, s6, 31744
    buffer_load_dwordx4 v4, s[40:43], s9 offen lds
    s_waitcnt vmcnt(0)
    s_barrier
qkv_have_panel:
    s_lshl_b32 s12, s11, 4
    s_lshl_b32 s13, s3, 2
    s_add_u32 s12, s12, s13
    s_lshl_b32 s14, s12, 14
    s_add_u32 s14, s14, 2097152
    v_add_u32 v8, 0, v4
    v_add_u32 v9, 16384, v4
    v_add_u32 v10, 32768, v4
    v_add_u32 v11, 49152, v4
    s_lshr_b32 s15, s12, 3
    s_and_b32 s15, s15, 31
    s_and_b32 s16, s12, 7
    s_cmp_ge_u32 s11, 32
    s_cbranch_scc1 qkv_v
    buffer_load_dwordx4 v[96:99], v8, s[40:43], s14 offen offset:0
    buffer_load_dwordx4 v[100:103], v9, s[40:43], s14 offen offset:0
    buffer_load_dwordx4 v[104:107], v10, s[40:43], s14 offen offset:0
    buffer_load_dwordx4 v[108:111], v11, s[40:43], s14 offen offset:0
    buffer_load_dwordx4 v[112:115], v8, s[40:43], s14 offen offset:1024
    buffer_load_dwordx4 v[116:119], v9, s[40:43], s14 offen offset:1024
    buffer_load_dwordx4 v[120:123], v10, s[40:43], s14 offen offset:1024
    buffer_load_dwordx4 v[124:127], v11, s[40:43], s14 offen offset:1024
    ds_read_b128 v[32:35], v4 offset:0
    ds_read_b128 v[36:39], v4 offset:16384
    ds_read_b128 v[40:43], v4 offset:32768
    ds_read_b128 v[44:47], v4 offset:49152
    ds_read_b128 v[48:51], v5 offset:0
    ds_read_b128 v[52:55], v5 offset:16384
    ds_read_b128 v[56:59], v5 offset:32768
    ds_read_b128 v[60:63], v5 offset:49152
    buffer_load_dwordx4 v[128:131], v8, s[40:43], s14 offen offset:2048
    buffer_load_dwordx4 v[132:135], v9, s[40:43], s14 offen offset:2048
    buffer_load_dwordx4 v[136:139], v10, s[40:43], s14 offen offset:2048
    buffer_load_dwordx4 v[140:143], v11, s[40:43], s14 offen offset:2048
    ds_read_b128 v[64:67], v4 offset:1024
    ds_read_b128 v[68:71], v4 offset:17408
    ds_read_b128 v[72:75], v4 offset:33792
    ds_read_b128 v[76:79], v4 offset:50176
    ds_read_b128 v[80:83], v5 offset:1024
    ds_read_b128 v[84:87], v5 offset:17408
    ds_read_b128 v[88:91], v5 offset:33792
    ds_read_b128 v[92:95], v5 offset:50176
    s_waitcnt vmcnt(8) lgkmcnt(8)
    v_mfma_f32_16x16x32_bf16 a[0:3], v[96:99], v[32:35], 0
    v_mfma_f32_16x16x32_bf16 a[4:7], v[100:103], v[32:35], 0
    v_mfma_f32_16x16x32_bf16 a[8:11], v[104:107], v[32:35], 0
    v_mfma_f32_16x16x32_bf16 a[12:15], v[108:111], v[32:35], 0
    v_mfma_f32_16x16x32_bf16 a[16:19], v[96:99], v[36:39], 0
    v_mfma_f32_16x16x32_bf16 a[20:23], v[100:103], v[36:39], 0
    v_mfma_f32_16x16x32_bf16 a[24:27], v[104:107], v[36:39], 0
    v_mfma_f32_16x16x32_bf16 a[28:31], v[108:111], v[36:39], 0
    v_mfma_f32_16x16x32_bf16 a[32:35], v[96:99], v[40:43], 0
    v_mfma_f32_16x16x32_bf16 a[36:39], v[100:103], v[40:43], 0
    v_mfma_f32_16x16x32_bf16 a[40:43], v[104:107], v[40:43], 0
    v_mfma_f32_16x16x32_bf16 a[44:47], v[108:111], v[40:43], 0
    v_mfma_f32_16x16x32_bf16 a[48:51], v[96:99], v[44:47], 0
    v_mfma_f32_16x16x32_bf16 a[52:55], v[100:103], v[44:47], 0
    v_mfma_f32_16x16x32_bf16 a[56:59], v[104:107], v[44:47], 0
    v_mfma_f32_16x16x32_bf16 a[60:63], v[108:111], v[44:47], 0
    v_mfma_f32_16x16x32_bf16 a[64:67], v[96:99], v[48:51], 0
    v_mfma_f32_16x16x32_bf16 a[68:71], v[100:103], v[48:51], 0
    v_mfma_f32_16x16x32_bf16 a[72:75], v[104:107], v[48:51], 0
    v_mfma_f32_16x16x32_bf16 a[76:79], v[108:111], v[48:51], 0
    v_mfma_f32_16x16x32_bf16 a[80:83], v[96:99], v[52:55], 0
    v_mfma_f32_16x16x32_bf16 a[84:87], v[100:103], v[52:55], 0
    v_mfma_f32_16x16x32_bf16 a[88:91], v[104:107], v[52:55], 0
    v_mfma_f32_16x16x32_bf16 a[92:95], v[108:111], v[52:55], 0
    v_mfma_f32_16x16x32_bf16 a[96:99], v[96:99], v[56:59], 0
    v_mfma_f32_16x16x32_bf16 a[100:103], v[100:103], v[56:59], 0
    v_mfma_f32_16x16x32_bf16 a[104:107], v[104:107], v[56:59], 0
    v_mfma_f32_16x16x32_bf16 a[108:111], v[108:111], v[56:59], 0
    v_mfma_f32_16x16x32_bf16 a[112:115], v[96:99], v[60:63], 0
    v_mfma_f32_16x16x32_bf16 a[116:119], v[100:103], v[60:63], 0
    v_mfma_f32_16x16x32_bf16 a[120:123], v[104:107], v[60:63], 0
    v_mfma_f32_16x16x32_bf16 a[124:127], v[108:111], v[60:63], 0
    buffer_load_dwordx4 v[96:99], v8, s[40:43], s14 offen offset:3072
    buffer_load_dwordx4 v[100:103], v9, s[40:43], s14 offen offset:3072
    buffer_load_dwordx4 v[104:107], v10, s[40:43], s14 offen offset:3072
    buffer_load_dwordx4 v[108:111], v11, s[40:43], s14 offen offset:3072
    ds_read_b128 v[32:35], v4 offset:2048
    ds_read_b128 v[36:39], v4 offset:18432
    ds_read_b128 v[40:43], v4 offset:34816
    ds_read_b128 v[44:47], v4 offset:51200
    ds_read_b128 v[48:51], v5 offset:2048
    ds_read_b128 v[52:55], v5 offset:18432
    ds_read_b128 v[56:59], v5 offset:34816
    ds_read_b128 v[60:63], v5 offset:51200
    s_waitcnt vmcnt(8) lgkmcnt(8)
    v_mfma_f32_16x16x32_bf16 a[0:3], v[112:115], v[64:67], a[0:3]
    v_mfma_f32_16x16x32_bf16 a[4:7], v[116:119], v[64:67], a[4:7]
    v_mfma_f32_16x16x32_bf16 a[8:11], v[120:123], v[64:67], a[8:11]
    v_mfma_f32_16x16x32_bf16 a[12:15], v[124:127], v[64:67], a[12:15]
    v_mfma_f32_16x16x32_bf16 a[16:19], v[112:115], v[68:71], a[16:19]
    v_mfma_f32_16x16x32_bf16 a[20:23], v[116:119], v[68:71], a[20:23]
    v_mfma_f32_16x16x32_bf16 a[24:27], v[120:123], v[68:71], a[24:27]
    v_mfma_f32_16x16x32_bf16 a[28:31], v[124:127], v[68:71], a[28:31]
    v_mfma_f32_16x16x32_bf16 a[32:35], v[112:115], v[72:75], a[32:35]
    v_mfma_f32_16x16x32_bf16 a[36:39], v[116:119], v[72:75], a[36:39]
    v_mfma_f32_16x16x32_bf16 a[40:43], v[120:123], v[72:75], a[40:43]
    v_mfma_f32_16x16x32_bf16 a[44:47], v[124:127], v[72:75], a[44:47]
    v_mfma_f32_16x16x32_bf16 a[48:51], v[112:115], v[76:79], a[48:51]
    v_mfma_f32_16x16x32_bf16 a[52:55], v[116:119], v[76:79], a[52:55]
    v_mfma_f32_16x16x32_bf16 a[56:59], v[120:123], v[76:79], a[56:59]
    v_mfma_f32_16x16x32_bf16 a[60:63], v[124:127], v[76:79], a[60:63]
    v_mfma_f32_16x16x32_bf16 a[64:67], v[112:115], v[80:83], a[64:67]
    v_mfma_f32_16x16x32_bf16 a[68:71], v[116:119], v[80:83], a[68:71]
    v_mfma_f32_16x16x32_bf16 a[72:75], v[120:123], v[80:83], a[72:75]
    v_mfma_f32_16x16x32_bf16 a[76:79], v[124:127], v[80:83], a[76:79]
    v_mfma_f32_16x16x32_bf16 a[80:83], v[112:115], v[84:87], a[80:83]
    v_mfma_f32_16x16x32_bf16 a[84:87], v[116:119], v[84:87], a[84:87]
    v_mfma_f32_16x16x32_bf16 a[88:91], v[120:123], v[84:87], a[88:91]
    v_mfma_f32_16x16x32_bf16 a[92:95], v[124:127], v[84:87], a[92:95]
    v_mfma_f32_16x16x32_bf16 a[96:99], v[112:115], v[88:91], a[96:99]
    v_mfma_f32_16x16x32_bf16 a[100:103], v[116:119], v[88:91], a[100:103]
    v_mfma_f32_16x16x32_bf16 a[104:107], v[120:123], v[88:91], a[104:107]
    v_mfma_f32_16x16x32_bf16 a[108:111], v[124:127], v[88:91], a[108:111]
    v_mfma_f32_16x16x32_bf16 a[112:115], v[112:115], v[92:95], a[112:115]
    v_mfma_f32_16x16x32_bf16 a[116:119], v[116:119], v[92:95], a[116:119]
    v_mfma_f32_16x16x32_bf16 a[120:123], v[120:123], v[92:95], a[120:123]
    v_mfma_f32_16x16x32_bf16 a[124:127], v[124:127], v[92:95], a[124:127]
    s_add_u32 s14, s14, 4096
    buffer_load_dwordx4 v[112:115], v8, s[40:43], s14 offen offset:0
    buffer_load_dwordx4 v[116:119], v9, s[40:43], s14 offen offset:0
    buffer_load_dwordx4 v[120:123], v10, s[40:43], s14 offen offset:0
    buffer_load_dwordx4 v[124:127], v11, s[40:43], s14 offen offset:0
    ds_read_b128 v[64:67], v4 offset:3072
    ds_read_b128 v[68:71], v4 offset:19456
    ds_read_b128 v[72:75], v4 offset:35840
    ds_read_b128 v[76:79], v4 offset:52224
    ds_read_b128 v[80:83], v5 offset:3072
    ds_read_b128 v[84:87], v5 offset:19456
    ds_read_b128 v[88:91], v5 offset:35840
    ds_read_b128 v[92:95], v5 offset:52224
    s_waitcnt vmcnt(8) lgkmcnt(8)
    v_mfma_f32_16x16x32_bf16 a[0:3], v[128:131], v[32:35], a[0:3]
    v_mfma_f32_16x16x32_bf16 a[4:7], v[132:135], v[32:35], a[4:7]
    v_mfma_f32_16x16x32_bf16 a[8:11], v[136:139], v[32:35], a[8:11]
    v_mfma_f32_16x16x32_bf16 a[12:15], v[140:143], v[32:35], a[12:15]
    v_mfma_f32_16x16x32_bf16 a[16:19], v[128:131], v[36:39], a[16:19]
    v_mfma_f32_16x16x32_bf16 a[20:23], v[132:135], v[36:39], a[20:23]
    v_mfma_f32_16x16x32_bf16 a[24:27], v[136:139], v[36:39], a[24:27]
    v_mfma_f32_16x16x32_bf16 a[28:31], v[140:143], v[36:39], a[28:31]
    v_mfma_f32_16x16x32_bf16 a[32:35], v[128:131], v[40:43], a[32:35]
    v_mfma_f32_16x16x32_bf16 a[36:39], v[132:135], v[40:43], a[36:39]
    v_mfma_f32_16x16x32_bf16 a[40:43], v[136:139], v[40:43], a[40:43]
    v_mfma_f32_16x16x32_bf16 a[44:47], v[140:143], v[40:43], a[44:47]
    v_mfma_f32_16x16x32_bf16 a[48:51], v[128:131], v[44:47], a[48:51]
    v_mfma_f32_16x16x32_bf16 a[52:55], v[132:135], v[44:47], a[52:55]
    v_mfma_f32_16x16x32_bf16 a[56:59], v[136:139], v[44:47], a[56:59]
    v_mfma_f32_16x16x32_bf16 a[60:63], v[140:143], v[44:47], a[60:63]
    v_mfma_f32_16x16x32_bf16 a[64:67], v[128:131], v[48:51], a[64:67]
    v_mfma_f32_16x16x32_bf16 a[68:71], v[132:135], v[48:51], a[68:71]
    v_mfma_f32_16x16x32_bf16 a[72:75], v[136:139], v[48:51], a[72:75]
    v_mfma_f32_16x16x32_bf16 a[76:79], v[140:143], v[48:51], a[76:79]
    v_mfma_f32_16x16x32_bf16 a[80:83], v[128:131], v[52:55], a[80:83]
    v_mfma_f32_16x16x32_bf16 a[84:87], v[132:135], v[52:55], a[84:87]
    v_mfma_f32_16x16x32_bf16 a[88:91], v[136:139], v[52:55], a[88:91]
    v_mfma_f32_16x16x32_bf16 a[92:95], v[140:143], v[52:55], a[92:95]
    v_mfma_f32_16x16x32_bf16 a[96:99], v[128:131], v[56:59], a[96:99]
    v_mfma_f32_16x16x32_bf16 a[100:103], v[132:135], v[56:59], a[100:103]
    v_mfma_f32_16x16x32_bf16 a[104:107], v[136:139], v[56:59], a[104:107]
    v_mfma_f32_16x16x32_bf16 a[108:111], v[140:143], v[56:59], a[108:111]
    v_mfma_f32_16x16x32_bf16 a[112:115], v[128:131], v[60:63], a[112:115]
    v_mfma_f32_16x16x32_bf16 a[116:119], v[132:135], v[60:63], a[116:119]
    v_mfma_f32_16x16x32_bf16 a[120:123], v[136:139], v[60:63], a[120:123]
    v_mfma_f32_16x16x32_bf16 a[124:127], v[140:143], v[60:63], a[124:127]
    buffer_load_dwordx4 v[128:131], v8, s[40:43], s14 offen offset:1024
    buffer_load_dwordx4 v[132:135], v9, s[40:43], s14 offen offset:1024
    buffer_load_dwordx4 v[136:139], v10, s[40:43], s14 offen offset:1024
    buffer_load_dwordx4 v[140:143], v11, s[40:43], s14 offen offset:1024
    ds_read_b128 v[32:35], v4 offset:4096
    ds_read_b128 v[36:39], v4 offset:20480
    ds_read_b128 v[40:43], v4 offset:36864
    ds_read_b128 v[44:47], v4 offset:53248
    ds_read_b128 v[48:51], v5 offset:4096
    ds_read_b128 v[52:55], v5 offset:20480
    ds_read_b128 v[56:59], v5 offset:36864
    ds_read_b128 v[60:63], v5 offset:53248
    s_waitcnt vmcnt(8) lgkmcnt(8)
    v_mfma_f32_16x16x32_bf16 a[0:3], v[96:99], v[64:67], a[0:3]
    v_mfma_f32_16x16x32_bf16 a[4:7], v[100:103], v[64:67], a[4:7]
    v_mfma_f32_16x16x32_bf16 a[8:11], v[104:107], v[64:67], a[8:11]
    v_mfma_f32_16x16x32_bf16 a[12:15], v[108:111], v[64:67], a[12:15]
    v_mfma_f32_16x16x32_bf16 a[16:19], v[96:99], v[68:71], a[16:19]
    v_mfma_f32_16x16x32_bf16 a[20:23], v[100:103], v[68:71], a[20:23]
    v_mfma_f32_16x16x32_bf16 a[24:27], v[104:107], v[68:71], a[24:27]
    v_mfma_f32_16x16x32_bf16 a[28:31], v[108:111], v[68:71], a[28:31]
    v_mfma_f32_16x16x32_bf16 a[32:35], v[96:99], v[72:75], a[32:35]
    v_mfma_f32_16x16x32_bf16 a[36:39], v[100:103], v[72:75], a[36:39]
    v_mfma_f32_16x16x32_bf16 a[40:43], v[104:107], v[72:75], a[40:43]
    v_mfma_f32_16x16x32_bf16 a[44:47], v[108:111], v[72:75], a[44:47]
    v_mfma_f32_16x16x32_bf16 a[48:51], v[96:99], v[76:79], a[48:51]
    v_mfma_f32_16x16x32_bf16 a[52:55], v[100:103], v[76:79], a[52:55]
    v_mfma_f32_16x16x32_bf16 a[56:59], v[104:107], v[76:79], a[56:59]
    v_mfma_f32_16x16x32_bf16 a[60:63], v[108:111], v[76:79], a[60:63]
    v_mfma_f32_16x16x32_bf16 a[64:67], v[96:99], v[80:83], a[64:67]
    v_mfma_f32_16x16x32_bf16 a[68:71], v[100:103], v[80:83], a[68:71]
    v_mfma_f32_16x16x32_bf16 a[72:75], v[104:107], v[80:83], a[72:75]
    v_mfma_f32_16x16x32_bf16 a[76:79], v[108:111], v[80:83], a[76:79]
    v_mfma_f32_16x16x32_bf16 a[80:83], v[96:99], v[84:87], a[80:83]
    v_mfma_f32_16x16x32_bf16 a[84:87], v[100:103], v[84:87], a[84:87]
    v_mfma_f32_16x16x32_bf16 a[88:91], v[104:107], v[84:87], a[88:91]
    v_mfma_f32_16x16x32_bf16 a[92:95], v[108:111], v[84:87], a[92:95]
    v_mfma_f32_16x16x32_bf16 a[96:99], v[96:99], v[88:91], a[96:99]
    v_mfma_f32_16x16x32_bf16 a[100:103], v[100:103], v[88:91], a[100:103]
    v_mfma_f32_16x16x32_bf16 a[104:107], v[104:107], v[88:91], a[104:107]
    v_mfma_f32_16x16x32_bf16 a[108:111], v[108:111], v[88:91], a[108:111]
    v_mfma_f32_16x16x32_bf16 a[112:115], v[96:99], v[92:95], a[112:115]
    v_mfma_f32_16x16x32_bf16 a[116:119], v[100:103], v[92:95], a[116:119]
    v_mfma_f32_16x16x32_bf16 a[120:123], v[104:107], v[92:95], a[120:123]
    v_mfma_f32_16x16x32_bf16 a[124:127], v[108:111], v[92:95], a[124:127]
    buffer_load_dwordx4 v[96:99], v8, s[40:43], s14 offen offset:2048
    buffer_load_dwordx4 v[100:103], v9, s[40:43], s14 offen offset:2048
    buffer_load_dwordx4 v[104:107], v10, s[40:43], s14 offen offset:2048
    buffer_load_dwordx4 v[108:111], v11, s[40:43], s14 offen offset:2048
    ds_read_b128 v[64:67], v4 offset:5120
    ds_read_b128 v[68:71], v4 offset:21504
    ds_read_b128 v[72:75], v4 offset:37888
    ds_read_b128 v[76:79], v4 offset:54272
    ds_read_b128 v[80:83], v5 offset:5120
    ds_read_b128 v[84:87], v5 offset:21504
    ds_read_b128 v[88:91], v5 offset:37888
    ds_read_b128 v[92:95], v5 offset:54272
    s_waitcnt vmcnt(8) lgkmcnt(8)
    v_mfma_f32_16x16x32_bf16 a[0:3], v[112:115], v[32:35], a[0:3]
    v_mfma_f32_16x16x32_bf16 a[4:7], v[116:119], v[32:35], a[4:7]
    v_mfma_f32_16x16x32_bf16 a[8:11], v[120:123], v[32:35], a[8:11]
    v_mfma_f32_16x16x32_bf16 a[12:15], v[124:127], v[32:35], a[12:15]
    v_mfma_f32_16x16x32_bf16 a[16:19], v[112:115], v[36:39], a[16:19]
    v_mfma_f32_16x16x32_bf16 a[20:23], v[116:119], v[36:39], a[20:23]
    v_mfma_f32_16x16x32_bf16 a[24:27], v[120:123], v[36:39], a[24:27]
    v_mfma_f32_16x16x32_bf16 a[28:31], v[124:127], v[36:39], a[28:31]
    v_mfma_f32_16x16x32_bf16 a[32:35], v[112:115], v[40:43], a[32:35]
    v_mfma_f32_16x16x32_bf16 a[36:39], v[116:119], v[40:43], a[36:39]
    v_mfma_f32_16x16x32_bf16 a[40:43], v[120:123], v[40:43], a[40:43]
    v_mfma_f32_16x16x32_bf16 a[44:47], v[124:127], v[40:43], a[44:47]
    v_mfma_f32_16x16x32_bf16 a[48:51], v[112:115], v[44:47], a[48:51]
    v_mfma_f32_16x16x32_bf16 a[52:55], v[116:119], v[44:47], a[52:55]
    v_mfma_f32_16x16x32_bf16 a[56:59], v[120:123], v[44:47], a[56:59]
    v_mfma_f32_16x16x32_bf16 a[60:63], v[124:127], v[44:47], a[60:63]
    v_mfma_f32_16x16x32_bf16 a[64:67], v[112:115], v[48:51], a[64:67]
    v_mfma_f32_16x16x32_bf16 a[68:71], v[116:119], v[48:51], a[68:71]
    v_mfma_f32_16x16x32_bf16 a[72:75], v[120:123], v[48:51], a[72:75]
    v_mfma_f32_16x16x32_bf16 a[76:79], v[124:127], v[48:51], a[76:79]
    v_mfma_f32_16x16x32_bf16 a[80:83], v[112:115], v[52:55], a[80:83]
    v_mfma_f32_16x16x32_bf16 a[84:87], v[116:119], v[52:55], a[84:87]
    v_mfma_f32_16x16x32_bf16 a[88:91], v[120:123], v[52:55], a[88:91]
    v_mfma_f32_16x16x32_bf16 a[92:95], v[124:127], v[52:55], a[92:95]
    v_mfma_f32_16x16x32_bf16 a[96:99], v[112:115], v[56:59], a[96:99]
    v_mfma_f32_16x16x32_bf16 a[100:103], v[116:119], v[56:59], a[100:103]
    v_mfma_f32_16x16x32_bf16 a[104:107], v[120:123], v[56:59], a[104:107]
    v_mfma_f32_16x16x32_bf16 a[108:111], v[124:127], v[56:59], a[108:111]
    v_mfma_f32_16x16x32_bf16 a[112:115], v[112:115], v[60:63], a[112:115]
    v_mfma_f32_16x16x32_bf16 a[116:119], v[116:119], v[60:63], a[116:119]
    v_mfma_f32_16x16x32_bf16 a[120:123], v[120:123], v[60:63], a[120:123]
    v_mfma_f32_16x16x32_bf16 a[124:127], v[124:127], v[60:63], a[124:127]
    buffer_load_dwordx4 v[112:115], v8, s[40:43], s14 offen offset:3072
    buffer_load_dwordx4 v[116:119], v9, s[40:43], s14 offen offset:3072
    buffer_load_dwordx4 v[120:123], v10, s[40:43], s14 offen offset:3072
    buffer_load_dwordx4 v[124:127], v11, s[40:43], s14 offen offset:3072
    ds_read_b128 v[32:35], v4 offset:6144
    ds_read_b128 v[36:39], v4 offset:22528
    ds_read_b128 v[40:43], v4 offset:38912
    ds_read_b128 v[44:47], v4 offset:55296
    ds_read_b128 v[48:51], v5 offset:6144
    ds_read_b128 v[52:55], v5 offset:22528
    ds_read_b128 v[56:59], v5 offset:38912
    ds_read_b128 v[60:63], v5 offset:55296
    s_waitcnt vmcnt(8) lgkmcnt(8)
    v_mfma_f32_16x16x32_bf16 a[0:3], v[128:131], v[64:67], a[0:3]
    v_mfma_f32_16x16x32_bf16 a[4:7], v[132:135], v[64:67], a[4:7]
    v_mfma_f32_16x16x32_bf16 a[8:11], v[136:139], v[64:67], a[8:11]
    v_mfma_f32_16x16x32_bf16 a[12:15], v[140:143], v[64:67], a[12:15]
    v_mfma_f32_16x16x32_bf16 a[16:19], v[128:131], v[68:71], a[16:19]
    v_mfma_f32_16x16x32_bf16 a[20:23], v[132:135], v[68:71], a[20:23]
    v_mfma_f32_16x16x32_bf16 a[24:27], v[136:139], v[68:71], a[24:27]
    v_mfma_f32_16x16x32_bf16 a[28:31], v[140:143], v[68:71], a[28:31]
    v_mfma_f32_16x16x32_bf16 a[32:35], v[128:131], v[72:75], a[32:35]
    v_mfma_f32_16x16x32_bf16 a[36:39], v[132:135], v[72:75], a[36:39]
    v_mfma_f32_16x16x32_bf16 a[40:43], v[136:139], v[72:75], a[40:43]
    v_mfma_f32_16x16x32_bf16 a[44:47], v[140:143], v[72:75], a[44:47]
    v_mfma_f32_16x16x32_bf16 a[48:51], v[128:131], v[76:79], a[48:51]
    v_mfma_f32_16x16x32_bf16 a[52:55], v[132:135], v[76:79], a[52:55]
    v_mfma_f32_16x16x32_bf16 a[56:59], v[136:139], v[76:79], a[56:59]
    v_mfma_f32_16x16x32_bf16 a[60:63], v[140:143], v[76:79], a[60:63]
    v_mfma_f32_16x16x32_bf16 a[64:67], v[128:131], v[80:83], a[64:67]
    v_mfma_f32_16x16x32_bf16 a[68:71], v[132:135], v[80:83], a[68:71]
    v_mfma_f32_16x16x32_bf16 a[72:75], v[136:139], v[80:83], a[72:75]
    v_mfma_f32_16x16x32_bf16 a[76:79], v[140:143], v[80:83], a[76:79]
    v_mfma_f32_16x16x32_bf16 a[80:83], v[128:131], v[84:87], a[80:83]
    v_mfma_f32_16x16x32_bf16 a[84:87], v[132:135], v[84:87], a[84:87]
    v_mfma_f32_16x16x32_bf16 a[88:91], v[136:139], v[84:87], a[88:91]
    v_mfma_f32_16x16x32_bf16 a[92:95], v[140:143], v[84:87], a[92:95]
    v_mfma_f32_16x16x32_bf16 a[96:99], v[128:131], v[88:91], a[96:99]
    v_mfma_f32_16x16x32_bf16 a[100:103], v[132:135], v[88:91], a[100:103]
    v_mfma_f32_16x16x32_bf16 a[104:107], v[136:139], v[88:91], a[104:107]
    v_mfma_f32_16x16x32_bf16 a[108:111], v[140:143], v[88:91], a[108:111]
    v_mfma_f32_16x16x32_bf16 a[112:115], v[128:131], v[92:95], a[112:115]
    v_mfma_f32_16x16x32_bf16 a[116:119], v[132:135], v[92:95], a[116:119]
    v_mfma_f32_16x16x32_bf16 a[120:123], v[136:139], v[92:95], a[120:123]
    v_mfma_f32_16x16x32_bf16 a[124:127], v[140:143], v[92:95], a[124:127]
    s_add_u32 s14, s14, 4096
    buffer_load_dwordx4 v[128:131], v8, s[40:43], s14 offen offset:0
    buffer_load_dwordx4 v[132:135], v9, s[40:43], s14 offen offset:0
    buffer_load_dwordx4 v[136:139], v10, s[40:43], s14 offen offset:0
    buffer_load_dwordx4 v[140:143], v11, s[40:43], s14 offen offset:0
    ds_read_b128 v[64:67], v4 offset:7168
    ds_read_b128 v[68:71], v4 offset:23552
    ds_read_b128 v[72:75], v4 offset:39936
    ds_read_b128 v[76:79], v4 offset:56320
    ds_read_b128 v[80:83], v5 offset:7168
    ds_read_b128 v[84:87], v5 offset:23552
    ds_read_b128 v[88:91], v5 offset:39936
    ds_read_b128 v[92:95], v5 offset:56320
    s_waitcnt vmcnt(8) lgkmcnt(8)
    v_mfma_f32_16x16x32_bf16 a[0:3], v[96:99], v[32:35], a[0:3]
    v_mfma_f32_16x16x32_bf16 a[4:7], v[100:103], v[32:35], a[4:7]
    v_mfma_f32_16x16x32_bf16 a[8:11], v[104:107], v[32:35], a[8:11]
    v_mfma_f32_16x16x32_bf16 a[12:15], v[108:111], v[32:35], a[12:15]
    v_mfma_f32_16x16x32_bf16 a[16:19], v[96:99], v[36:39], a[16:19]
    v_mfma_f32_16x16x32_bf16 a[20:23], v[100:103], v[36:39], a[20:23]
    v_mfma_f32_16x16x32_bf16 a[24:27], v[104:107], v[36:39], a[24:27]
    v_mfma_f32_16x16x32_bf16 a[28:31], v[108:111], v[36:39], a[28:31]
    v_mfma_f32_16x16x32_bf16 a[32:35], v[96:99], v[40:43], a[32:35]
    v_mfma_f32_16x16x32_bf16 a[36:39], v[100:103], v[40:43], a[36:39]
    v_mfma_f32_16x16x32_bf16 a[40:43], v[104:107], v[40:43], a[40:43]
    v_mfma_f32_16x16x32_bf16 a[44:47], v[108:111], v[40:43], a[44:47]
    v_mfma_f32_16x16x32_bf16 a[48:51], v[96:99], v[44:47], a[48:51]
    v_mfma_f32_16x16x32_bf16 a[52:55], v[100:103], v[44:47], a[52:55]
    v_mfma_f32_16x16x32_bf16 a[56:59], v[104:107], v[44:47], a[56:59]
    v_mfma_f32_16x16x32_bf16 a[60:63], v[108:111], v[44:47], a[60:63]
    v_mfma_f32_16x16x32_bf16 a[64:67], v[96:99], v[48:51], a[64:67]
    v_mfma_f32_16x16x32_bf16 a[68:71], v[100:103], v[48:51], a[68:71]
    v_mfma_f32_16x16x32_bf16 a[72:75], v[104:107], v[48:51], a[72:75]
    v_mfma_f32_16x16x32_bf16 a[76:79], v[108:111], v[48:51], a[76:79]
    v_mfma_f32_16x16x32_bf16 a[80:83], v[96:99], v[52:55], a[80:83]
    v_mfma_f32_16x16x32_bf16 a[84:87], v[100:103], v[52:55], a[84:87]
    v_mfma_f32_16x16x32_bf16 a[88:91], v[104:107], v[52:55], a[88:91]
    v_mfma_f32_16x16x32_bf16 a[92:95], v[108:111], v[52:55], a[92:95]
    v_mfma_f32_16x16x32_bf16 a[96:99], v[96:99], v[56:59], a[96:99]
    v_mfma_f32_16x16x32_bf16 a[100:103], v[100:103], v[56:59], a[100:103]
    v_mfma_f32_16x16x32_bf16 a[104:107], v[104:107], v[56:59], a[104:107]
    v_mfma_f32_16x16x32_bf16 a[108:111], v[108:111], v[56:59], a[108:111]
    v_mfma_f32_16x16x32_bf16 a[112:115], v[96:99], v[60:63], a[112:115]
    v_mfma_f32_16x16x32_bf16 a[116:119], v[100:103], v[60:63], a[116:119]
    v_mfma_f32_16x16x32_bf16 a[120:123], v[104:107], v[60:63], a[120:123]
    v_mfma_f32_16x16x32_bf16 a[124:127], v[108:111], v[60:63], a[124:127]
    buffer_load_dwordx4 v[96:99], v8, s[40:43], s14 offen offset:1024
    buffer_load_dwordx4 v[100:103], v9, s[40:43], s14 offen offset:1024
    buffer_load_dwordx4 v[104:107], v10, s[40:43], s14 offen offset:1024
    buffer_load_dwordx4 v[108:111], v11, s[40:43], s14 offen offset:1024
    ds_read_b128 v[32:35], v4 offset:8192
    ds_read_b128 v[36:39], v4 offset:24576
    ds_read_b128 v[40:43], v4 offset:40960
    ds_read_b128 v[44:47], v4 offset:57344
    ds_read_b128 v[48:51], v5 offset:8192
    ds_read_b128 v[52:55], v5 offset:24576
    ds_read_b128 v[56:59], v5 offset:40960
    ds_read_b128 v[60:63], v5 offset:57344
    s_waitcnt vmcnt(8) lgkmcnt(8)
    v_mfma_f32_16x16x32_bf16 a[0:3], v[112:115], v[64:67], a[0:3]
    v_mfma_f32_16x16x32_bf16 a[4:7], v[116:119], v[64:67], a[4:7]
    v_mfma_f32_16x16x32_bf16 a[8:11], v[120:123], v[64:67], a[8:11]
    v_mfma_f32_16x16x32_bf16 a[12:15], v[124:127], v[64:67], a[12:15]
    v_mfma_f32_16x16x32_bf16 a[16:19], v[112:115], v[68:71], a[16:19]
    v_mfma_f32_16x16x32_bf16 a[20:23], v[116:119], v[68:71], a[20:23]
    v_mfma_f32_16x16x32_bf16 a[24:27], v[120:123], v[68:71], a[24:27]
    v_mfma_f32_16x16x32_bf16 a[28:31], v[124:127], v[68:71], a[28:31]
    v_mfma_f32_16x16x32_bf16 a[32:35], v[112:115], v[72:75], a[32:35]
    v_mfma_f32_16x16x32_bf16 a[36:39], v[116:119], v[72:75], a[36:39]
    v_mfma_f32_16x16x32_bf16 a[40:43], v[120:123], v[72:75], a[40:43]
    v_mfma_f32_16x16x32_bf16 a[44:47], v[124:127], v[72:75], a[44:47]
    v_mfma_f32_16x16x32_bf16 a[48:51], v[112:115], v[76:79], a[48:51]
    v_mfma_f32_16x16x32_bf16 a[52:55], v[116:119], v[76:79], a[52:55]
    v_mfma_f32_16x16x32_bf16 a[56:59], v[120:123], v[76:79], a[56:59]
    v_mfma_f32_16x16x32_bf16 a[60:63], v[124:127], v[76:79], a[60:63]
    v_mfma_f32_16x16x32_bf16 a[64:67], v[112:115], v[80:83], a[64:67]
    v_mfma_f32_16x16x32_bf16 a[68:71], v[116:119], v[80:83], a[68:71]
    v_mfma_f32_16x16x32_bf16 a[72:75], v[120:123], v[80:83], a[72:75]
    v_mfma_f32_16x16x32_bf16 a[76:79], v[124:127], v[80:83], a[76:79]
    v_mfma_f32_16x16x32_bf16 a[80:83], v[112:115], v[84:87], a[80:83]
    v_mfma_f32_16x16x32_bf16 a[84:87], v[116:119], v[84:87], a[84:87]
    v_mfma_f32_16x16x32_bf16 a[88:91], v[120:123], v[84:87], a[88:91]
    v_mfma_f32_16x16x32_bf16 a[92:95], v[124:127], v[84:87], a[92:95]
    v_mfma_f32_16x16x32_bf16 a[96:99], v[112:115], v[88:91], a[96:99]
    v_mfma_f32_16x16x32_bf16 a[100:103], v[116:119], v[88:91], a[100:103]
    v_mfma_f32_16x16x32_bf16 a[104:107], v[120:123], v[88:91], a[104:107]
    v_mfma_f32_16x16x32_bf16 a[108:111], v[124:127], v[88:91], a[108:111]
    v_mfma_f32_16x16x32_bf16 a[112:115], v[112:115], v[92:95], a[112:115]
    v_mfma_f32_16x16x32_bf16 a[116:119], v[116:119], v[92:95], a[116:119]
    v_mfma_f32_16x16x32_bf16 a[120:123], v[120:123], v[92:95], a[120:123]
    v_mfma_f32_16x16x32_bf16 a[124:127], v[124:127], v[92:95], a[124:127]
    buffer_load_dwordx4 v[112:115], v8, s[40:43], s14 offen offset:2048
    buffer_load_dwordx4 v[116:119], v9, s[40:43], s14 offen offset:2048
    buffer_load_dwordx4 v[120:123], v10, s[40:43], s14 offen offset:2048
    buffer_load_dwordx4 v[124:127], v11, s[40:43], s14 offen offset:2048
    ds_read_b128 v[64:67], v4 offset:9216
    ds_read_b128 v[68:71], v4 offset:25600
    ds_read_b128 v[72:75], v4 offset:41984
    ds_read_b128 v[76:79], v4 offset:58368
    ds_read_b128 v[80:83], v5 offset:9216
    ds_read_b128 v[84:87], v5 offset:25600
    ds_read_b128 v[88:91], v5 offset:41984
    ds_read_b128 v[92:95], v5 offset:58368
    s_waitcnt vmcnt(8) lgkmcnt(8)
    v_mfma_f32_16x16x32_bf16 a[0:3], v[128:131], v[32:35], a[0:3]
    v_mfma_f32_16x16x32_bf16 a[4:7], v[132:135], v[32:35], a[4:7]
    v_mfma_f32_16x16x32_bf16 a[8:11], v[136:139], v[32:35], a[8:11]
    v_mfma_f32_16x16x32_bf16 a[12:15], v[140:143], v[32:35], a[12:15]
    v_mfma_f32_16x16x32_bf16 a[16:19], v[128:131], v[36:39], a[16:19]
    v_mfma_f32_16x16x32_bf16 a[20:23], v[132:135], v[36:39], a[20:23]
    v_mfma_f32_16x16x32_bf16 a[24:27], v[136:139], v[36:39], a[24:27]
    v_mfma_f32_16x16x32_bf16 a[28:31], v[140:143], v[36:39], a[28:31]
    v_mfma_f32_16x16x32_bf16 a[32:35], v[128:131], v[40:43], a[32:35]
    v_mfma_f32_16x16x32_bf16 a[36:39], v[132:135], v[40:43], a[36:39]
    v_mfma_f32_16x16x32_bf16 a[40:43], v[136:139], v[40:43], a[40:43]
    v_mfma_f32_16x16x32_bf16 a[44:47], v[140:143], v[40:43], a[44:47]
    v_mfma_f32_16x16x32_bf16 a[48:51], v[128:131], v[44:47], a[48:51]
    v_mfma_f32_16x16x32_bf16 a[52:55], v[132:135], v[44:47], a[52:55]
    v_mfma_f32_16x16x32_bf16 a[56:59], v[136:139], v[44:47], a[56:59]
    v_mfma_f32_16x16x32_bf16 a[60:63], v[140:143], v[44:47], a[60:63]
    v_mfma_f32_16x16x32_bf16 a[64:67], v[128:131], v[48:51], a[64:67]
    v_mfma_f32_16x16x32_bf16 a[68:71], v[132:135], v[48:51], a[68:71]
    v_mfma_f32_16x16x32_bf16 a[72:75], v[136:139], v[48:51], a[72:75]
    v_mfma_f32_16x16x32_bf16 a[76:79], v[140:143], v[48:51], a[76:79]
    v_mfma_f32_16x16x32_bf16 a[80:83], v[128:131], v[52:55], a[80:83]
    v_mfma_f32_16x16x32_bf16 a[84:87], v[132:135], v[52:55], a[84:87]
    v_mfma_f32_16x16x32_bf16 a[88:91], v[136:139], v[52:55], a[88:91]
    v_mfma_f32_16x16x32_bf16 a[92:95], v[140:143], v[52:55], a[92:95]
    v_mfma_f32_16x16x32_bf16 a[96:99], v[128:131], v[56:59], a[96:99]
    v_mfma_f32_16x16x32_bf16 a[100:103], v[132:135], v[56:59], a[100:103]
    v_mfma_f32_16x16x32_bf16 a[104:107], v[136:139], v[56:59], a[104:107]
    v_mfma_f32_16x16x32_bf16 a[108:111], v[140:143], v[56:59], a[108:111]
    v_mfma_f32_16x16x32_bf16 a[112:115], v[128:131], v[60:63], a[112:115]
    v_mfma_f32_16x16x32_bf16 a[116:119], v[132:135], v[60:63], a[116:119]
    v_mfma_f32_16x16x32_bf16 a[120:123], v[136:139], v[60:63], a[120:123]
    v_mfma_f32_16x16x32_bf16 a[124:127], v[140:143], v[60:63], a[124:127]
    buffer_load_dwordx4 v[128:131], v8, s[40:43], s14 offen offset:3072
    buffer_load_dwordx4 v[132:135], v9, s[40:43], s14 offen offset:3072
    buffer_load_dwordx4 v[136:139], v10, s[40:43], s14 offen offset:3072
    buffer_load_dwordx4 v[140:143], v11, s[40:43], s14 offen offset:3072
    ds_read_b128 v[32:35], v4 offset:10240
    ds_read_b128 v[36:39], v4 offset:26624
    ds_read_b128 v[40:43], v4 offset:43008
    ds_read_b128 v[44:47], v4 offset:59392
    ds_read_b128 v[48:51], v5 offset:10240
    ds_read_b128 v[52:55], v5 offset:26624
    ds_read_b128 v[56:59], v5 offset:43008
    ds_read_b128 v[60:63], v5 offset:59392
    s_waitcnt vmcnt(8) lgkmcnt(8)
    v_mfma_f32_16x16x32_bf16 a[0:3], v[96:99], v[64:67], a[0:3]
    v_mfma_f32_16x16x32_bf16 a[4:7], v[100:103], v[64:67], a[4:7]
    v_mfma_f32_16x16x32_bf16 a[8:11], v[104:107], v[64:67], a[8:11]
    v_mfma_f32_16x16x32_bf16 a[12:15], v[108:111], v[64:67], a[12:15]
    v_mfma_f32_16x16x32_bf16 a[16:19], v[96:99], v[68:71], a[16:19]
    v_mfma_f32_16x16x32_bf16 a[20:23], v[100:103], v[68:71], a[20:23]
    v_mfma_f32_16x16x32_bf16 a[24:27], v[104:107], v[68:71], a[24:27]
    v_mfma_f32_16x16x32_bf16 a[28:31], v[108:111], v[68:71], a[28:31]
    v_mfma_f32_16x16x32_bf16 a[32:35], v[96:99], v[72:75], a[32:35]
    v_mfma_f32_16x16x32_bf16 a[36:39], v[100:103], v[72:75], a[36:39]
    v_mfma_f32_16x16x32_bf16 a[40:43], v[104:107], v[72:75], a[40:43]
    v_mfma_f32_16x16x32_bf16 a[44:47], v[108:111], v[72:75], a[44:47]
    v_mfma_f32_16x16x32_bf16 a[48:51], v[96:99], v[76:79], a[48:51]
    v_mfma_f32_16x16x32_bf16 a[52:55], v[100:103], v[76:79], a[52:55]
    v_mfma_f32_16x16x32_bf16 a[56:59], v[104:107], v[76:79], a[56:59]
    v_mfma_f32_16x16x32_bf16 a[60:63], v[108:111], v[76:79], a[60:63]
    v_mfma_f32_16x16x32_bf16 a[64:67], v[96:99], v[80:83], a[64:67]
    v_mfma_f32_16x16x32_bf16 a[68:71], v[100:103], v[80:83], a[68:71]
    v_mfma_f32_16x16x32_bf16 a[72:75], v[104:107], v[80:83], a[72:75]
    v_mfma_f32_16x16x32_bf16 a[76:79], v[108:111], v[80:83], a[76:79]
    v_mfma_f32_16x16x32_bf16 a[80:83], v[96:99], v[84:87], a[80:83]
    v_mfma_f32_16x16x32_bf16 a[84:87], v[100:103], v[84:87], a[84:87]
    v_mfma_f32_16x16x32_bf16 a[88:91], v[104:107], v[84:87], a[88:91]
    v_mfma_f32_16x16x32_bf16 a[92:95], v[108:111], v[84:87], a[92:95]
    v_mfma_f32_16x16x32_bf16 a[96:99], v[96:99], v[88:91], a[96:99]
    v_mfma_f32_16x16x32_bf16 a[100:103], v[100:103], v[88:91], a[100:103]
    v_mfma_f32_16x16x32_bf16 a[104:107], v[104:107], v[88:91], a[104:107]
    v_mfma_f32_16x16x32_bf16 a[108:111], v[108:111], v[88:91], a[108:111]
    v_mfma_f32_16x16x32_bf16 a[112:115], v[96:99], v[92:95], a[112:115]
    v_mfma_f32_16x16x32_bf16 a[116:119], v[100:103], v[92:95], a[116:119]
    v_mfma_f32_16x16x32_bf16 a[120:123], v[104:107], v[92:95], a[120:123]
    v_mfma_f32_16x16x32_bf16 a[124:127], v[108:111], v[92:95], a[124:127]
    s_add_u32 s14, s14, 4096
    buffer_load_dwordx4 v[96:99], v8, s[40:43], s14 offen offset:0
    buffer_load_dwordx4 v[100:103], v9, s[40:43], s14 offen offset:0
    buffer_load_dwordx4 v[104:107], v10, s[40:43], s14 offen offset:0
    buffer_load_dwordx4 v[108:111], v11, s[40:43], s14 offen offset:0
    ds_read_b128 v[64:67], v4 offset:11264
    ds_read_b128 v[68:71], v4 offset:27648
    ds_read_b128 v[72:75], v4 offset:44032
    ds_read_b128 v[76:79], v4 offset:60416
    ds_read_b128 v[80:83], v5 offset:11264
    ds_read_b128 v[84:87], v5 offset:27648
    ds_read_b128 v[88:91], v5 offset:44032
    ds_read_b128 v[92:95], v5 offset:60416
    s_waitcnt vmcnt(8) lgkmcnt(8)
    v_mfma_f32_16x16x32_bf16 a[0:3], v[112:115], v[32:35], a[0:3]
    v_mfma_f32_16x16x32_bf16 a[4:7], v[116:119], v[32:35], a[4:7]
    v_mfma_f32_16x16x32_bf16 a[8:11], v[120:123], v[32:35], a[8:11]
    v_mfma_f32_16x16x32_bf16 a[12:15], v[124:127], v[32:35], a[12:15]
    v_mfma_f32_16x16x32_bf16 a[16:19], v[112:115], v[36:39], a[16:19]
    v_mfma_f32_16x16x32_bf16 a[20:23], v[116:119], v[36:39], a[20:23]
    v_mfma_f32_16x16x32_bf16 a[24:27], v[120:123], v[36:39], a[24:27]
    v_mfma_f32_16x16x32_bf16 a[28:31], v[124:127], v[36:39], a[28:31]
    v_mfma_f32_16x16x32_bf16 a[32:35], v[112:115], v[40:43], a[32:35]
    v_mfma_f32_16x16x32_bf16 a[36:39], v[116:119], v[40:43], a[36:39]
    v_mfma_f32_16x16x32_bf16 a[40:43], v[120:123], v[40:43], a[40:43]
    v_mfma_f32_16x16x32_bf16 a[44:47], v[124:127], v[40:43], a[44:47]
    v_mfma_f32_16x16x32_bf16 a[48:51], v[112:115], v[44:47], a[48:51]
    v_mfma_f32_16x16x32_bf16 a[52:55], v[116:119], v[44:47], a[52:55]
    v_mfma_f32_16x16x32_bf16 a[56:59], v[120:123], v[44:47], a[56:59]
    v_mfma_f32_16x16x32_bf16 a[60:63], v[124:127], v[44:47], a[60:63]
    v_mfma_f32_16x16x32_bf16 a[64:67], v[112:115], v[48:51], a[64:67]
    v_mfma_f32_16x16x32_bf16 a[68:71], v[116:119], v[48:51], a[68:71]
    v_mfma_f32_16x16x32_bf16 a[72:75], v[120:123], v[48:51], a[72:75]
    v_mfma_f32_16x16x32_bf16 a[76:79], v[124:127], v[48:51], a[76:79]
    v_mfma_f32_16x16x32_bf16 a[80:83], v[112:115], v[52:55], a[80:83]
    v_mfma_f32_16x16x32_bf16 a[84:87], v[116:119], v[52:55], a[84:87]
    v_mfma_f32_16x16x32_bf16 a[88:91], v[120:123], v[52:55], a[88:91]
    v_mfma_f32_16x16x32_bf16 a[92:95], v[124:127], v[52:55], a[92:95]
    v_mfma_f32_16x16x32_bf16 a[96:99], v[112:115], v[56:59], a[96:99]
    v_mfma_f32_16x16x32_bf16 a[100:103], v[116:119], v[56:59], a[100:103]
    v_mfma_f32_16x16x32_bf16 a[104:107], v[120:123], v[56:59], a[104:107]
    v_mfma_f32_16x16x32_bf16 a[108:111], v[124:127], v[56:59], a[108:111]
    v_mfma_f32_16x16x32_bf16 a[112:115], v[112:115], v[60:63], a[112:115]
    v_mfma_f32_16x16x32_bf16 a[116:119], v[116:119], v[60:63], a[116:119]
    v_mfma_f32_16x16x32_bf16 a[120:123], v[120:123], v[60:63], a[120:123]
    v_mfma_f32_16x16x32_bf16 a[124:127], v[124:127], v[60:63], a[124:127]
    buffer_load_dwordx4 v[112:115], v8, s[40:43], s14 offen offset:1024
    buffer_load_dwordx4 v[116:119], v9, s[40:43], s14 offen offset:1024
    buffer_load_dwordx4 v[120:123], v10, s[40:43], s14 offen offset:1024
    buffer_load_dwordx4 v[124:127], v11, s[40:43], s14 offen offset:1024
    ds_read_b128 v[32:35], v4 offset:12288
    ds_read_b128 v[36:39], v4 offset:28672
    ds_read_b128 v[40:43], v4 offset:45056
    ds_read_b128 v[44:47], v4 offset:61440
    ds_read_b128 v[48:51], v5 offset:12288
    ds_read_b128 v[52:55], v5 offset:28672
    ds_read_b128 v[56:59], v5 offset:45056
    ds_read_b128 v[60:63], v5 offset:61440
    s_waitcnt vmcnt(8) lgkmcnt(8)
    v_mfma_f32_16x16x32_bf16 a[0:3], v[128:131], v[64:67], a[0:3]
    v_mfma_f32_16x16x32_bf16 a[4:7], v[132:135], v[64:67], a[4:7]
    v_mfma_f32_16x16x32_bf16 a[8:11], v[136:139], v[64:67], a[8:11]
    v_mfma_f32_16x16x32_bf16 a[12:15], v[140:143], v[64:67], a[12:15]
    v_mfma_f32_16x16x32_bf16 a[16:19], v[128:131], v[68:71], a[16:19]
    v_mfma_f32_16x16x32_bf16 a[20:23], v[132:135], v[68:71], a[20:23]
    v_mfma_f32_16x16x32_bf16 a[24:27], v[136:139], v[68:71], a[24:27]
    v_mfma_f32_16x16x32_bf16 a[28:31], v[140:143], v[68:71], a[28:31]
    v_mfma_f32_16x16x32_bf16 a[32:35], v[128:131], v[72:75], a[32:35]
    v_mfma_f32_16x16x32_bf16 a[36:39], v[132:135], v[72:75], a[36:39]
    v_mfma_f32_16x16x32_bf16 a[40:43], v[136:139], v[72:75], a[40:43]
    v_mfma_f32_16x16x32_bf16 a[44:47], v[140:143], v[72:75], a[44:47]
    v_mfma_f32_16x16x32_bf16 a[48:51], v[128:131], v[76:79], a[48:51]
    v_mfma_f32_16x16x32_bf16 a[52:55], v[132:135], v[76:79], a[52:55]
    v_mfma_f32_16x16x32_bf16 a[56:59], v[136:139], v[76:79], a[56:59]
    v_mfma_f32_16x16x32_bf16 a[60:63], v[140:143], v[76:79], a[60:63]
    v_mfma_f32_16x16x32_bf16 a[64:67], v[128:131], v[80:83], a[64:67]
    v_mfma_f32_16x16x32_bf16 a[68:71], v[132:135], v[80:83], a[68:71]
    v_mfma_f32_16x16x32_bf16 a[72:75], v[136:139], v[80:83], a[72:75]
    v_mfma_f32_16x16x32_bf16 a[76:79], v[140:143], v[80:83], a[76:79]
    v_mfma_f32_16x16x32_bf16 a[80:83], v[128:131], v[84:87], a[80:83]
    v_mfma_f32_16x16x32_bf16 a[84:87], v[132:135], v[84:87], a[84:87]
    v_mfma_f32_16x16x32_bf16 a[88:91], v[136:139], v[84:87], a[88:91]
    v_mfma_f32_16x16x32_bf16 a[92:95], v[140:143], v[84:87], a[92:95]
    v_mfma_f32_16x16x32_bf16 a[96:99], v[128:131], v[88:91], a[96:99]
    v_mfma_f32_16x16x32_bf16 a[100:103], v[132:135], v[88:91], a[100:103]
    v_mfma_f32_16x16x32_bf16 a[104:107], v[136:139], v[88:91], a[104:107]
    v_mfma_f32_16x16x32_bf16 a[108:111], v[140:143], v[88:91], a[108:111]
    v_mfma_f32_16x16x32_bf16 a[112:115], v[128:131], v[92:95], a[112:115]
    v_mfma_f32_16x16x32_bf16 a[116:119], v[132:135], v[92:95], a[116:119]
    v_mfma_f32_16x16x32_bf16 a[120:123], v[136:139], v[92:95], a[120:123]
    v_mfma_f32_16x16x32_bf16 a[124:127], v[140:143], v[92:95], a[124:127]
    buffer_load_dwordx4 v[128:131], v8, s[40:43], s14 offen offset:2048
    buffer_load_dwordx4 v[132:135], v9, s[40:43], s14 offen offset:2048
    buffer_load_dwordx4 v[136:139], v10, s[40:43], s14 offen offset:2048
    buffer_load_dwordx4 v[140:143], v11, s[40:43], s14 offen offset:2048
    ds_read_b128 v[64:67], v4 offset:13312
    ds_read_b128 v[68:71], v4 offset:29696
    ds_read_b128 v[72:75], v4 offset:46080
    ds_read_b128 v[76:79], v4 offset:62464
    ds_read_b128 v[80:83], v5 offset:13312
    ds_read_b128 v[84:87], v5 offset:29696
    ds_read_b128 v[88:91], v5 offset:46080
    ds_read_b128 v[92:95], v5 offset:62464
    s_waitcnt vmcnt(8) lgkmcnt(8)
    v_mfma_f32_16x16x32_bf16 a[0:3], v[96:99], v[32:35], a[0:3]
    v_mfma_f32_16x16x32_bf16 a[4:7], v[100:103], v[32:35], a[4:7]
    v_mfma_f32_16x16x32_bf16 a[8:11], v[104:107], v[32:35], a[8:11]
    v_mfma_f32_16x16x32_bf16 a[12:15], v[108:111], v[32:35], a[12:15]
    v_mfma_f32_16x16x32_bf16 a[16:19], v[96:99], v[36:39], a[16:19]
    v_mfma_f32_16x16x32_bf16 a[20:23], v[100:103], v[36:39], a[20:23]
    v_mfma_f32_16x16x32_bf16 a[24:27], v[104:107], v[36:39], a[24:27]
    v_mfma_f32_16x16x32_bf16 a[28:31], v[108:111], v[36:39], a[28:31]
    v_mfma_f32_16x16x32_bf16 a[32:35], v[96:99], v[40:43], a[32:35]
    v_mfma_f32_16x16x32_bf16 a[36:39], v[100:103], v[40:43], a[36:39]
    v_mfma_f32_16x16x32_bf16 a[40:43], v[104:107], v[40:43], a[40:43]
    v_mfma_f32_16x16x32_bf16 a[44:47], v[108:111], v[40:43], a[44:47]
    v_mfma_f32_16x16x32_bf16 a[48:51], v[96:99], v[44:47], a[48:51]
    v_mfma_f32_16x16x32_bf16 a[52:55], v[100:103], v[44:47], a[52:55]
    v_mfma_f32_16x16x32_bf16 a[56:59], v[104:107], v[44:47], a[56:59]
    v_mfma_f32_16x16x32_bf16 a[60:63], v[108:111], v[44:47], a[60:63]
    v_mfma_f32_16x16x32_bf16 a[64:67], v[96:99], v[48:51], a[64:67]
    v_mfma_f32_16x16x32_bf16 a[68:71], v[100:103], v[48:51], a[68:71]
    v_mfma_f32_16x16x32_bf16 a[72:75], v[104:107], v[48:51], a[72:75]
    v_mfma_f32_16x16x32_bf16 a[76:79], v[108:111], v[48:51], a[76:79]
    v_mfma_f32_16x16x32_bf16 a[80:83], v[96:99], v[52:55], a[80:83]
    v_mfma_f32_16x16x32_bf16 a[84:87], v[100:103], v[52:55], a[84:87]
    v_mfma_f32_16x16x32_bf16 a[88:91], v[104:107], v[52:55], a[88:91]
    v_mfma_f32_16x16x32_bf16 a[92:95], v[108:111], v[52:55], a[92:95]
    v_mfma_f32_16x16x32_bf16 a[96:99], v[96:99], v[56:59], a[96:99]
    v_mfma_f32_16x16x32_bf16 a[100:103], v[100:103], v[56:59], a[100:103]
    v_mfma_f32_16x16x32_bf16 a[104:107], v[104:107], v[56:59], a[104:107]
    v_mfma_f32_16x16x32_bf16 a[108:111], v[108:111], v[56:59], a[108:111]
    v_mfma_f32_16x16x32_bf16 a[112:115], v[96:99], v[60:63], a[112:115]
    v_mfma_f32_16x16x32_bf16 a[116:119], v[100:103], v[60:63], a[116:119]
    v_mfma_f32_16x16x32_bf16 a[120:123], v[104:107], v[60:63], a[120:123]
    v_mfma_f32_16x16x32_bf16 a[124:127], v[108:111], v[60:63], a[124:127]
    buffer_load_dwordx4 v[96:99], v8, s[40:43], s14 offen offset:3072
    buffer_load_dwordx4 v[100:103], v9, s[40:43], s14 offen offset:3072
    buffer_load_dwordx4 v[104:107], v10, s[40:43], s14 offen offset:3072
    buffer_load_dwordx4 v[108:111], v11, s[40:43], s14 offen offset:3072
    ds_read_b128 v[32:35], v4 offset:14336
    ds_read_b128 v[36:39], v4 offset:30720
    ds_read_b128 v[40:43], v4 offset:47104
    ds_read_b128 v[44:47], v4 offset:63488
    ds_read_b128 v[48:51], v5 offset:14336
    ds_read_b128 v[52:55], v5 offset:30720
    ds_read_b128 v[56:59], v5 offset:47104
    ds_read_b128 v[60:63], v5 offset:63488
    s_waitcnt vmcnt(8) lgkmcnt(8)
    v_mfma_f32_16x16x32_bf16 a[0:3], v[112:115], v[64:67], a[0:3]
    v_mfma_f32_16x16x32_bf16 a[4:7], v[116:119], v[64:67], a[4:7]
    v_mfma_f32_16x16x32_bf16 a[8:11], v[120:123], v[64:67], a[8:11]
    v_mfma_f32_16x16x32_bf16 a[12:15], v[124:127], v[64:67], a[12:15]
    v_mfma_f32_16x16x32_bf16 a[16:19], v[112:115], v[68:71], a[16:19]
    v_mfma_f32_16x16x32_bf16 a[20:23], v[116:119], v[68:71], a[20:23]
    v_mfma_f32_16x16x32_bf16 a[24:27], v[120:123], v[68:71], a[24:27]
    v_mfma_f32_16x16x32_bf16 a[28:31], v[124:127], v[68:71], a[28:31]
    v_mfma_f32_16x16x32_bf16 a[32:35], v[112:115], v[72:75], a[32:35]
    v_mfma_f32_16x16x32_bf16 a[36:39], v[116:119], v[72:75], a[36:39]
    v_mfma_f32_16x16x32_bf16 a[40:43], v[120:123], v[72:75], a[40:43]
    v_mfma_f32_16x16x32_bf16 a[44:47], v[124:127], v[72:75], a[44:47]
    v_mfma_f32_16x16x32_bf16 a[48:51], v[112:115], v[76:79], a[48:51]
    v_mfma_f32_16x16x32_bf16 a[52:55], v[116:119], v[76:79], a[52:55]
    v_mfma_f32_16x16x32_bf16 a[56:59], v[120:123], v[76:79], a[56:59]
    v_mfma_f32_16x16x32_bf16 a[60:63], v[124:127], v[76:79], a[60:63]
    v_mfma_f32_16x16x32_bf16 a[64:67], v[112:115], v[80:83], a[64:67]
    v_mfma_f32_16x16x32_bf16 a[68:71], v[116:119], v[80:83], a[68:71]
    v_mfma_f32_16x16x32_bf16 a[72:75], v[120:123], v[80:83], a[72:75]
    v_mfma_f32_16x16x32_bf16 a[76:79], v[124:127], v[80:83], a[76:79]
    v_mfma_f32_16x16x32_bf16 a[80:83], v[112:115], v[84:87], a[80:83]
    v_mfma_f32_16x16x32_bf16 a[84:87], v[116:119], v[84:87], a[84:87]
    v_mfma_f32_16x16x32_bf16 a[88:91], v[120:123], v[84:87], a[88:91]
    v_mfma_f32_16x16x32_bf16 a[92:95], v[124:127], v[84:87], a[92:95]
    v_mfma_f32_16x16x32_bf16 a[96:99], v[112:115], v[88:91], a[96:99]
    v_mfma_f32_16x16x32_bf16 a[100:103], v[116:119], v[88:91], a[100:103]
    v_mfma_f32_16x16x32_bf16 a[104:107], v[120:123], v[88:91], a[104:107]
    v_mfma_f32_16x16x32_bf16 a[108:111], v[124:127], v[88:91], a[108:111]
    v_mfma_f32_16x16x32_bf16 a[112:115], v[112:115], v[92:95], a[112:115]
    v_mfma_f32_16x16x32_bf16 a[116:119], v[116:119], v[92:95], a[116:119]
    v_mfma_f32_16x16x32_bf16 a[120:123], v[120:123], v[92:95], a[120:123]
    v_mfma_f32_16x16x32_bf16 a[124:127], v[124:127], v[92:95], a[124:127]
    ds_read_b128 v[64:67], v4 offset:15360
    ds_read_b128 v[68:71], v4 offset:31744
    ds_read_b128 v[72:75], v4 offset:48128
    ds_read_b128 v[76:79], v4 offset:64512
    ds_read_b128 v[80:83], v5 offset:15360
    ds_read_b128 v[84:87], v5 offset:31744
    ds_read_b128 v[88:91], v5 offset:48128
    ds_read_b128 v[92:95], v5 offset:64512
    s_waitcnt vmcnt(4) lgkmcnt(8)
    v_mfma_f32_16x16x32_bf16 a[0:3], v[128:131], v[32:35], a[0:3]
    v_mfma_f32_16x16x32_bf16 a[4:7], v[132:135], v[32:35], a[4:7]
    v_mfma_f32_16x16x32_bf16 a[8:11], v[136:139], v[32:35], a[8:11]
    v_mfma_f32_16x16x32_bf16 a[12:15], v[140:143], v[32:35], a[12:15]
    v_mfma_f32_16x16x32_bf16 a[16:19], v[128:131], v[36:39], a[16:19]
    v_mfma_f32_16x16x32_bf16 a[20:23], v[132:135], v[36:39], a[20:23]
    v_mfma_f32_16x16x32_bf16 a[24:27], v[136:139], v[36:39], a[24:27]
    v_mfma_f32_16x16x32_bf16 a[28:31], v[140:143], v[36:39], a[28:31]
    v_mfma_f32_16x16x32_bf16 a[32:35], v[128:131], v[40:43], a[32:35]
    v_mfma_f32_16x16x32_bf16 a[36:39], v[132:135], v[40:43], a[36:39]
    v_mfma_f32_16x16x32_bf16 a[40:43], v[136:139], v[40:43], a[40:43]
    v_mfma_f32_16x16x32_bf16 a[44:47], v[140:143], v[40:43], a[44:47]
    v_mfma_f32_16x16x32_bf16 a[48:51], v[128:131], v[44:47], a[48:51]
    v_mfma_f32_16x16x32_bf16 a[52:55], v[132:135], v[44:47], a[52:55]
    v_mfma_f32_16x16x32_bf16 a[56:59], v[136:139], v[44:47], a[56:59]
    v_mfma_f32_16x16x32_bf16 a[60:63], v[140:143], v[44:47], a[60:63]
    v_mfma_f32_16x16x32_bf16 a[64:67], v[128:131], v[48:51], a[64:67]
    v_mfma_f32_16x16x32_bf16 a[68:71], v[132:135], v[48:51], a[68:71]
    v_mfma_f32_16x16x32_bf16 a[72:75], v[136:139], v[48:51], a[72:75]
    v_mfma_f32_16x16x32_bf16 a[76:79], v[140:143], v[48:51], a[76:79]
    v_mfma_f32_16x16x32_bf16 a[80:83], v[128:131], v[52:55], a[80:83]
    v_mfma_f32_16x16x32_bf16 a[84:87], v[132:135], v[52:55], a[84:87]
    v_mfma_f32_16x16x32_bf16 a[88:91], v[136:139], v[52:55], a[88:91]
    v_mfma_f32_16x16x32_bf16 a[92:95], v[140:143], v[52:55], a[92:95]
    v_mfma_f32_16x16x32_bf16 a[96:99], v[128:131], v[56:59], a[96:99]
    v_mfma_f32_16x16x32_bf16 a[100:103], v[132:135], v[56:59], a[100:103]
    v_mfma_f32_16x16x32_bf16 a[104:107], v[136:139], v[56:59], a[104:107]
    v_mfma_f32_16x16x32_bf16 a[108:111], v[140:143], v[56:59], a[108:111]
    v_mfma_f32_16x16x32_bf16 a[112:115], v[128:131], v[60:63], a[112:115]
    v_mfma_f32_16x16x32_bf16 a[116:119], v[132:135], v[60:63], a[116:119]
    v_mfma_f32_16x16x32_bf16 a[120:123], v[136:139], v[60:63], a[120:123]
    v_mfma_f32_16x16x32_bf16 a[124:127], v[140:143], v[60:63], a[124:127]
    s_waitcnt vmcnt(0) lgkmcnt(0)
    v_mfma_f32_16x16x32_bf16 a[0:3], v[96:99], v[64:67], a[0:3]
    v_mfma_f32_16x16x32_bf16 a[4:7], v[100:103], v[64:67], a[4:7]
    v_mfma_f32_16x16x32_bf16 a[8:11], v[104:107], v[64:67], a[8:11]
    v_mfma_f32_16x16x32_bf16 a[12:15], v[108:111], v[64:67], a[12:15]
    v_mfma_f32_16x16x32_bf16 a[16:19], v[96:99], v[68:71], a[16:19]
    v_mfma_f32_16x16x32_bf16 a[20:23], v[100:103], v[68:71], a[20:23]
    v_mfma_f32_16x16x32_bf16 a[24:27], v[104:107], v[68:71], a[24:27]
    v_mfma_f32_16x16x32_bf16 a[28:31], v[108:111], v[68:71], a[28:31]
    v_mfma_f32_16x16x32_bf16 a[32:35], v[96:99], v[72:75], a[32:35]
    v_mfma_f32_16x16x32_bf16 a[36:39], v[100:103], v[72:75], a[36:39]
    v_mfma_f32_16x16x32_bf16 a[40:43], v[104:107], v[72:75], a[40:43]
    v_mfma_f32_16x16x32_bf16 a[44:47], v[108:111], v[72:75], a[44:47]
    v_mfma_f32_16x16x32_bf16 a[48:51], v[96:99], v[76:79], a[48:51]
    v_mfma_f32_16x16x32_bf16 a[52:55], v[100:103], v[76:79], a[52:55]
    v_mfma_f32_16x16x32_bf16 a[56:59], v[104:107], v[76:79], a[56:59]
    v_mfma_f32_16x16x32_bf16 a[60:63], v[108:111], v[76:79], a[60:63]
    v_mfma_f32_16x16x32_bf16 a[64:67], v[96:99], v[80:83], a[64:67]
    v_mfma_f32_16x16x32_bf16 a[68:71], v[100:103], v[80:83], a[68:71]
    v_mfma_f32_16x16x32_bf16 a[72:75], v[104:107], v[80:83], a[72:75]
    v_mfma_f32_16x16x32_bf16 a[76:79], v[108:111], v[80:83], a[76:79]
    v_mfma_f32_16x16x32_bf16 a[80:83], v[96:99], v[84:87], a[80:83]
    v_mfma_f32_16x16x32_bf16 a[84:87], v[100:103], v[84:87], a[84:87]
    v_mfma_f32_16x16x32_bf16 a[88:91], v[104:107], v[84:87], a[88:91]
    v_mfma_f32_16x16x32_bf16 a[92:95], v[108:111], v[84:87], a[92:95]
    v_mfma_f32_16x16x32_bf16 a[96:99], v[96:99], v[88:91], a[96:99]
    v_mfma_f32_16x16x32_bf16 a[100:103], v[100:103], v[88:91], a[100:103]
    v_mfma_f32_16x16x32_bf16 a[104:107], v[104:107], v[88:91], a[104:107]
    v_mfma_f32_16x16x32_bf16 a[108:111], v[108:111], v[88:91], a[108:111]
    v_mfma_f32_16x16x32_bf16 a[112:115], v[96:99], v[92:95], a[112:115]
    v_mfma_f32_16x16x32_bf16 a[116:119], v[100:103], v[92:95], a[116:119]
    v_mfma_f32_16x16x32_bf16 a[120:123], v[104:107], v[92:95], a[120:123]
    v_mfma_f32_16x16x32_bf16 a[124:127], v[108:111], v[92:95], a[124:127]
    s_nop 9
    s_cmp_ge_u32 s11, 16
    s_cselect_b32 s17, 16777216, 0
    s_add_u32 s17, s17, 25165824
    s_lshl_b32 s18, s4, 20
    s_add_u32 s17, s17, s18
    s_lshl_b32 s18, s15, 13
    s_add_u32 s17, s17, s18
    s_lshl_b32 s18, s16, 10
    s_add_u32 s17, s17, s18
    v_accvgpr_read_b32 v20, a0
    v_accvgpr_read_b32 v24, a4
    v_accvgpr_read_b32 v21, a1
    v_accvgpr_read_b32 v25, a5
    v_accvgpr_read_b32 v22, a2
    v_accvgpr_read_b32 v26, a6
    v_accvgpr_read_b32 v23, a3
    v_accvgpr_read_b32 v27, a7
    v_cvt_pk_bf16_f32 v16, v20, v21
    v_cvt_pk_bf16_f32 v17, v22, v23
    v_cvt_pk_bf16_f32 v18, v24, v25
    v_cvt_pk_bf16_f32 v19, v26, v27
    s_add_u32 s18, s17, 0
    buffer_store_dwordx4 v[16:19], v4, s[40:43], s18 offen sc0 sc1
    v_accvgpr_read_b32 v36, a8
    v_accvgpr_read_b32 v40, a12
    v_accvgpr_read_b32 v37, a9
    v_accvgpr_read_b32 v41, a13
    v_accvgpr_read_b32 v38, a10
    v_accvgpr_read_b32 v42, a14
    v_accvgpr_read_b32 v39, a11
    v_accvgpr_read_b32 v43, a15
    v_cvt_pk_bf16_f32 v32, v36, v37
    v_cvt_pk_bf16_f32 v33, v38, v39
    v_cvt_pk_bf16_f32 v34, v40, v41
    v_cvt_pk_bf16_f32 v35, v42, v43
    s_add_u32 s18, s17, 2048
    buffer_store_dwordx4 v[32:35], v4, s[40:43], s18 offen sc0 sc1
    v_accvgpr_read_b32 v20, a16
    v_accvgpr_read_b32 v24, a20
    v_accvgpr_read_b32 v21, a17
    v_accvgpr_read_b32 v25, a21
    v_accvgpr_read_b32 v22, a18
    v_accvgpr_read_b32 v26, a22
    v_accvgpr_read_b32 v23, a19
    v_accvgpr_read_b32 v27, a23
    v_cvt_pk_bf16_f32 v16, v20, v21
    v_cvt_pk_bf16_f32 v17, v22, v23
    v_cvt_pk_bf16_f32 v18, v24, v25
    v_cvt_pk_bf16_f32 v19, v26, v27
    s_add_u32 s18, s17, 1024
    buffer_store_dwordx4 v[16:19], v4, s[40:43], s18 offen sc0 sc1
    v_accvgpr_read_b32 v36, a24
    v_accvgpr_read_b32 v40, a28
    v_accvgpr_read_b32 v37, a25
    v_accvgpr_read_b32 v41, a29
    v_accvgpr_read_b32 v38, a26
    v_accvgpr_read_b32 v42, a30
    v_accvgpr_read_b32 v39, a27
    v_accvgpr_read_b32 v43, a31
    v_cvt_pk_bf16_f32 v32, v36, v37
    v_cvt_pk_bf16_f32 v33, v38, v39
    v_cvt_pk_bf16_f32 v34, v40, v41
    v_cvt_pk_bf16_f32 v35, v42, v43
    s_add_u32 s18, s17, 3072
    buffer_store_dwordx4 v[32:35], v4, s[40:43], s18 offen sc0 sc1
    v_accvgpr_read_b32 v20, a32
    v_accvgpr_read_b32 v24, a36
    v_accvgpr_read_b32 v21, a33
    v_accvgpr_read_b32 v25, a37
    v_accvgpr_read_b32 v22, a34
    v_accvgpr_read_b32 v26, a38
    v_accvgpr_read_b32 v23, a35
    v_accvgpr_read_b32 v27, a39
    v_cvt_pk_bf16_f32 v16, v20, v21
    v_cvt_pk_bf16_f32 v17, v22, v23
    v_cvt_pk_bf16_f32 v18, v24, v25
    v_cvt_pk_bf16_f32 v19, v26, v27
    s_add_u32 s18, s17, 262144
    buffer_store_dwordx4 v[16:19], v4, s[40:43], s18 offen sc0 sc1
    v_accvgpr_read_b32 v36, a40
    v_accvgpr_read_b32 v40, a44
    v_accvgpr_read_b32 v37, a41
    v_accvgpr_read_b32 v41, a45
    v_accvgpr_read_b32 v38, a42
    v_accvgpr_read_b32 v42, a46
    v_accvgpr_read_b32 v39, a43
    v_accvgpr_read_b32 v43, a47
    v_cvt_pk_bf16_f32 v32, v36, v37
    v_cvt_pk_bf16_f32 v33, v38, v39
    v_cvt_pk_bf16_f32 v34, v40, v41
    v_cvt_pk_bf16_f32 v35, v42, v43
    s_add_u32 s18, s17, 264192
    buffer_store_dwordx4 v[32:35], v4, s[40:43], s18 offen sc0 sc1
    v_accvgpr_read_b32 v20, a48
    v_accvgpr_read_b32 v24, a52
    v_accvgpr_read_b32 v21, a49
    v_accvgpr_read_b32 v25, a53
    v_accvgpr_read_b32 v22, a50
    v_accvgpr_read_b32 v26, a54
    v_accvgpr_read_b32 v23, a51
    v_accvgpr_read_b32 v27, a55
    v_cvt_pk_bf16_f32 v16, v20, v21
    v_cvt_pk_bf16_f32 v17, v22, v23
    v_cvt_pk_bf16_f32 v18, v24, v25
    v_cvt_pk_bf16_f32 v19, v26, v27
    s_add_u32 s18, s17, 263168
    buffer_store_dwordx4 v[16:19], v4, s[40:43], s18 offen sc0 sc1
    v_accvgpr_read_b32 v36, a56
    v_accvgpr_read_b32 v40, a60
    v_accvgpr_read_b32 v37, a57
    v_accvgpr_read_b32 v41, a61
    v_accvgpr_read_b32 v38, a58
    v_accvgpr_read_b32 v42, a62
    v_accvgpr_read_b32 v39, a59
    v_accvgpr_read_b32 v43, a63
    v_cvt_pk_bf16_f32 v32, v36, v37
    v_cvt_pk_bf16_f32 v33, v38, v39
    v_cvt_pk_bf16_f32 v34, v40, v41
    v_cvt_pk_bf16_f32 v35, v42, v43
    s_add_u32 s18, s17, 265216
    buffer_store_dwordx4 v[32:35], v4, s[40:43], s18 offen sc0 sc1
    v_accvgpr_read_b32 v20, a64
    v_accvgpr_read_b32 v24, a68
    v_accvgpr_read_b32 v21, a65
    v_accvgpr_read_b32 v25, a69
    v_accvgpr_read_b32 v22, a66
    v_accvgpr_read_b32 v26, a70
    v_accvgpr_read_b32 v23, a67
    v_accvgpr_read_b32 v27, a71
    v_cvt_pk_bf16_f32 v16, v20, v21
    v_cvt_pk_bf16_f32 v17, v22, v23
    v_cvt_pk_bf16_f32 v18, v24, v25
    v_cvt_pk_bf16_f32 v19, v26, v27
    s_add_u32 s18, s17, 524288
    buffer_store_dwordx4 v[16:19], v4, s[40:43], s18 offen sc0 sc1
    v_accvgpr_read_b32 v36, a72
    v_accvgpr_read_b32 v40, a76
    v_accvgpr_read_b32 v37, a73
    v_accvgpr_read_b32 v41, a77
    v_accvgpr_read_b32 v38, a74
    v_accvgpr_read_b32 v42, a78
    v_accvgpr_read_b32 v39, a75
    v_accvgpr_read_b32 v43, a79
    v_cvt_pk_bf16_f32 v32, v36, v37
    v_cvt_pk_bf16_f32 v33, v38, v39
    v_cvt_pk_bf16_f32 v34, v40, v41
    v_cvt_pk_bf16_f32 v35, v42, v43
    s_add_u32 s18, s17, 526336
    buffer_store_dwordx4 v[32:35], v4, s[40:43], s18 offen sc0 sc1
    v_accvgpr_read_b32 v20, a80
    v_accvgpr_read_b32 v24, a84
    v_accvgpr_read_b32 v21, a81
    v_accvgpr_read_b32 v25, a85
    v_accvgpr_read_b32 v22, a82
    v_accvgpr_read_b32 v26, a86
    v_accvgpr_read_b32 v23, a83
    v_accvgpr_read_b32 v27, a87
    v_cvt_pk_bf16_f32 v16, v20, v21
    v_cvt_pk_bf16_f32 v17, v22, v23
    v_cvt_pk_bf16_f32 v18, v24, v25
    v_cvt_pk_bf16_f32 v19, v26, v27
    s_add_u32 s18, s17, 525312
    buffer_store_dwordx4 v[16:19], v4, s[40:43], s18 offen sc0 sc1
    v_accvgpr_read_b32 v36, a88
    v_accvgpr_read_b32 v40, a92
    v_accvgpr_read_b32 v37, a89
    v_accvgpr_read_b32 v41, a93
    v_accvgpr_read_b32 v38, a90
    v_accvgpr_read_b32 v42, a94
    v_accvgpr_read_b32 v39, a91
    v_accvgpr_read_b32 v43, a95
    v_cvt_pk_bf16_f32 v32, v36, v37
    v_cvt_pk_bf16_f32 v33, v38, v39
    v_cvt_pk_bf16_f32 v34, v40, v41
    v_cvt_pk_bf16_f32 v35, v42, v43
    s_add_u32 s18, s17, 527360
    buffer_store_dwordx4 v[32:35], v4, s[40:43], s18 offen sc0 sc1
    v_accvgpr_read_b32 v20, a96
    v_accvgpr_read_b32 v24, a100
    v_accvgpr_read_b32 v21, a97
    v_accvgpr_read_b32 v25, a101
    v_accvgpr_read_b32 v22, a98
    v_accvgpr_read_b32 v26, a102
    v_accvgpr_read_b32 v23, a99
    v_accvgpr_read_b32 v27, a103
    v_cvt_pk_bf16_f32 v16, v20, v21
    v_cvt_pk_bf16_f32 v17, v22, v23
    v_cvt_pk_bf16_f32 v18, v24, v25
    v_cvt_pk_bf16_f32 v19, v26, v27
    s_add_u32 s18, s17, 786432
    buffer_store_dwordx4 v[16:19], v4, s[40:43], s18 offen sc0 sc1
    v_accvgpr_read_b32 v36, a104
    v_accvgpr_read_b32 v40, a108
    v_accvgpr_read_b32 v37, a105
    v_accvgpr_read_b32 v41, a109
    v_accvgpr_read_b32 v38, a106
    v_accvgpr_read_b32 v42, a110
    v_accvgpr_read_b32 v39, a107
    v_accvgpr_read_b32 v43, a111
    v_cvt_pk_bf16_f32 v32, v36, v37
    v_cvt_pk_bf16_f32 v33, v38, v39
    v_cvt_pk_bf16_f32 v34, v40, v41
    v_cvt_pk_bf16_f32 v35, v42, v43
    s_add_u32 s18, s17, 788480
    buffer_store_dwordx4 v[32:35], v4, s[40:43], s18 offen sc0 sc1
    v_accvgpr_read_b32 v20, a112
    v_accvgpr_read_b32 v24, a116
    v_accvgpr_read_b32 v21, a113
    v_accvgpr_read_b32 v25, a117
    v_accvgpr_read_b32 v22, a114
    v_accvgpr_read_b32 v26, a118
    v_accvgpr_read_b32 v23, a115
    v_accvgpr_read_b32 v27, a119
    v_cvt_pk_bf16_f32 v16, v20, v21
    v_cvt_pk_bf16_f32 v17, v22, v23
    v_cvt_pk_bf16_f32 v18, v24, v25
    v_cvt_pk_bf16_f32 v19, v26, v27
    s_add_u32 s18, s17, 787456
    buffer_store_dwordx4 v[16:19], v4, s[40:43], s18 offen sc0 sc1
    v_accvgpr_read_b32 v36, a120
    v_accvgpr_read_b32 v40, a124
    v_accvgpr_read_b32 v37, a121
    v_accvgpr_read_b32 v41, a125
    v_accvgpr_read_b32 v38, a122
    v_accvgpr_read_b32 v42, a126
    v_accvgpr_read_b32 v39, a123
    v_accvgpr_read_b32 v43, a127
    v_cvt_pk_bf16_f32 v32, v36, v37
    v_cvt_pk_bf16_f32 v33, v38, v39
    v_cvt_pk_bf16_f32 v34, v40, v41
    v_cvt_pk_bf16_f32 v35, v42, v43
    s_add_u32 s18, s17, 789504
    buffer_store_dwordx4 v[32:35], v4, s[40:43], s18 offen sc0 sc1
    s_branch qkv_sig
qkv_v:
    buffer_load_dwordx4 v[96:99], v8, s[40:43], s14 offen offset:0
    buffer_load_dwordx4 v[100:103], v9, s[40:43], s14 offen offset:0
    buffer_load_dwordx4 v[104:107], v10, s[40:43], s14 offen offset:0
    buffer_load_dwordx4 v[108:111], v11, s[40:43], s14 offen offset:0
    buffer_load_dwordx4 v[112:115], v8, s[40:43], s14 offen offset:1024
    buffer_load_dwordx4 v[116:119], v9, s[40:43], s14 offen offset:1024
    buffer_load_dwordx4 v[120:123], v10, s[40:43], s14 offen offset:1024
    buffer_load_dwordx4 v[124:127], v11, s[40:43], s14 offen offset:1024
    ds_read_b128 v[32:35], v4 offset:0
    ds_read_b128 v[36:39], v4 offset:16384
    ds_read_b128 v[40:43], v4 offset:32768
    ds_read_b128 v[44:47], v4 offset:49152
    ds_read_b128 v[48:51], v5 offset:0
    ds_read_b128 v[52:55], v5 offset:16384
    ds_read_b128 v[56:59], v5 offset:32768
    ds_read_b128 v[60:63], v5 offset:49152
    buffer_load_dwordx4 v[128:131], v8, s[40:43], s14 offen offset:2048
    buffer_load_dwordx4 v[132:135], v9, s[40:43], s14 offen offset:2048
    buffer_load_dwordx4 v[136:139], v10, s[40:43], s14 offen offset:2048
    buffer_load_dwordx4 v[140:143], v11, s[40:43], s14 offen offset:2048
    ds_read_b128 v[64:67], v4 offset:1024
    ds_read_b128 v[68:71], v4 offset:17408
    ds_read_b128 v[72:75], v4 offset:33792
    ds_read_b128 v[76:79], v4 offset:50176
    ds_read_b128 v[80:83], v5 offset:1024
    ds_read_b128 v[84:87], v5 offset:17408
    ds_read_b128 v[88:91], v5 offset:33792
    ds_read_b128 v[92:95], v5 offset:50176
    s_waitcnt vmcnt(8) lgkmcnt(8)
    v_mfma_f32_16x16x32_bf16 a[0:3], v[32:35], v[96:99], 0
    v_mfma_f32_16x16x32_bf16 a[4:7], v[32:35], v[100:103], 0
    v_mfma_f32_16x16x32_bf16 a[8:11], v[32:35], v[104:107], 0
    v_mfma_f32_16x16x32_bf16 a[12:15], v[32:35], v[108:111], 0
    v_mfma_f32_16x16x32_bf16 a[16:19], v[36:39], v[96:99], 0
    v_mfma_f32_16x16x32_bf16 a[20:23], v[36:39], v[100:103], 0
    v_mfma_f32_16x16x32_bf16 a[24:27], v[36:39], v[104:107], 0
    v_mfma_f32_16x16x32_bf16 a[28:31], v[36:39], v[108:111], 0
    v_mfma_f32_16x16x32_bf16 a[32:35], v[40:43], v[96:99], 0
    v_mfma_f32_16x16x32_bf16 a[36:39], v[40:43], v[100:103], 0
    v_mfma_f32_16x16x32_bf16 a[40:43], v[40:43], v[104:107], 0
    v_mfma_f32_16x16x32_bf16 a[44:47], v[40:43], v[108:111], 0
    v_mfma_f32_16x16x32_bf16 a[48:51], v[44:47], v[96:99], 0
    v_mfma_f32_16x16x32_bf16 a[52:55], v[44:47], v[100:103], 0
    v_mfma_f32_16x16x32_bf16 a[56:59], v[44:47], v[104:107], 0
    v_mfma_f32_16x16x32_bf16 a[60:63], v[44:47], v[108:111], 0
    v_mfma_f32_16x16x32_bf16 a[64:67], v[48:51], v[96:99], 0
    v_mfma_f32_16x16x32_bf16 a[68:71], v[48:51], v[100:103], 0
    v_mfma_f32_16x16x32_bf16 a[72:75], v[48:51], v[104:107], 0
    v_mfma_f32_16x16x32_bf16 a[76:79], v[48:51], v[108:111], 0
    v_mfma_f32_16x16x32_bf16 a[80:83], v[52:55], v[96:99], 0
    v_mfma_f32_16x16x32_bf16 a[84:87], v[52:55], v[100:103], 0
    v_mfma_f32_16x16x32_bf16 a[88:91], v[52:55], v[104:107], 0
    v_mfma_f32_16x16x32_bf16 a[92:95], v[52:55], v[108:111], 0
    v_mfma_f32_16x16x32_bf16 a[96:99], v[56:59], v[96:99], 0
    v_mfma_f32_16x16x32_bf16 a[100:103], v[56:59], v[100:103], 0
    v_mfma_f32_16x16x32_bf16 a[104:107], v[56:59], v[104:107], 0
    v_mfma_f32_16x16x32_bf16 a[108:111], v[56:59], v[108:111], 0
    v_mfma_f32_16x16x32_bf16 a[112:115], v[60:63], v[96:99], 0
    v_mfma_f32_16x16x32_bf16 a[116:119], v[60:63], v[100:103], 0
    v_mfma_f32_16x16x32_bf16 a[120:123], v[60:63], v[104:107], 0
    v_mfma_f32_16x16x32_bf16 a[124:127], v[60:63], v[108:111], 0
    buffer_load_dwordx4 v[96:99], v8, s[40:43], s14 offen offset:3072
    buffer_load_dwordx4 v[100:103], v9, s[40:43], s14 offen offset:3072
    buffer_load_dwordx4 v[104:107], v10, s[40:43], s14 offen offset:3072
    buffer_load_dwordx4 v[108:111], v11, s[40:43], s14 offen offset:3072
    ds_read_b128 v[32:35], v4 offset:2048
    ds_read_b128 v[36:39], v4 offset:18432
    ds_read_b128 v[40:43], v4 offset:34816
    ds_read_b128 v[44:47], v4 offset:51200
    ds_read_b128 v[48:51], v5 offset:2048
    ds_read_b128 v[52:55], v5 offset:18432
    ds_read_b128 v[56:59], v5 offset:34816
    ds_read_b128 v[60:63], v5 offset:51200
    s_waitcnt vmcnt(8) lgkmcnt(8)
    v_mfma_f32_16x16x32_bf16 a[0:3], v[64:67], v[112:115], a[0:3]
    v_mfma_f32_16x16x32_bf16 a[4:7], v[64:67], v[116:119], a[4:7]
    v_mfma_f32_16x16x32_bf16 a[8:11], v[64:67], v[120:123], a[8:11]
    v_mfma_f32_16x16x32_bf16 a[12:15], v[64:67], v[124:127], a[12:15]
    v_mfma_f32_16x16x32_bf16 a[16:19], v[68:71], v[112:115], a[16:19]
    v_mfma_f32_16x16x32_bf16 a[20:23], v[68:71], v[116:119], a[20:23]
    v_mfma_f32_16x16x32_bf16 a[24:27], v[68:71], v[120:123], a[24:27]
    v_mfma_f32_16x16x32_bf16 a[28:31], v[68:71], v[124:127], a[28:31]
    v_mfma_f32_16x16x32_bf16 a[32:35], v[72:75], v[112:115], a[32:35]
    v_mfma_f32_16x16x32_bf16 a[36:39], v[72:75], v[116:119], a[36:39]
    v_mfma_f32_16x16x32_bf16 a[40:43], v[72:75], v[120:123], a[40:43]
    v_mfma_f32_16x16x32_bf16 a[44:47], v[72:75], v[124:127], a[44:47]
    v_mfma_f32_16x16x32_bf16 a[48:51], v[76:79], v[112:115], a[48:51]
    v_mfma_f32_16x16x32_bf16 a[52:55], v[76:79], v[116:119], a[52:55]
    v_mfma_f32_16x16x32_bf16 a[56:59], v[76:79], v[120:123], a[56:59]
    v_mfma_f32_16x16x32_bf16 a[60:63], v[76:79], v[124:127], a[60:63]
    v_mfma_f32_16x16x32_bf16 a[64:67], v[80:83], v[112:115], a[64:67]
    v_mfma_f32_16x16x32_bf16 a[68:71], v[80:83], v[116:119], a[68:71]
    v_mfma_f32_16x16x32_bf16 a[72:75], v[80:83], v[120:123], a[72:75]
    v_mfma_f32_16x16x32_bf16 a[76:79], v[80:83], v[124:127], a[76:79]
    v_mfma_f32_16x16x32_bf16 a[80:83], v[84:87], v[112:115], a[80:83]
    v_mfma_f32_16x16x32_bf16 a[84:87], v[84:87], v[116:119], a[84:87]
    v_mfma_f32_16x16x32_bf16 a[88:91], v[84:87], v[120:123], a[88:91]
    v_mfma_f32_16x16x32_bf16 a[92:95], v[84:87], v[124:127], a[92:95]
    v_mfma_f32_16x16x32_bf16 a[96:99], v[88:91], v[112:115], a[96:99]
    v_mfma_f32_16x16x32_bf16 a[100:103], v[88:91], v[116:119], a[100:103]
    v_mfma_f32_16x16x32_bf16 a[104:107], v[88:91], v[120:123], a[104:107]
    v_mfma_f32_16x16x32_bf16 a[108:111], v[88:91], v[124:127], a[108:111]
    v_mfma_f32_16x16x32_bf16 a[112:115], v[92:95], v[112:115], a[112:115]
    v_mfma_f32_16x16x32_bf16 a[116:119], v[92:95], v[116:119], a[116:119]
    v_mfma_f32_16x16x32_bf16 a[120:123], v[92:95], v[120:123], a[120:123]
    v_mfma_f32_16x16x32_bf16 a[124:127], v[92:95], v[124:127], a[124:127]
    s_add_u32 s14, s14, 4096
    buffer_load_dwordx4 v[112:115], v8, s[40:43], s14 offen offset:0
    buffer_load_dwordx4 v[116:119], v9, s[40:43], s14 offen offset:0
    buffer_load_dwordx4 v[120:123], v10, s[40:43], s14 offen offset:0
    buffer_load_dwordx4 v[124:127], v11, s[40:43], s14 offen offset:0
    ds_read_b128 v[64:67], v4 offset:3072
    ds_read_b128 v[68:71], v4 offset:19456
    ds_read_b128 v[72:75], v4 offset:35840
    ds_read_b128 v[76:79], v4 offset:52224
    ds_read_b128 v[80:83], v5 offset:3072
    ds_read_b128 v[84:87], v5 offset:19456
    ds_read_b128 v[88:91], v5 offset:35840
    ds_read_b128 v[92:95], v5 offset:52224
    s_waitcnt vmcnt(8) lgkmcnt(8)
    v_mfma_f32_16x16x32_bf16 a[0:3], v[32:35], v[128:131], a[0:3]
    v_mfma_f32_16x16x32_bf16 a[4:7], v[32:35], v[132:135], a[4:7]
    v_mfma_f32_16x16x32_bf16 a[8:11], v[32:35], v[136:139], a[8:11]
    v_mfma_f32_16x16x32_bf16 a[12:15], v[32:35], v[140:143], a[12:15]
    v_mfma_f32_16x16x32_bf16 a[16:19], v[36:39], v[128:131], a[16:19]
    v_mfma_f32_16x16x32_bf16 a[20:23], v[36:39], v[132:135], a[20:23]
    v_mfma_f32_16x16x32_bf16 a[24:27], v[36:39], v[136:139], a[24:27]
    v_mfma_f32_16x16x32_bf16 a[28:31], v[36:39], v[140:143], a[28:31]
    v_mfma_f32_16x16x32_bf16 a[32:35], v[40:43], v[128:131], a[32:35]
    v_mfma_f32_16x16x32_bf16 a[36:39], v[40:43], v[132:135], a[36:39]
    v_mfma_f32_16x16x32_bf16 a[40:43], v[40:43], v[136:139], a[40:43]
    v_mfma_f32_16x16x32_bf16 a[44:47], v[40:43], v[140:143], a[44:47]
    v_mfma_f32_16x16x32_bf16 a[48:51], v[44:47], v[128:131], a[48:51]
    v_mfma_f32_16x16x32_bf16 a[52:55], v[44:47], v[132:135], a[52:55]
    v_mfma_f32_16x16x32_bf16 a[56:59], v[44:47], v[136:139], a[56:59]
    v_mfma_f32_16x16x32_bf16 a[60:63], v[44:47], v[140:143], a[60:63]
    v_mfma_f32_16x16x32_bf16 a[64:67], v[48:51], v[128:131], a[64:67]
    v_mfma_f32_16x16x32_bf16 a[68:71], v[48:51], v[132:135], a[68:71]
    v_mfma_f32_16x16x32_bf16 a[72:75], v[48:51], v[136:139], a[72:75]
    v_mfma_f32_16x16x32_bf16 a[76:79], v[48:51], v[140:143], a[76:79]
    v_mfma_f32_16x16x32_bf16 a[80:83], v[52:55], v[128:131], a[80:83]
    v_mfma_f32_16x16x32_bf16 a[84:87], v[52:55], v[132:135], a[84:87]
    v_mfma_f32_16x16x32_bf16 a[88:91], v[52:55], v[136:139], a[88:91]
    v_mfma_f32_16x16x32_bf16 a[92:95], v[52:55], v[140:143], a[92:95]
    v_mfma_f32_16x16x32_bf16 a[96:99], v[56:59], v[128:131], a[96:99]
    v_mfma_f32_16x16x32_bf16 a[100:103], v[56:59], v[132:135], a[100:103]
    v_mfma_f32_16x16x32_bf16 a[104:107], v[56:59], v[136:139], a[104:107]
    v_mfma_f32_16x16x32_bf16 a[108:111], v[56:59], v[140:143], a[108:111]
    v_mfma_f32_16x16x32_bf16 a[112:115], v[60:63], v[128:131], a[112:115]
    v_mfma_f32_16x16x32_bf16 a[116:119], v[60:63], v[132:135], a[116:119]
    v_mfma_f32_16x16x32_bf16 a[120:123], v[60:63], v[136:139], a[120:123]
    v_mfma_f32_16x16x32_bf16 a[124:127], v[60:63], v[140:143], a[124:127]
    buffer_load_dwordx4 v[128:131], v8, s[40:43], s14 offen offset:1024
    buffer_load_dwordx4 v[132:135], v9, s[40:43], s14 offen offset:1024
    buffer_load_dwordx4 v[136:139], v10, s[40:43], s14 offen offset:1024
    buffer_load_dwordx4 v[140:143], v11, s[40:43], s14 offen offset:1024
    ds_read_b128 v[32:35], v4 offset:4096
    ds_read_b128 v[36:39], v4 offset:20480
    ds_read_b128 v[40:43], v4 offset:36864
    ds_read_b128 v[44:47], v4 offset:53248
    ds_read_b128 v[48:51], v5 offset:4096
    ds_read_b128 v[52:55], v5 offset:20480
    ds_read_b128 v[56:59], v5 offset:36864
    ds_read_b128 v[60:63], v5 offset:53248
    s_waitcnt vmcnt(8) lgkmcnt(8)
    v_mfma_f32_16x16x32_bf16 a[0:3], v[64:67], v[96:99], a[0:3]
    v_mfma_f32_16x16x32_bf16 a[4:7], v[64:67], v[100:103], a[4:7]
    v_mfma_f32_16x16x32_bf16 a[8:11], v[64:67], v[104:107], a[8:11]
    v_mfma_f32_16x16x32_bf16 a[12:15], v[64:67], v[108:111], a[12:15]
    v_mfma_f32_16x16x32_bf16 a[16:19], v[68:71], v[96:99], a[16:19]
    v_mfma_f32_16x16x32_bf16 a[20:23], v[68:71], v[100:103], a[20:23]
    v_mfma_f32_16x16x32_bf16 a[24:27], v[68:71], v[104:107], a[24:27]
    v_mfma_f32_16x16x32_bf16 a[28:31], v[68:71], v[108:111], a[28:31]
    v_mfma_f32_16x16x32_bf16 a[32:35], v[72:75], v[96:99], a[32:35]
    v_mfma_f32_16x16x32_bf16 a[36:39], v[72:75], v[100:103], a[36:39]
    v_mfma_f32_16x16x32_bf16 a[40:43], v[72:75], v[104:107], a[40:43]
    v_mfma_f32_16x16x32_bf16 a[44:47], v[72:75], v[108:111], a[44:47]
    v_mfma_f32_16x16x32_bf16 a[48:51], v[76:79], v[96:99], a[48:51]
    v_mfma_f32_16x16x32_bf16 a[52:55], v[76:79], v[100:103], a[52:55]
    v_mfma_f32_16x16x32_bf16 a[56:59], v[76:79], v[104:107], a[56:59]
    v_mfma_f32_16x16x32_bf16 a[60:63], v[76:79], v[108:111], a[60:63]
    v_mfma_f32_16x16x32_bf16 a[64:67], v[80:83], v[96:99], a[64:67]
    v_mfma_f32_16x16x32_bf16 a[68:71], v[80:83], v[100:103], a[68:71]
    v_mfma_f32_16x16x32_bf16 a[72:75], v[80:83], v[104:107], a[72:75]
    v_mfma_f32_16x16x32_bf16 a[76:79], v[80:83], v[108:111], a[76:79]
    v_mfma_f32_16x16x32_bf16 a[80:83], v[84:87], v[96:99], a[80:83]
    v_mfma_f32_16x16x32_bf16 a[84:87], v[84:87], v[100:103], a[84:87]
    v_mfma_f32_16x16x32_bf16 a[88:91], v[84:87], v[104:107], a[88:91]
    v_mfma_f32_16x16x32_bf16 a[92:95], v[84:87], v[108:111], a[92:95]
    v_mfma_f32_16x16x32_bf16 a[96:99], v[88:91], v[96:99], a[96:99]
    v_mfma_f32_16x16x32_bf16 a[100:103], v[88:91], v[100:103], a[100:103]
    v_mfma_f32_16x16x32_bf16 a[104:107], v[88:91], v[104:107], a[104:107]
    v_mfma_f32_16x16x32_bf16 a[108:111], v[88:91], v[108:111], a[108:111]
    v_mfma_f32_16x16x32_bf16 a[112:115], v[92:95], v[96:99], a[112:115]
    v_mfma_f32_16x16x32_bf16 a[116:119], v[92:95], v[100:103], a[116:119]
    v_mfma_f32_16x16x32_bf16 a[120:123], v[92:95], v[104:107], a[120:123]
    v_mfma_f32_16x16x32_bf16 a[124:127], v[92:95], v[108:111], a[124:127]
    buffer_load_dwordx4 v[96:99], v8, s[40:43], s14 offen offset:2048
    buffer_load_dwordx4 v[100:103], v9, s[40:43], s14 offen offset:2048
    buffer_load_dwordx4 v[104:107], v10, s[40:43], s14 offen offset:2048
    buffer_load_dwordx4 v[108:111], v11, s[40:43], s14 offen offset:2048
    ds_read_b128 v[64:67], v4 offset:5120
    ds_read_b128 v[68:71], v4 offset:21504
    ds_read_b128 v[72:75], v4 offset:37888
    ds_read_b128 v[76:79], v4 offset:54272
    ds_read_b128 v[80:83], v5 offset:5120
    ds_read_b128 v[84:87], v5 offset:21504
    ds_read_b128 v[88:91], v5 offset:37888
    ds_read_b128 v[92:95], v5 offset:54272
    s_waitcnt vmcnt(8) lgkmcnt(8)
    v_mfma_f32_16x16x32_bf16 a[0:3], v[32:35], v[112:115], a[0:3]
    v_mfma_f32_16x16x32_bf16 a[4:7], v[32:35], v[116:119], a[4:7]
    v_mfma_f32_16x16x32_bf16 a[8:11], v[32:35], v[120:123], a[8:11]
    v_mfma_f32_16x16x32_bf16 a[12:15], v[32:35], v[124:127], a[12:15]
    v_mfma_f32_16x16x32_bf16 a[16:19], v[36:39], v[112:115], a[16:19]
    v_mfma_f32_16x16x32_bf16 a[20:23], v[36:39], v[116:119], a[20:23]
    v_mfma_f32_16x16x32_bf16 a[24:27], v[36:39], v[120:123], a[24:27]
    v_mfma_f32_16x16x32_bf16 a[28:31], v[36:39], v[124:127], a[28:31]
    v_mfma_f32_16x16x32_bf16 a[32:35], v[40:43], v[112:115], a[32:35]
    v_mfma_f32_16x16x32_bf16 a[36:39], v[40:43], v[116:119], a[36:39]
    v_mfma_f32_16x16x32_bf16 a[40:43], v[40:43], v[120:123], a[40:43]
    v_mfma_f32_16x16x32_bf16 a[44:47], v[40:43], v[124:127], a[44:47]
    v_mfma_f32_16x16x32_bf16 a[48:51], v[44:47], v[112:115], a[48:51]
    v_mfma_f32_16x16x32_bf16 a[52:55], v[44:47], v[116:119], a[52:55]
    v_mfma_f32_16x16x32_bf16 a[56:59], v[44:47], v[120:123], a[56:59]
    v_mfma_f32_16x16x32_bf16 a[60:63], v[44:47], v[124:127], a[60:63]
    v_mfma_f32_16x16x32_bf16 a[64:67], v[48:51], v[112:115], a[64:67]
    v_mfma_f32_16x16x32_bf16 a[68:71], v[48:51], v[116:119], a[68:71]
    v_mfma_f32_16x16x32_bf16 a[72:75], v[48:51], v[120:123], a[72:75]
    v_mfma_f32_16x16x32_bf16 a[76:79], v[48:51], v[124:127], a[76:79]
    v_mfma_f32_16x16x32_bf16 a[80:83], v[52:55], v[112:115], a[80:83]
    v_mfma_f32_16x16x32_bf16 a[84:87], v[52:55], v[116:119], a[84:87]
    v_mfma_f32_16x16x32_bf16 a[88:91], v[52:55], v[120:123], a[88:91]
    v_mfma_f32_16x16x32_bf16 a[92:95], v[52:55], v[124:127], a[92:95]
    v_mfma_f32_16x16x32_bf16 a[96:99], v[56:59], v[112:115], a[96:99]
    v_mfma_f32_16x16x32_bf16 a[100:103], v[56:59], v[116:119], a[100:103]
    v_mfma_f32_16x16x32_bf16 a[104:107], v[56:59], v[120:123], a[104:107]
    v_mfma_f32_16x16x32_bf16 a[108:111], v[56:59], v[124:127], a[108:111]
    v_mfma_f32_16x16x32_bf16 a[112:115], v[60:63], v[112:115], a[112:115]
    v_mfma_f32_16x16x32_bf16 a[116:119], v[60:63], v[116:119], a[116:119]
    v_mfma_f32_16x16x32_bf16 a[120:123], v[60:63], v[120:123], a[120:123]
    v_mfma_f32_16x16x32_bf16 a[124:127], v[60:63], v[124:127], a[124:127]
    buffer_load_dwordx4 v[112:115], v8, s[40:43], s14 offen offset:3072
    buffer_load_dwordx4 v[116:119], v9, s[40:43], s14 offen offset:3072
    buffer_load_dwordx4 v[120:123], v10, s[40:43], s14 offen offset:3072
    buffer_load_dwordx4 v[124:127], v11, s[40:43], s14 offen offset:3072
    ds_read_b128 v[32:35], v4 offset:6144
    ds_read_b128 v[36:39], v4 offset:22528
    ds_read_b128 v[40:43], v4 offset:38912
    ds_read_b128 v[44:47], v4 offset:55296
    ds_read_b128 v[48:51], v5 offset:6144
    ds_read_b128 v[52:55], v5 offset:22528
    ds_read_b128 v[56:59], v5 offset:38912
    ds_read_b128 v[60:63], v5 offset:55296
    s_waitcnt vmcnt(8) lgkmcnt(8)
    v_mfma_f32_16x16x32_bf16 a[0:3], v[64:67], v[128:131], a[0:3]
    v_mfma_f32_16x16x32_bf16 a[4:7], v[64:67], v[132:135], a[4:7]
    v_mfma_f32_16x16x32_bf16 a[8:11], v[64:67], v[136:139], a[8:11]
    v_mfma_f32_16x16x32_bf16 a[12:15], v[64:67], v[140:143], a[12:15]
    v_mfma_f32_16x16x32_bf16 a[16:19], v[68:71], v[128:131], a[16:19]
    v_mfma_f32_16x16x32_bf16 a[20:23], v[68:71], v[132:135], a[20:23]
    v_mfma_f32_16x16x32_bf16 a[24:27], v[68:71], v[136:139], a[24:27]
    v_mfma_f32_16x16x32_bf16 a[28:31], v[68:71], v[140:143], a[28:31]
    v_mfma_f32_16x16x32_bf16 a[32:35], v[72:75], v[128:131], a[32:35]
    v_mfma_f32_16x16x32_bf16 a[36:39], v[72:75], v[132:135], a[36:39]
    v_mfma_f32_16x16x32_bf16 a[40:43], v[72:75], v[136:139], a[40:43]
    v_mfma_f32_16x16x32_bf16 a[44:47], v[72:75], v[140:143], a[44:47]
    v_mfma_f32_16x16x32_bf16 a[48:51], v[76:79], v[128:131], a[48:51]
    v_mfma_f32_16x16x32_bf16 a[52:55], v[76:79], v[132:135], a[52:55]
    v_mfma_f32_16x16x32_bf16 a[56:59], v[76:79], v[136:139], a[56:59]
    v_mfma_f32_16x16x32_bf16 a[60:63], v[76:79], v[140:143], a[60:63]
    v_mfma_f32_16x16x32_bf16 a[64:67], v[80:83], v[128:131], a[64:67]
    v_mfma_f32_16x16x32_bf16 a[68:71], v[80:83], v[132:135], a[68:71]
    v_mfma_f32_16x16x32_bf16 a[72:75], v[80:83], v[136:139], a[72:75]
    v_mfma_f32_16x16x32_bf16 a[76:79], v[80:83], v[140:143], a[76:79]
    v_mfma_f32_16x16x32_bf16 a[80:83], v[84:87], v[128:131], a[80:83]
    v_mfma_f32_16x16x32_bf16 a[84:87], v[84:87], v[132:135], a[84:87]
    v_mfma_f32_16x16x32_bf16 a[88:91], v[84:87], v[136:139], a[88:91]
    v_mfma_f32_16x16x32_bf16 a[92:95], v[84:87], v[140:143], a[92:95]
    v_mfma_f32_16x16x32_bf16 a[96:99], v[88:91], v[128:131], a[96:99]
    v_mfma_f32_16x16x32_bf16 a[100:103], v[88:91], v[132:135], a[100:103]
    v_mfma_f32_16x16x32_bf16 a[104:107], v[88:91], v[136:139], a[104:107]
    v_mfma_f32_16x16x32_bf16 a[108:111], v[88:91], v[140:143], a[108:111]
    v_mfma_f32_16x16x32_bf16 a[112:115], v[92:95], v[128:131], a[112:115]
    v_mfma_f32_16x16x32_bf16 a[116:119], v[92:95], v[132:135], a[116:119]
    v_mfma_f32_16x16x32_bf16 a[120:123], v[92:95], v[136:139], a[120:123]
    v_mfma_f32_16x16x32_bf16 a[124:127], v[92:95], v[140:143], a[124:127]
    s_add_u32 s14, s14, 4096
    buffer_load_dwordx4 v[128:131], v8, s[40:43], s14 offen offset:0
    buffer_load_dwordx4 v[132:135], v9, s[40:43], s14 offen offset:0
    buffer_load_dwordx4 v[136:139], v10, s[40:43], s14 offen offset:0
    buffer_load_dwordx4 v[140:143], v11, s[40:43], s14 offen offset:0
    ds_read_b128 v[64:67], v4 offset:7168
    ds_read_b128 v[68:71], v4 offset:23552
    ds_read_b128 v[72:75], v4 offset:39936
    ds_read_b128 v[76:79], v4 offset:56320
    ds_read_b128 v[80:83], v5 offset:7168
    ds_read_b128 v[84:87], v5 offset:23552
    ds_read_b128 v[88:91], v5 offset:39936
    ds_read_b128 v[92:95], v5 offset:56320
    s_waitcnt vmcnt(8) lgkmcnt(8)
    v_mfma_f32_16x16x32_bf16 a[0:3], v[32:35], v[96:99], a[0:3]
    v_mfma_f32_16x16x32_bf16 a[4:7], v[32:35], v[100:103], a[4:7]
    v_mfma_f32_16x16x32_bf16 a[8:11], v[32:35], v[104:107], a[8:11]
    v_mfma_f32_16x16x32_bf16 a[12:15], v[32:35], v[108:111], a[12:15]
    v_mfma_f32_16x16x32_bf16 a[16:19], v[36:39], v[96:99], a[16:19]
    v_mfma_f32_16x16x32_bf16 a[20:23], v[36:39], v[100:103], a[20:23]
    v_mfma_f32_16x16x32_bf16 a[24:27], v[36:39], v[104:107], a[24:27]
    v_mfma_f32_16x16x32_bf16 a[28:31], v[36:39], v[108:111], a[28:31]
    v_mfma_f32_16x16x32_bf16 a[32:35], v[40:43], v[96:99], a[32:35]
    v_mfma_f32_16x16x32_bf16 a[36:39], v[40:43], v[100:103], a[36:39]
    v_mfma_f32_16x16x32_bf16 a[40:43], v[40:43], v[104:107], a[40:43]
    v_mfma_f32_16x16x32_bf16 a[44:47], v[40:43], v[108:111], a[44:47]
    v_mfma_f32_16x16x32_bf16 a[48:51], v[44:47], v[96:99], a[48:51]
    v_mfma_f32_16x16x32_bf16 a[52:55], v[44:47], v[100:103], a[52:55]
    v_mfma_f32_16x16x32_bf16 a[56:59], v[44:47], v[104:107], a[56:59]
    v_mfma_f32_16x16x32_bf16 a[60:63], v[44:47], v[108:111], a[60:63]
    v_mfma_f32_16x16x32_bf16 a[64:67], v[48:51], v[96:99], a[64:67]
    v_mfma_f32_16x16x32_bf16 a[68:71], v[48:51], v[100:103], a[68:71]
    v_mfma_f32_16x16x32_bf16 a[72:75], v[48:51], v[104:107], a[72:75]
    v_mfma_f32_16x16x32_bf16 a[76:79], v[48:51], v[108:111], a[76:79]
    v_mfma_f32_16x16x32_bf16 a[80:83], v[52:55], v[96:99], a[80:83]
    v_mfma_f32_16x16x32_bf16 a[84:87], v[52:55], v[100:103], a[84:87]
    v_mfma_f32_16x16x32_bf16 a[88:91], v[52:55], v[104:107], a[88:91]
    v_mfma_f32_16x16x32_bf16 a[92:95], v[52:55], v[108:111], a[92:95]
    v_mfma_f32_16x16x32_bf16 a[96:99], v[56:59], v[96:99], a[96:99]
    v_mfma_f32_16x16x32_bf16 a[100:103], v[56:59], v[100:103], a[100:103]
    v_mfma_f32_16x16x32_bf16 a[104:107], v[56:59], v[104:107], a[104:107]
    v_mfma_f32_16x16x32_bf16 a[108:111], v[56:59], v[108:111], a[108:111]
    v_mfma_f32_16x16x32_bf16 a[112:115], v[60:63], v[96:99], a[112:115]
    v_mfma_f32_16x16x32_bf16 a[116:119], v[60:63], v[100:103], a[116:119]
    v_mfma_f32_16x16x32_bf16 a[120:123], v[60:63], v[104:107], a[120:123]
    v_mfma_f32_16x16x32_bf16 a[124:127], v[60:63], v[108:111], a[124:127]
    buffer_load_dwordx4 v[96:99], v8, s[40:43], s14 offen offset:1024
    buffer_load_dwordx4 v[100:103], v9, s[40:43], s14 offen offset:1024
    buffer_load_dwordx4 v[104:107], v10, s[40:43], s14 offen offset:1024
    buffer_load_dwordx4 v[108:111], v11, s[40:43], s14 offen offset:1024
    ds_read_b128 v[32:35], v4 offset:8192
    ds_read_b128 v[36:39], v4 offset:24576
    ds_read_b128 v[40:43], v4 offset:40960
    ds_read_b128 v[44:47], v4 offset:57344
    ds_read_b128 v[48:51], v5 offset:8192
    ds_read_b128 v[52:55], v5 offset:24576
    ds_read_b128 v[56:59], v5 offset:40960
    ds_read_b128 v[60:63], v5 offset:57344
    s_waitcnt vmcnt(8) lgkmcnt(8)
    v_mfma_f32_16x16x32_bf16 a[0:3], v[64:67], v[112:115], a[0:3]
    v_mfma_f32_16x16x32_bf16 a[4:7], v[64:67], v[116:119], a[4:7]
    v_mfma_f32_16x16x32_bf16 a[8:11], v[64:67], v[120:123], a[8:11]
    v_mfma_f32_16x16x32_bf16 a[12:15], v[64:67], v[124:127], a[12:15]
    v_mfma_f32_16x16x32_bf16 a[16:19], v[68:71], v[112:115], a[16:19]
    v_mfma_f32_16x16x32_bf16 a[20:23], v[68:71], v[116:119], a[20:23]
    v_mfma_f32_16x16x32_bf16 a[24:27], v[68:71], v[120:123], a[24:27]
    v_mfma_f32_16x16x32_bf16 a[28:31], v[68:71], v[124:127], a[28:31]
    v_mfma_f32_16x16x32_bf16 a[32:35], v[72:75], v[112:115], a[32:35]
    v_mfma_f32_16x16x32_bf16 a[36:39], v[72:75], v[116:119], a[36:39]
    v_mfma_f32_16x16x32_bf16 a[40:43], v[72:75], v[120:123], a[40:43]
    v_mfma_f32_16x16x32_bf16 a[44:47], v[72:75], v[124:127], a[44:47]
    v_mfma_f32_16x16x32_bf16 a[48:51], v[76:79], v[112:115], a[48:51]
    v_mfma_f32_16x16x32_bf16 a[52:55], v[76:79], v[116:119], a[52:55]
    v_mfma_f32_16x16x32_bf16 a[56:59], v[76:79], v[120:123], a[56:59]
    v_mfma_f32_16x16x32_bf16 a[60:63], v[76:79], v[124:127], a[60:63]
    v_mfma_f32_16x16x32_bf16 a[64:67], v[80:83], v[112:115], a[64:67]
    v_mfma_f32_16x16x32_bf16 a[68:71], v[80:83], v[116:119], a[68:71]
    v_mfma_f32_16x16x32_bf16 a[72:75], v[80:83], v[120:123], a[72:75]
    v_mfma_f32_16x16x32_bf16 a[76:79], v[80:83], v[124:127], a[76:79]
    v_mfma_f32_16x16x32_bf16 a[80:83], v[84:87], v[112:115], a[80:83]
    v_mfma_f32_16x16x32_bf16 a[84:87], v[84:87], v[116:119], a[84:87]
    v_mfma_f32_16x16x32_bf16 a[88:91], v[84:87], v[120:123], a[88:91]
    v_mfma_f32_16x16x32_bf16 a[92:95], v[84:87], v[124:127], a[92:95]
    v_mfma_f32_16x16x32_bf16 a[96:99], v[88:91], v[112:115], a[96:99]
    v_mfma_f32_16x16x32_bf16 a[100:103], v[88:91], v[116:119], a[100:103]
    v_mfma_f32_16x16x32_bf16 a[104:107], v[88:91], v[120:123], a[104:107]
    v_mfma_f32_16x16x32_bf16 a[108:111], v[88:91], v[124:127], a[108:111]
    v_mfma_f32_16x16x32_bf16 a[112:115], v[92:95], v[112:115], a[112:115]
    v_mfma_f32_16x16x32_bf16 a[116:119], v[92:95], v[116:119], a[116:119]
    v_mfma_f32_16x16x32_bf16 a[120:123], v[92:95], v[120:123], a[120:123]
    v_mfma_f32_16x16x32_bf16 a[124:127], v[92:95], v[124:127], a[124:127]
    buffer_load_dwordx4 v[112:115], v8, s[40:43], s14 offen offset:2048
    buffer_load_dwordx4 v[116:119], v9, s[40:43], s14 offen offset:2048
    buffer_load_dwordx4 v[120:123], v10, s[40:43], s14 offen offset:2048
    buffer_load_dwordx4 v[124:127], v11, s[40:43], s14 offen offset:2048
    ds_read_b128 v[64:67], v4 offset:9216
    ds_read_b128 v[68:71], v4 offset:25600
    ds_read_b128 v[72:75], v4 offset:41984
    ds_read_b128 v[76:79], v4 offset:58368
    ds_read_b128 v[80:83], v5 offset:9216
    ds_read_b128 v[84:87], v5 offset:25600
    ds_read_b128 v[88:91], v5 offset:41984
    ds_read_b128 v[92:95], v5 offset:58368
    s_waitcnt vmcnt(8) lgkmcnt(8)
    v_mfma_f32_16x16x32_bf16 a[0:3], v[32:35], v[128:131], a[0:3]
    v_mfma_f32_16x16x32_bf16 a[4:7], v[32:35], v[132:135], a[4:7]
    v_mfma_f32_16x16x32_bf16 a[8:11], v[32:35], v[136:139], a[8:11]
    v_mfma_f32_16x16x32_bf16 a[12:15], v[32:35], v[140:143], a[12:15]
    v_mfma_f32_16x16x32_bf16 a[16:19], v[36:39], v[128:131], a[16:19]
    v_mfma_f32_16x16x32_bf16 a[20:23], v[36:39], v[132:135], a[20:23]
    v_mfma_f32_16x16x32_bf16 a[24:27], v[36:39], v[136:139], a[24:27]
    v_mfma_f32_16x16x32_bf16 a[28:31], v[36:39], v[140:143], a[28:31]
    v_mfma_f32_16x16x32_bf16 a[32:35], v[40:43], v[128:131], a[32:35]
    v_mfma_f32_16x16x32_bf16 a[36:39], v[40:43], v[132:135], a[36:39]
    v_mfma_f32_16x16x32_bf16 a[40:43], v[40:43], v[136:139], a[40:43]
    v_mfma_f32_16x16x32_bf16 a[44:47], v[40:43], v[140:143], a[44:47]
    v_mfma_f32_16x16x32_bf16 a[48:51], v[44:47], v[128:131], a[48:51]
    v_mfma_f32_16x16x32_bf16 a[52:55], v[44:47], v[132:135], a[52:55]
    v_mfma_f32_16x16x32_bf16 a[56:59], v[44:47], v[136:139], a[56:59]
    v_mfma_f32_16x16x32_bf16 a[60:63], v[44:47], v[140:143], a[60:63]
    v_mfma_f32_16x16x32_bf16 a[64:67], v[48:51], v[128:131], a[64:67]
    v_mfma_f32_16x16x32_bf16 a[68:71], v[48:51], v[132:135], a[68:71]
    v_mfma_f32_16x16x32_bf16 a[72:75], v[48:51], v[136:139], a[72:75]
    v_mfma_f32_16x16x32_bf16 a[76:79], v[48:51], v[140:143], a[76:79]
    v_mfma_f32_16x16x32_bf16 a[80:83], v[52:55], v[128:131], a[80:83]
    v_mfma_f32_16x16x32_bf16 a[84:87], v[52:55], v[132:135], a[84:87]
    v_mfma_f32_16x16x32_bf16 a[88:91], v[52:55], v[136:139], a[88:91]
    v_mfma_f32_16x16x32_bf16 a[92:95], v[52:55], v[140:143], a[92:95]
    v_mfma_f32_16x16x32_bf16 a[96:99], v[56:59], v[128:131], a[96:99]
    v_mfma_f32_16x16x32_bf16 a[100:103], v[56:59], v[132:135], a[100:103]
    v_mfma_f32_16x16x32_bf16 a[104:107], v[56:59], v[136:139], a[104:107]
    v_mfma_f32_16x16x32_bf16 a[108:111], v[56:59], v[140:143], a[108:111]
    v_mfma_f32_16x16x32_bf16 a[112:115], v[60:63], v[128:131], a[112:115]
    v_mfma_f32_16x16x32_bf16 a[116:119], v[60:63], v[132:135], a[116:119]
    v_mfma_f32_16x16x32_bf16 a[120:123], v[60:63], v[136:139], a[120:123]
    v_mfma_f32_16x16x32_bf16 a[124:127], v[60:63], v[140:143], a[124:127]
    buffer_load_dwordx4 v[128:131], v8, s[40:43], s14 offen offset:3072
    buffer_load_dwordx4 v[132:135], v9, s[40:43], s14 offen offset:3072
    buffer_load_dwordx4 v[136:139], v10, s[40:43], s14 offen offset:3072
    buffer_load_dwordx4 v[140:143], v11, s[40:43], s14 offen offset:3072
    ds_read_b128 v[32:35], v4 offset:10240
    ds_read_b128 v[36:39], v4 offset:26624
    ds_read_b128 v[40:43], v4 offset:43008
    ds_read_b128 v[44:47], v4 offset:59392
    ds_read_b128 v[48:51], v5 offset:10240
    ds_read_b128 v[52:55], v5 offset:26624
    ds_read_b128 v[56:59], v5 offset:43008
    ds_read_b128 v[60:63], v5 offset:59392
    s_waitcnt vmcnt(8) lgkmcnt(8)
    v_mfma_f32_16x16x32_bf16 a[0:3], v[64:67], v[96:99], a[0:3]
    v_mfma_f32_16x16x32_bf16 a[4:7], v[64:67], v[100:103], a[4:7]
    v_mfma_f32_16x16x32_bf16 a[8:11], v[64:67], v[104:107], a[8:11]
    v_mfma_f32_16x16x32_bf16 a[12:15], v[64:67], v[108:111], a[12:15]
    v_mfma_f32_16x16x32_bf16 a[16:19], v[68:71], v[96:99], a[16:19]
    v_mfma_f32_16x16x32_bf16 a[20:23], v[68:71], v[100:103], a[20:23]
    v_mfma_f32_16x16x32_bf16 a[24:27], v[68:71], v[104:107], a[24:27]
    v_mfma_f32_16x16x32_bf16 a[28:31], v[68:71], v[108:111], a[28:31]
    v_mfma_f32_16x16x32_bf16 a[32:35], v[72:75], v[96:99], a[32:35]
    v_mfma_f32_16x16x32_bf16 a[36:39], v[72:75], v[100:103], a[36:39]
    v_mfma_f32_16x16x32_bf16 a[40:43], v[72:75], v[104:107], a[40:43]
    v_mfma_f32_16x16x32_bf16 a[44:47], v[72:75], v[108:111], a[44:47]
    v_mfma_f32_16x16x32_bf16 a[48:51], v[76:79], v[96:99], a[48:51]
    v_mfma_f32_16x16x32_bf16 a[52:55], v[76:79], v[100:103], a[52:55]
    v_mfma_f32_16x16x32_bf16 a[56:59], v[76:79], v[104:107], a[56:59]
    v_mfma_f32_16x16x32_bf16 a[60:63], v[76:79], v[108:111], a[60:63]
    v_mfma_f32_16x16x32_bf16 a[64:67], v[80:83], v[96:99], a[64:67]
    v_mfma_f32_16x16x32_bf16 a[68:71], v[80:83], v[100:103], a[68:71]
    v_mfma_f32_16x16x32_bf16 a[72:75], v[80:83], v[104:107], a[72:75]
    v_mfma_f32_16x16x32_bf16 a[76:79], v[80:83], v[108:111], a[76:79]
    v_mfma_f32_16x16x32_bf16 a[80:83], v[84:87], v[96:99], a[80:83]
    v_mfma_f32_16x16x32_bf16 a[84:87], v[84:87], v[100:103], a[84:87]
    v_mfma_f32_16x16x32_bf16 a[88:91], v[84:87], v[104:107], a[88:91]
    v_mfma_f32_16x16x32_bf16 a[92:95], v[84:87], v[108:111], a[92:95]
    v_mfma_f32_16x16x32_bf16 a[96:99], v[88:91], v[96:99], a[96:99]
    v_mfma_f32_16x16x32_bf16 a[100:103], v[88:91], v[100:103], a[100:103]
    v_mfma_f32_16x16x32_bf16 a[104:107], v[88:91], v[104:107], a[104:107]
    v_mfma_f32_16x16x32_bf16 a[108:111], v[88:91], v[108:111], a[108:111]
    v_mfma_f32_16x16x32_bf16 a[112:115], v[92:95], v[96:99], a[112:115]
    v_mfma_f32_16x16x32_bf16 a[116:119], v[92:95], v[100:103], a[116:119]
    v_mfma_f32_16x16x32_bf16 a[120:123], v[92:95], v[104:107], a[120:123]
    v_mfma_f32_16x16x32_bf16 a[124:127], v[92:95], v[108:111], a[124:127]
    s_add_u32 s14, s14, 4096
    buffer_load_dwordx4 v[96:99], v8, s[40:43], s14 offen offset:0
    buffer_load_dwordx4 v[100:103], v9, s[40:43], s14 offen offset:0
    buffer_load_dwordx4 v[104:107], v10, s[40:43], s14 offen offset:0
    buffer_load_dwordx4 v[108:111], v11, s[40:43], s14 offen offset:0
    ds_read_b128 v[64:67], v4 offset:11264
    ds_read_b128 v[68:71], v4 offset:27648
    ds_read_b128 v[72:75], v4 offset:44032
    ds_read_b128 v[76:79], v4 offset:60416
    ds_read_b128 v[80:83], v5 offset:11264
    ds_read_b128 v[84:87], v5 offset:27648
    ds_read_b128 v[88:91], v5 offset:44032
    ds_read_b128 v[92:95], v5 offset:60416
    s_waitcnt vmcnt(8) lgkmcnt(8)
    v_mfma_f32_16x16x32_bf16 a[0:3], v[32:35], v[112:115], a[0:3]
    v_mfma_f32_16x16x32_bf16 a[4:7], v[32:35], v[116:119], a[4:7]
    v_mfma_f32_16x16x32_bf16 a[8:11], v[32:35], v[120:123], a[8:11]
    v_mfma_f32_16x16x32_bf16 a[12:15], v[32:35], v[124:127], a[12:15]
    v_mfma_f32_16x16x32_bf16 a[16:19], v[36:39], v[112:115], a[16:19]
    v_mfma_f32_16x16x32_bf16 a[20:23], v[36:39], v[116:119], a[20:23]
    v_mfma_f32_16x16x32_bf16 a[24:27], v[36:39], v[120:123], a[24:27]
    v_mfma_f32_16x16x32_bf16 a[28:31], v[36:39], v[124:127], a[28:31]
    v_mfma_f32_16x16x32_bf16 a[32:35], v[40:43], v[112:115], a[32:35]
    v_mfma_f32_16x16x32_bf16 a[36:39], v[40:43], v[116:119], a[36:39]
    v_mfma_f32_16x16x32_bf16 a[40:43], v[40:43], v[120:123], a[40:43]
    v_mfma_f32_16x16x32_bf16 a[44:47], v[40:43], v[124:127], a[44:47]
    v_mfma_f32_16x16x32_bf16 a[48:51], v[44:47], v[112:115], a[48:51]
    v_mfma_f32_16x16x32_bf16 a[52:55], v[44:47], v[116:119], a[52:55]
    v_mfma_f32_16x16x32_bf16 a[56:59], v[44:47], v[120:123], a[56:59]
    v_mfma_f32_16x16x32_bf16 a[60:63], v[44:47], v[124:127], a[60:63]
    v_mfma_f32_16x16x32_bf16 a[64:67], v[48:51], v[112:115], a[64:67]
    v_mfma_f32_16x16x32_bf16 a[68:71], v[48:51], v[116:119], a[68:71]
    v_mfma_f32_16x16x32_bf16 a[72:75], v[48:51], v[120:123], a[72:75]
    v_mfma_f32_16x16x32_bf16 a[76:79], v[48:51], v[124:127], a[76:79]
    v_mfma_f32_16x16x32_bf16 a[80:83], v[52:55], v[112:115], a[80:83]
    v_mfma_f32_16x16x32_bf16 a[84:87], v[52:55], v[116:119], a[84:87]
    v_mfma_f32_16x16x32_bf16 a[88:91], v[52:55], v[120:123], a[88:91]
    v_mfma_f32_16x16x32_bf16 a[92:95], v[52:55], v[124:127], a[92:95]
    v_mfma_f32_16x16x32_bf16 a[96:99], v[56:59], v[112:115], a[96:99]
    v_mfma_f32_16x16x32_bf16 a[100:103], v[56:59], v[116:119], a[100:103]
    v_mfma_f32_16x16x32_bf16 a[104:107], v[56:59], v[120:123], a[104:107]
    v_mfma_f32_16x16x32_bf16 a[108:111], v[56:59], v[124:127], a[108:111]
    v_mfma_f32_16x16x32_bf16 a[112:115], v[60:63], v[112:115], a[112:115]
    v_mfma_f32_16x16x32_bf16 a[116:119], v[60:63], v[116:119], a[116:119]
    v_mfma_f32_16x16x32_bf16 a[120:123], v[60:63], v[120:123], a[120:123]
    v_mfma_f32_16x16x32_bf16 a[124:127], v[60:63], v[124:127], a[124:127]
    buffer_load_dwordx4 v[112:115], v8, s[40:43], s14 offen offset:1024
    buffer_load_dwordx4 v[116:119], v9, s[40:43], s14 offen offset:1024
    buffer_load_dwordx4 v[120:123], v10, s[40:43], s14 offen offset:1024
    buffer_load_dwordx4 v[124:127], v11, s[40:43], s14 offen offset:1024
    ds_read_b128 v[32:35], v4 offset:12288
    ds_read_b128 v[36:39], v4 offset:28672
    ds_read_b128 v[40:43], v4 offset:45056
    ds_read_b128 v[44:47], v4 offset:61440
    ds_read_b128 v[48:51], v5 offset:12288
    ds_read_b128 v[52:55], v5 offset:28672
    ds_read_b128 v[56:59], v5 offset:45056
    ds_read_b128 v[60:63], v5 offset:61440
    s_waitcnt vmcnt(8) lgkmcnt(8)
    v_mfma_f32_16x16x32_bf16 a[0:3], v[64:67], v[128:131], a[0:3]
    v_mfma_f32_16x16x32_bf16 a[4:7], v[64:67], v[132:135], a[4:7]
    v_mfma_f32_16x16x32_bf16 a[8:11], v[64:67], v[136:139], a[8:11]
    v_mfma_f32_16x16x32_bf16 a[12:15], v[64:67], v[140:143], a[12:15]
    v_mfma_f32_16x16x32_bf16 a[16:19], v[68:71], v[128:131], a[16:19]
    v_mfma_f32_16x16x32_bf16 a[20:23], v[68:71], v[132:135], a[20:23]
    v_mfma_f32_16x16x32_bf16 a[24:27], v[68:71], v[136:139], a[24:27]
    v_mfma_f32_16x16x32_bf16 a[28:31], v[68:71], v[140:143], a[28:31]
    v_mfma_f32_16x16x32_bf16 a[32:35], v[72:75], v[128:131], a[32:35]
    v_mfma_f32_16x16x32_bf16 a[36:39], v[72:75], v[132:135], a[36:39]
    v_mfma_f32_16x16x32_bf16 a[40:43], v[72:75], v[136:139], a[40:43]
    v_mfma_f32_16x16x32_bf16 a[44:47], v[72:75], v[140:143], a[44:47]
    v_mfma_f32_16x16x32_bf16 a[48:51], v[76:79], v[128:131], a[48:51]
    v_mfma_f32_16x16x32_bf16 a[52:55], v[76:79], v[132:135], a[52:55]
    v_mfma_f32_16x16x32_bf16 a[56:59], v[76:79], v[136:139], a[56:59]
    v_mfma_f32_16x16x32_bf16 a[60:63], v[76:79], v[140:143], a[60:63]
    v_mfma_f32_16x16x32_bf16 a[64:67], v[80:83], v[128:131], a[64:67]
    v_mfma_f32_16x16x32_bf16 a[68:71], v[80:83], v[132:135], a[68:71]
    v_mfma_f32_16x16x32_bf16 a[72:75], v[80:83], v[136:139], a[72:75]
    v_mfma_f32_16x16x32_bf16 a[76:79], v[80:83], v[140:143], a[76:79]
    v_mfma_f32_16x16x32_bf16 a[80:83], v[84:87], v[128:131], a[80:83]
    v_mfma_f32_16x16x32_bf16 a[84:87], v[84:87], v[132:135], a[84:87]
    v_mfma_f32_16x16x32_bf16 a[88:91], v[84:87], v[136:139], a[88:91]
    v_mfma_f32_16x16x32_bf16 a[92:95], v[84:87], v[140:143], a[92:95]
    v_mfma_f32_16x16x32_bf16 a[96:99], v[88:91], v[128:131], a[96:99]
    v_mfma_f32_16x16x32_bf16 a[100:103], v[88:91], v[132:135], a[100:103]
    v_mfma_f32_16x16x32_bf16 a[104:107], v[88:91], v[136:139], a[104:107]
    v_mfma_f32_16x16x32_bf16 a[108:111], v[88:91], v[140:143], a[108:111]
    v_mfma_f32_16x16x32_bf16 a[112:115], v[92:95], v[128:131], a[112:115]
    v_mfma_f32_16x16x32_bf16 a[116:119], v[92:95], v[132:135], a[116:119]
    v_mfma_f32_16x16x32_bf16 a[120:123], v[92:95], v[136:139], a[120:123]
    v_mfma_f32_16x16x32_bf16 a[124:127], v[92:95], v[140:143], a[124:127]
    buffer_load_dwordx4 v[128:131], v8, s[40:43], s14 offen offset:2048
    buffer_load_dwordx4 v[132:135], v9, s[40:43], s14 offen offset:2048
    buffer_load_dwordx4 v[136:139], v10, s[40:43], s14 offen offset:2048
    buffer_load_dwordx4 v[140:143], v11, s[40:43], s14 offen offset:2048
    ds_read_b128 v[64:67], v4 offset:13312
    ds_read_b128 v[68:71], v4 offset:29696
    ds_read_b128 v[72:75], v4 offset:46080
    ds_read_b128 v[76:79], v4 offset:62464
    ds_read_b128 v[80:83], v5 offset:13312
    ds_read_b128 v[84:87], v5 offset:29696
    ds_read_b128 v[88:91], v5 offset:46080
    ds_read_b128 v[92:95], v5 offset:62464
    s_waitcnt vmcnt(8) lgkmcnt(8)
    v_mfma_f32_16x16x32_bf16 a[0:3], v[32:35], v[96:99], a[0:3]
    v_mfma_f32_16x16x32_bf16 a[4:7], v[32:35], v[100:103], a[4:7]
    v_mfma_f32_16x16x32_bf16 a[8:11], v[32:35], v[104:107], a[8:11]
    v_mfma_f32_16x16x32_bf16 a[12:15], v[32:35], v[108:111], a[12:15]
    v_mfma_f32_16x16x32_bf16 a[16:19], v[36:39], v[96:99], a[16:19]
    v_mfma_f32_16x16x32_bf16 a[20:23], v[36:39], v[100:103], a[20:23]
    v_mfma_f32_16x16x32_bf16 a[24:27], v[36:39], v[104:107], a[24:27]
    v_mfma_f32_16x16x32_bf16 a[28:31], v[36:39], v[108:111], a[28:31]
    v_mfma_f32_16x16x32_bf16 a[32:35], v[40:43], v[96:99], a[32:35]
    v_mfma_f32_16x16x32_bf16 a[36:39], v[40:43], v[100:103], a[36:39]
    v_mfma_f32_16x16x32_bf16 a[40:43], v[40:43], v[104:107], a[40:43]
    v_mfma_f32_16x16x32_bf16 a[44:47], v[40:43], v[108:111], a[44:47]
    v_mfma_f32_16x16x32_bf16 a[48:51], v[44:47], v[96:99], a[48:51]
    v_mfma_f32_16x16x32_bf16 a[52:55], v[44:47], v[100:103], a[52:55]
    v_mfma_f32_16x16x32_bf16 a[56:59], v[44:47], v[104:107], a[56:59]
    v_mfma_f32_16x16x32_bf16 a[60:63], v[44:47], v[108:111], a[60:63]
    v_mfma_f32_16x16x32_bf16 a[64:67], v[48:51], v[96:99], a[64:67]
    v_mfma_f32_16x16x32_bf16 a[68:71], v[48:51], v[100:103], a[68:71]
    v_mfma_f32_16x16x32_bf16 a[72:75], v[48:51], v[104:107], a[72:75]
    v_mfma_f32_16x16x32_bf16 a[76:79], v[48:51], v[108:111], a[76:79]
    v_mfma_f32_16x16x32_bf16 a[80:83], v[52:55], v[96:99], a[80:83]
    v_mfma_f32_16x16x32_bf16 a[84:87], v[52:55], v[100:103], a[84:87]
    v_mfma_f32_16x16x32_bf16 a[88:91], v[52:55], v[104:107], a[88:91]
    v_mfma_f32_16x16x32_bf16 a[92:95], v[52:55], v[108:111], a[92:95]
    v_mfma_f32_16x16x32_bf16 a[96:99], v[56:59], v[96:99], a[96:99]
    v_mfma_f32_16x16x32_bf16 a[100:103], v[56:59], v[100:103], a[100:103]
    v_mfma_f32_16x16x32_bf16 a[104:107], v[56:59], v[104:107], a[104:107]
    v_mfma_f32_16x16x32_bf16 a[108:111], v[56:59], v[108:111], a[108:111]
    v_mfma_f32_16x16x32_bf16 a[112:115], v[60:63], v[96:99], a[112:115]
    v_mfma_f32_16x16x32_bf16 a[116:119], v[60:63], v[100:103], a[116:119]
    v_mfma_f32_16x16x32_bf16 a[120:123], v[60:63], v[104:107], a[120:123]
    v_mfma_f32_16x16x32_bf16 a[124:127], v[60:63], v[108:111], a[124:127]
    buffer_load_dwordx4 v[96:99], v8, s[40:43], s14 offen offset:3072
    buffer_load_dwordx4 v[100:103], v9, s[40:43], s14 offen offset:3072
    buffer_load_dwordx4 v[104:107], v10, s[40:43], s14 offen offset:3072
    buffer_load_dwordx4 v[108:111], v11, s[40:43], s14 offen offset:3072
    ds_read_b128 v[32:35], v4 offset:14336
    ds_read_b128 v[36:39], v4 offset:30720
    ds_read_b128 v[40:43], v4 offset:47104
    ds_read_b128 v[44:47], v4 offset:63488
    ds_read_b128 v[48:51], v5 offset:14336
    ds_read_b128 v[52:55], v5 offset:30720
    ds_read_b128 v[56:59], v5 offset:47104
    ds_read_b128 v[60:63], v5 offset:63488
    s_waitcnt vmcnt(8) lgkmcnt(8)
    v_mfma_f32_16x16x32_bf16 a[0:3], v[64:67], v[112:115], a[0:3]
    v_mfma_f32_16x16x32_bf16 a[4:7], v[64:67], v[116:119], a[4:7]
    v_mfma_f32_16x16x32_bf16 a[8:11], v[64:67], v[120:123], a[8:11]
    v_mfma_f32_16x16x32_bf16 a[12:15], v[64:67], v[124:127], a[12:15]
    v_mfma_f32_16x16x32_bf16 a[16:19], v[68:71], v[112:115], a[16:19]
    v_mfma_f32_16x16x32_bf16 a[20:23], v[68:71], v[116:119], a[20:23]
    v_mfma_f32_16x16x32_bf16 a[24:27], v[68:71], v[120:123], a[24:27]
    v_mfma_f32_16x16x32_bf16 a[28:31], v[68:71], v[124:127], a[28:31]
    v_mfma_f32_16x16x32_bf16 a[32:35], v[72:75], v[112:115], a[32:35]
    v_mfma_f32_16x16x32_bf16 a[36:39], v[72:75], v[116:119], a[36:39]
    v_mfma_f32_16x16x32_bf16 a[40:43], v[72:75], v[120:123], a[40:43]
    v_mfma_f32_16x16x32_bf16 a[44:47], v[72:75], v[124:127], a[44:47]
    v_mfma_f32_16x16x32_bf16 a[48:51], v[76:79], v[112:115], a[48:51]
    v_mfma_f32_16x16x32_bf16 a[52:55], v[76:79], v[116:119], a[52:55]
    v_mfma_f32_16x16x32_bf16 a[56:59], v[76:79], v[120:123], a[56:59]
    v_mfma_f32_16x16x32_bf16 a[60:63], v[76:79], v[124:127], a[60:63]
    v_mfma_f32_16x16x32_bf16 a[64:67], v[80:83], v[112:115], a[64:67]
    v_mfma_f32_16x16x32_bf16 a[68:71], v[80:83], v[116:119], a[68:71]
    v_mfma_f32_16x16x32_bf16 a[72:75], v[80:83], v[120:123], a[72:75]
    v_mfma_f32_16x16x32_bf16 a[76:79], v[80:83], v[124:127], a[76:79]
    v_mfma_f32_16x16x32_bf16 a[80:83], v[84:87], v[112:115], a[80:83]
    v_mfma_f32_16x16x32_bf16 a[84:87], v[84:87], v[116:119], a[84:87]
    v_mfma_f32_16x16x32_bf16 a[88:91], v[84:87], v[120:123], a[88:91]
    v_mfma_f32_16x16x32_bf16 a[92:95], v[84:87], v[124:127], a[92:95]
    v_mfma_f32_16x16x32_bf16 a[96:99], v[88:91], v[112:115], a[96:99]
    v_mfma_f32_16x16x32_bf16 a[100:103], v[88:91], v[116:119], a[100:103]
    v_mfma_f32_16x16x32_bf16 a[104:107], v[88:91], v[120:123], a[104:107]
    v_mfma_f32_16x16x32_bf16 a[108:111], v[88:91], v[124:127], a[108:111]
    v_mfma_f32_16x16x32_bf16 a[112:115], v[92:95], v[112:115], a[112:115]
    v_mfma_f32_16x16x32_bf16 a[116:119], v[92:95], v[116:119], a[116:119]
    v_mfma_f32_16x16x32_bf16 a[120:123], v[92:95], v[120:123], a[120:123]
    v_mfma_f32_16x16x32_bf16 a[124:127], v[92:95], v[124:127], a[124:127]
    ds_read_b128 v[64:67], v4 offset:15360
    ds_read_b128 v[68:71], v4 offset:31744
    ds_read_b128 v[72:75], v4 offset:48128
    ds_read_b128 v[76:79], v4 offset:64512
    ds_read_b128 v[80:83], v5 offset:15360
    ds_read_b128 v[84:87], v5 offset:31744
    ds_read_b128 v[88:91], v5 offset:48128
    ds_read_b128 v[92:95], v5 offset:64512
    s_waitcnt vmcnt(4) lgkmcnt(8)
    v_mfma_f32_16x16x32_bf16 a[0:3], v[32:35], v[128:131], a[0:3]
    v_mfma_f32_16x16x32_bf16 a[4:7], v[32:35], v[132:135], a[4:7]
    v_mfma_f32_16x16x32_bf16 a[8:11], v[32:35], v[136:139], a[8:11]
    v_mfma_f32_16x16x32_bf16 a[12:15], v[32:35], v[140:143], a[12:15]
    v_mfma_f32_16x16x32_bf16 a[16:19], v[36:39], v[128:131], a[16:19]
    v_mfma_f32_16x16x32_bf16 a[20:23], v[36:39], v[132:135], a[20:23]
    v_mfma_f32_16x16x32_bf16 a[24:27], v[36:39], v[136:139], a[24:27]
    v_mfma_f32_16x16x32_bf16 a[28:31], v[36:39], v[140:143], a[28:31]
    v_mfma_f32_16x16x32_bf16 a[32:35], v[40:43], v[128:131], a[32:35]
    v_mfma_f32_16x16x32_bf16 a[36:39], v[40:43], v[132:135], a[36:39]
    v_mfma_f32_16x16x32_bf16 a[40:43], v[40:43], v[136:139], a[40:43]
    v_mfma_f32_16x16x32_bf16 a[44:47], v[40:43], v[140:143], a[44:47]
    v_mfma_f32_16x16x32_bf16 a[48:51], v[44:47], v[128:131], a[48:51]
    v_mfma_f32_16x16x32_bf16 a[52:55], v[44:47], v[132:135], a[52:55]
    v_mfma_f32_16x16x32_bf16 a[56:59], v[44:47], v[136:139], a[56:59]
    v_mfma_f32_16x16x32_bf16 a[60:63], v[44:47], v[140:143], a[60:63]
    v_mfma_f32_16x16x32_bf16 a[64:67], v[48:51], v[128:131], a[64:67]
    v_mfma_f32_16x16x32_bf16 a[68:71], v[48:51], v[132:135], a[68:71]
    v_mfma_f32_16x16x32_bf16 a[72:75], v[48:51], v[136:139], a[72:75]
    v_mfma_f32_16x16x32_bf16 a[76:79], v[48:51], v[140:143], a[76:79]
    v_mfma_f32_16x16x32_bf16 a[80:83], v[52:55], v[128:131], a[80:83]
    v_mfma_f32_16x16x32_bf16 a[84:87], v[52:55], v[132:135], a[84:87]
    v_mfma_f32_16x16x32_bf16 a[88:91], v[52:55], v[136:139], a[88:91]
    v_mfma_f32_16x16x32_bf16 a[92:95], v[52:55], v[140:143], a[92:95]
    v_mfma_f32_16x16x32_bf16 a[96:99], v[56:59], v[128:131], a[96:99]
    v_mfma_f32_16x16x32_bf16 a[100:103], v[56:59], v[132:135], a[100:103]
    v_mfma_f32_16x16x32_bf16 a[104:107], v[56:59], v[136:139], a[104:107]
    v_mfma_f32_16x16x32_bf16 a[108:111], v[56:59], v[140:143], a[108:111]
    v_mfma_f32_16x16x32_bf16 a[112:115], v[60:63], v[128:131], a[112:115]
    v_mfma_f32_16x16x32_bf16 a[116:119], v[60:63], v[132:135], a[116:119]
    v_mfma_f32_16x16x32_bf16 a[120:123], v[60:63], v[136:139], a[120:123]
    v_mfma_f32_16x16x32_bf16 a[124:127], v[60:63], v[140:143], a[124:127]
    s_waitcnt vmcnt(0) lgkmcnt(0)
    v_mfma_f32_16x16x32_bf16 a[0:3], v[64:67], v[96:99], a[0:3]
    v_mfma_f32_16x16x32_bf16 a[4:7], v[64:67], v[100:103], a[4:7]
    v_mfma_f32_16x16x32_bf16 a[8:11], v[64:67], v[104:107], a[8:11]
    v_mfma_f32_16x16x32_bf16 a[12:15], v[64:67], v[108:111], a[12:15]
    v_mfma_f32_16x16x32_bf16 a[16:19], v[68:71], v[96:99], a[16:19]
    v_mfma_f32_16x16x32_bf16 a[20:23], v[68:71], v[100:103], a[20:23]
    v_mfma_f32_16x16x32_bf16 a[24:27], v[68:71], v[104:107], a[24:27]
    v_mfma_f32_16x16x32_bf16 a[28:31], v[68:71], v[108:111], a[28:31]
    v_mfma_f32_16x16x32_bf16 a[32:35], v[72:75], v[96:99], a[32:35]
    v_mfma_f32_16x16x32_bf16 a[36:39], v[72:75], v[100:103], a[36:39]
    v_mfma_f32_16x16x32_bf16 a[40:43], v[72:75], v[104:107], a[40:43]
    v_mfma_f32_16x16x32_bf16 a[44:47], v[72:75], v[108:111], a[44:47]
    v_mfma_f32_16x16x32_bf16 a[48:51], v[76:79], v[96:99], a[48:51]
    v_mfma_f32_16x16x32_bf16 a[52:55], v[76:79], v[100:103], a[52:55]
    v_mfma_f32_16x16x32_bf16 a[56:59], v[76:79], v[104:107], a[56:59]
    v_mfma_f32_16x16x32_bf16 a[60:63], v[76:79], v[108:111], a[60:63]
    v_mfma_f32_16x16x32_bf16 a[64:67], v[80:83], v[96:99], a[64:67]
    v_mfma_f32_16x16x32_bf16 a[68:71], v[80:83], v[100:103], a[68:71]
    v_mfma_f32_16x16x32_bf16 a[72:75], v[80:83], v[104:107], a[72:75]
    v_mfma_f32_16x16x32_bf16 a[76:79], v[80:83], v[108:111], a[76:79]
    v_mfma_f32_16x16x32_bf16 a[80:83], v[84:87], v[96:99], a[80:83]
    v_mfma_f32_16x16x32_bf16 a[84:87], v[84:87], v[100:103], a[84:87]
    v_mfma_f32_16x16x32_bf16 a[88:91], v[84:87], v[104:107], a[88:91]
    v_mfma_f32_16x16x32_bf16 a[92:95], v[84:87], v[108:111], a[92:95]
    v_mfma_f32_16x16x32_bf16 a[96:99], v[88:91], v[96:99], a[96:99]
    v_mfma_f32_16x16x32_bf16 a[100:103], v[88:91], v[100:103], a[100:103]
    v_mfma_f32_16x16x32_bf16 a[104:107], v[88:91], v[104:107], a[104:107]
    v_mfma_f32_16x16x32_bf16 a[108:111], v[88:91], v[108:111], a[108:111]
    v_mfma_f32_16x16x32_bf16 a[112:115], v[92:95], v[96:99], a[112:115]
    v_mfma_f32_16x16x32_bf16 a[116:119], v[92:95], v[100:103], a[116:119]
    v_mfma_f32_16x16x32_bf16 a[120:123], v[92:95], v[104:107], a[120:123]
    v_mfma_f32_16x16x32_bf16 a[124:127], v[92:95], v[108:111], a[124:127]
    s_nop 9
    s_lshl_b32 s17, s4, 20
    s_add_u32 s17, s17, 58720256
    s_lshl_b32 s18, s15, 13
    s_add_u32 s17, s17, s18
    s_lshl_b32 s18, s16, 10
    s_add_u32 s17, s17, s18
    v_accvgpr_read_b32 v20, a0
    v_accvgpr_read_b32 v24, a16
    v_accvgpr_read_b32 v21, a1
    v_accvgpr_read_b32 v25, a17
    v_accvgpr_read_b32 v22, a2
    v_accvgpr_read_b32 v26, a18
    v_accvgpr_read_b32 v23, a3
    v_accvgpr_read_b32 v27, a19
    v_cvt_pk_bf16_f32 v16, v20, v21
    v_cvt_pk_bf16_f32 v17, v22, v23
    v_cvt_pk_bf16_f32 v18, v24, v25
    v_cvt_pk_bf16_f32 v19, v26, v27
    s_add_u32 s18, s17, 0
    buffer_store_dwordx4 v[16:19], v4, s[40:43], s18 offen sc0 sc1
    v_accvgpr_read_b32 v36, a4
    v_accvgpr_read_b32 v40, a20
    v_accvgpr_read_b32 v37, a5
    v_accvgpr_read_b32 v41, a21
    v_accvgpr_read_b32 v38, a6
    v_accvgpr_read_b32 v42, a22
    v_accvgpr_read_b32 v39, a7
    v_accvgpr_read_b32 v43, a23
    v_cvt_pk_bf16_f32 v32, v36, v37
    v_cvt_pk_bf16_f32 v33, v38, v39
    v_cvt_pk_bf16_f32 v34, v40, v41
    v_cvt_pk_bf16_f32 v35, v42, v43
    s_add_u32 s18, s17, 1024
    buffer_store_dwordx4 v[32:35], v4, s[40:43], s18 offen sc0 sc1
    v_accvgpr_read_b32 v20, a8
    v_accvgpr_read_b32 v24, a24
    v_accvgpr_read_b32 v21, a9
    v_accvgpr_read_b32 v25, a25
    v_accvgpr_read_b32 v22, a10
    v_accvgpr_read_b32 v26, a26
    v_accvgpr_read_b32 v23, a11
    v_accvgpr_read_b32 v27, a27
    v_cvt_pk_bf16_f32 v16, v20, v21
    v_cvt_pk_bf16_f32 v17, v22, v23
    v_cvt_pk_bf16_f32 v18, v24, v25
    v_cvt_pk_bf16_f32 v19, v26, v27
    s_add_u32 s18, s17, 2048
    buffer_store_dwordx4 v[16:19], v4, s[40:43], s18 offen sc0 sc1
    v_accvgpr_read_b32 v36, a12
    v_accvgpr_read_b32 v40, a28
    v_accvgpr_read_b32 v37, a13
    v_accvgpr_read_b32 v41, a29
    v_accvgpr_read_b32 v38, a14
    v_accvgpr_read_b32 v42, a30
    v_accvgpr_read_b32 v39, a15
    v_accvgpr_read_b32 v43, a31
    v_cvt_pk_bf16_f32 v32, v36, v37
    v_cvt_pk_bf16_f32 v33, v38, v39
    v_cvt_pk_bf16_f32 v34, v40, v41
    v_cvt_pk_bf16_f32 v35, v42, v43
    s_add_u32 s18, s17, 3072
    buffer_store_dwordx4 v[32:35], v4, s[40:43], s18 offen sc0 sc1
    v_accvgpr_read_b32 v20, a32
    v_accvgpr_read_b32 v24, a48
    v_accvgpr_read_b32 v21, a33
    v_accvgpr_read_b32 v25, a49
    v_accvgpr_read_b32 v22, a34
    v_accvgpr_read_b32 v26, a50
    v_accvgpr_read_b32 v23, a35
    v_accvgpr_read_b32 v27, a51
    v_cvt_pk_bf16_f32 v16, v20, v21
    v_cvt_pk_bf16_f32 v17, v22, v23
    v_cvt_pk_bf16_f32 v18, v24, v25
    v_cvt_pk_bf16_f32 v19, v26, v27
    s_add_u32 s18, s17, 262144
    buffer_store_dwordx4 v[16:19], v4, s[40:43], s18 offen sc0 sc1
    v_accvgpr_read_b32 v36, a36
    v_accvgpr_read_b32 v40, a52
    v_accvgpr_read_b32 v37, a37
    v_accvgpr_read_b32 v41, a53
    v_accvgpr_read_b32 v38, a38
    v_accvgpr_read_b32 v42, a54
    v_accvgpr_read_b32 v39, a39
    v_accvgpr_read_b32 v43, a55
    v_cvt_pk_bf16_f32 v32, v36, v37
    v_cvt_pk_bf16_f32 v33, v38, v39
    v_cvt_pk_bf16_f32 v34, v40, v41
    v_cvt_pk_bf16_f32 v35, v42, v43
    s_add_u32 s18, s17, 263168
    buffer_store_dwordx4 v[32:35], v4, s[40:43], s18 offen sc0 sc1
    v_accvgpr_read_b32 v20, a40
    v_accvgpr_read_b32 v24, a56
    v_accvgpr_read_b32 v21, a41
    v_accvgpr_read_b32 v25, a57
    v_accvgpr_read_b32 v22, a42
    v_accvgpr_read_b32 v26, a58
    v_accvgpr_read_b32 v23, a43
    v_accvgpr_read_b32 v27, a59
    v_cvt_pk_bf16_f32 v16, v20, v21
    v_cvt_pk_bf16_f32 v17, v22, v23
    v_cvt_pk_bf16_f32 v18, v24, v25
    v_cvt_pk_bf16_f32 v19, v26, v27
    s_add_u32 s18, s17, 264192
    buffer_store_dwordx4 v[16:19], v4, s[40:43], s18 offen sc0 sc1
    v_accvgpr_read_b32 v36, a44
    v_accvgpr_read_b32 v40, a60
    v_accvgpr_read_b32 v37, a45
    v_accvgpr_read_b32 v41, a61
    v_accvgpr_read_b32 v38, a46
    v_accvgpr_read_b32 v42, a62
    v_accvgpr_read_b32 v39, a47
    v_accvgpr_read_b32 v43, a63
    v_cvt_pk_bf16_f32 v32, v36, v37
    v_cvt_pk_bf16_f32 v33, v38, v39
    v_cvt_pk_bf16_f32 v34, v40, v41
    v_cvt_pk_bf16_f32 v35, v42, v43
    s_add_u32 s18, s17, 265216
    buffer_store_dwordx4 v[32:35], v4, s[40:43], s18 offen sc0 sc1
    v_accvgpr_read_b32 v20, a64
    v_accvgpr_read_b32 v24, a80
    v_accvgpr_read_b32 v21, a65
    v_accvgpr_read_b32 v25, a81
    v_accvgpr_read_b32 v22, a66
    v_accvgpr_read_b32 v26, a82
    v_accvgpr_read_b32 v23, a67
    v_accvgpr_read_b32 v27, a83
    v_cvt_pk_bf16_f32 v16, v20, v21
    v_cvt_pk_bf16_f32 v17, v22, v23
    v_cvt_pk_bf16_f32 v18, v24, v25
    v_cvt_pk_bf16_f32 v19, v26, v27
    s_add_u32 s18, s17, 524288
    buffer_store_dwordx4 v[16:19], v4, s[40:43], s18 offen sc0 sc1
    v_accvgpr_read_b32 v36, a68
    v_accvgpr_read_b32 v40, a84
    v_accvgpr_read_b32 v37, a69
    v_accvgpr_read_b32 v41, a85
    v_accvgpr_read_b32 v38, a70
    v_accvgpr_read_b32 v42, a86
    v_accvgpr_read_b32 v39, a71
    v_accvgpr_read_b32 v43, a87
    v_cvt_pk_bf16_f32 v32, v36, v37
    v_cvt_pk_bf16_f32 v33, v38, v39
    v_cvt_pk_bf16_f32 v34, v40, v41
    v_cvt_pk_bf16_f32 v35, v42, v43
    s_add_u32 s18, s17, 525312
    buffer_store_dwordx4 v[32:35], v4, s[40:43], s18 offen sc0 sc1
    v_accvgpr_read_b32 v20, a72
    v_accvgpr_read_b32 v24, a88
    v_accvgpr_read_b32 v21, a73
    v_accvgpr_read_b32 v25, a89
    v_accvgpr_read_b32 v22, a74
    v_accvgpr_read_b32 v26, a90
    v_accvgpr_read_b32 v23, a75
    v_accvgpr_read_b32 v27, a91
    v_cvt_pk_bf16_f32 v16, v20, v21
    v_cvt_pk_bf16_f32 v17, v22, v23
    v_cvt_pk_bf16_f32 v18, v24, v25
    v_cvt_pk_bf16_f32 v19, v26, v27
    s_add_u32 s18, s17, 526336
    buffer_store_dwordx4 v[16:19], v4, s[40:43], s18 offen sc0 sc1
    v_accvgpr_read_b32 v36, a76
    v_accvgpr_read_b32 v40, a92
    v_accvgpr_read_b32 v37, a77
    v_accvgpr_read_b32 v41, a93
    v_accvgpr_read_b32 v38, a78
    v_accvgpr_read_b32 v42, a94
    v_accvgpr_read_b32 v39, a79
    v_accvgpr_read_b32 v43, a95
    v_cvt_pk_bf16_f32 v32, v36, v37
    v_cvt_pk_bf16_f32 v33, v38, v39
    v_cvt_pk_bf16_f32 v34, v40, v41
    v_cvt_pk_bf16_f32 v35, v42, v43
    s_add_u32 s18, s17, 527360
    buffer_store_dwordx4 v[32:35], v4, s[40:43], s18 offen sc0 sc1
    v_accvgpr_read_b32 v20, a96
    v_accvgpr_read_b32 v24, a112
    v_accvgpr_read_b32 v21, a97
    v_accvgpr_read_b32 v25, a113
    v_accvgpr_read_b32 v22, a98
    v_accvgpr_read_b32 v26, a114
    v_accvgpr_read_b32 v23, a99
    v_accvgpr_read_b32 v27, a115
    v_cvt_pk_bf16_f32 v16, v20, v21
    v_cvt_pk_bf16_f32 v17, v22, v23
    v_cvt_pk_bf16_f32 v18, v24, v25
    v_cvt_pk_bf16_f32 v19, v26, v27
    s_add_u32 s18, s17, 786432
    buffer_store_dwordx4 v[16:19], v4, s[40:43], s18 offen sc0 sc1
    v_accvgpr_read_b32 v36, a100
    v_accvgpr_read_b32 v40, a116
    v_accvgpr_read_b32 v37, a101
    v_accvgpr_read_b32 v41, a117
    v_accvgpr_read_b32 v38, a102
    v_accvgpr_read_b32 v42, a118
    v_accvgpr_read_b32 v39, a103
    v_accvgpr_read_b32 v43, a119
    v_cvt_pk_bf16_f32 v32, v36, v37
    v_cvt_pk_bf16_f32 v33, v38, v39
    v_cvt_pk_bf16_f32 v34, v40, v41
    v_cvt_pk_bf16_f32 v35, v42, v43
    s_add_u32 s18, s17, 787456
    buffer_store_dwordx4 v[32:35], v4, s[40:43], s18 offen sc0 sc1
    v_accvgpr_read_b32 v20, a104
    v_accvgpr_read_b32 v24, a120
    v_accvgpr_read_b32 v21, a105
    v_accvgpr_read_b32 v25, a121
    v_accvgpr_read_b32 v22, a106
    v_accvgpr_read_b32 v26, a122
    v_accvgpr_read_b32 v23, a107
    v_accvgpr_read_b32 v27, a123
    v_cvt_pk_bf16_f32 v16, v20, v21
    v_cvt_pk_bf16_f32 v17, v22, v23
    v_cvt_pk_bf16_f32 v18, v24, v25
    v_cvt_pk_bf16_f32 v19, v26, v27
    s_add_u32 s18, s17, 788480
    buffer_store_dwordx4 v[16:19], v4, s[40:43], s18 offen sc0 sc1
    v_accvgpr_read_b32 v36, a108
    v_accvgpr_read_b32 v40, a124
    v_accvgpr_read_b32 v37, a109
    v_accvgpr_read_b32 v41, a125
    v_accvgpr_read_b32 v38, a110
    v_accvgpr_read_b32 v42, a126
    v_accvgpr_read_b32 v39, a111
    v_accvgpr_read_b32 v43, a127
    v_cvt_pk_bf16_f32 v32, v36, v37
    v_cvt_pk_bf16_f32 v33, v38, v39
    v_cvt_pk_bf16_f32 v34, v40, v41
    v_cvt_pk_bf16_f32 v35, v42, v43
    s_add_u32 s18, s17, 789504
    buffer_store_dwordx4 v[32:35], v4, s[40:43], s18 offen sc0 sc1
qkv_sig:
    s_cmp_ge_u32 s11, 16
    s_cselect_b32 s19, 1, 17
    s_add_u32 s19, s19, s4
    s_waitcnt vmcnt(0)
    s_barrier
    s_cmp_eq_u32 s3, 0
    s_cbranch_scc0 sg_5
    s_add_u32 s80, s19, 0
    s_lshl_b32 s80, s80, 6
    s_add_u32 s80, s80, 132120576
    v_mov_b32 v16, 1
    v_mov_b32 v17, 0
    s_mov_b64 exec, 1
    buffer_atomic_add v16, v17, s[40:43], s80 offen
    s_mov_b64 exec, -1
sg_5:
    s_branch worker_loop
worker_stage:
    s_sub_u32 s5, s91, 768
    s_mul_hi_u32 s4, s5, 12485371
    s_mul_i32 s6, s4, 344
    s_sub_u32 s5, s5, s6
    s_cmp_ge_u32 s5, 128
    s_cbranch_scc1 worker_s4
    s_sub_u32 s4, s4, 1
    s_cmp_ge_u32 s4, 16
    s_cbranch_scc1 worker_loop
    s_mov_b32 s90, -1
    s_lshr_b32 s10, s5, 4
    s_lshl_b32 s11, s4, 3
    s_add_u32 s10, s10, s11
    s_and_b32 s11, s5, 15
    s_mul_i32 s6, s10, 131072
    s_mul_i32 s7, s3, 32768
    s_add_u32 s6, s6, s7
    s_add_u32 s6, s6, 100663296
    s_mul_i32 s8, s11, 262144
    s_add_u32 s8, s8, s7
    s_add_u32 s8, s8, 14680064
    v_add_u32 v8, 131072, v4
    buffer_load_dwordx4 a[0:3], v4, s[40:43], s8 offen offset:0
    buffer_load_dwordx4 a[4:7], v8, s[40:43], s8 offen offset:0
    buffer_load_dwordx4 a[8:11], v4, s[40:43], s8 offen offset:1024
    buffer_load_dwordx4 a[12:15], v8, s[40:43], s8 offen offset:1024
    buffer_load_dwordx4 a[16:19], v4, s[40:43], s8 offen offset:2048
    buffer_load_dwordx4 a[20:23], v8, s[40:43], s8 offen offset:2048
    buffer_load_dwordx4 a[24:27], v4, s[40:43], s8 offen offset:3072
    buffer_load_dwordx4 a[28:31], v8, s[40:43], s8 offen offset:3072
    s_add_u32 s8, s8, 4096
    buffer_load_dwordx4 a[32:35], v4, s[40:43], s8 offen offset:0
    buffer_load_dwordx4 a[36:39], v8, s[40:43], s8 offen offset:0
    buffer_load_dwordx4 a[40:43], v4, s[40:43], s8 offen offset:1024
    buffer_load_dwordx4 a[44:47], v8, s[40:43], s8 offen offset:1024
    buffer_load_dwordx4 a[48:51], v4, s[40:43], s8 offen offset:2048
    buffer_load_dwordx4 a[52:55], v8, s[40:43], s8 offen offset:2048
    buffer_load_dwordx4 a[56:59], v4, s[40:43], s8 offen offset:3072
    buffer_load_dwordx4 a[60:63], v8, s[40:43], s8 offen offset:3072
    s_add_u32 s8, s8, 4096
    buffer_load_dwordx4 a[64:67], v4, s[40:43], s8 offen offset:0
    buffer_load_dwordx4 a[68:71], v8, s[40:43], s8 offen offset:0
    buffer_load_dwordx4 a[72:75], v4, s[40:43], s8 offen offset:1024
    buffer_load_dwordx4 a[76:79], v8, s[40:43], s8 offen offset:1024
    buffer_load_dwordx4 a[80:83], v4, s[40:43], s8 offen offset:2048
    buffer_load_dwordx4 a[84:87], v8, s[40:43], s8 offen offset:2048
    buffer_load_dwordx4 a[88:91], v4, s[40:43], s8 offen offset:3072
    buffer_load_dwordx4 a[92:95], v8, s[40:43], s8 offen offset:3072
    s_add_u32 s8, s8, 4096
    buffer_load_dwordx4 a[96:99], v4, s[40:43], s8 offen offset:0
    buffer_load_dwordx4 a[100:103], v8, s[40:43], s8 offen offset:0
    buffer_load_dwordx4 a[104:107], v4, s[40:43], s8 offen offset:1024
    buffer_load_dwordx4 a[108:111], v8, s[40:43], s8 offen offset:1024
    buffer_load_dwordx4 a[112:115], v4, s[40:43], s8 offen offset:2048
    buffer_load_dwordx4 a[116:119], v8, s[40:43], s8 offen offset:2048
    buffer_load_dwordx4 a[120:123], v4, s[40:43], s8 offen offset:3072
    buffer_load_dwordx4 a[124:127], v8, s[40:43], s8 offen offset:3072
    s_add_u32 s8, s8, 4096
    buffer_load_dwordx4 a[128:131], v4, s[40:43], s8 offen offset:0
    buffer_load_dwordx4 a[132:135], v8, s[40:43], s8 offen offset:0
    buffer_load_dwordx4 a[136:139], v4, s[40:43], s8 offen offset:1024
    buffer_load_dwordx4 a[140:143], v8, s[40:43], s8 offen offset:1024
    buffer_load_dwordx4 a[144:147], v4, s[40:43], s8 offen offset:2048
    buffer_load_dwordx4 a[148:151], v8, s[40:43], s8 offen offset:2048
    buffer_load_dwordx4 a[152:155], v4, s[40:43], s8 offen offset:3072
    buffer_load_dwordx4 a[156:159], v8, s[40:43], s8 offen offset:3072
    s_add_u32 s8, s8, 4096
    buffer_load_dwordx4 a[160:163], v4, s[40:43], s8 offen offset:0
    buffer_load_dwordx4 a[164:167], v8, s[40:43], s8 offen offset:0
    buffer_load_dwordx4 a[168:171], v4, s[40:43], s8 offen offset:1024
    buffer_load_dwordx4 a[172:175], v8, s[40:43], s8 offen offset:1024
    buffer_load_dwordx4 a[176:179], v4, s[40:43], s8 offen offset:2048
    buffer_load_dwordx4 a[180:183], v8, s[40:43], s8 offen offset:2048
    buffer_load_dwordx4 a[184:187], v4, s[40:43], s8 offen offset:3072
    buffer_load_dwordx4 a[188:191], v8, s[40:43], s8 offen offset:3072
    s_add_u32 s8, s8, 4096
    buffer_load_dwordx4 a[192:195], v4, s[40:43], s8 offen offset:0
    buffer_load_dwordx4 a[196:199], v8, s[40:43], s8 offen offset:0
    buffer_load_dwordx4 a[200:203], v4, s[40:43], s8 offen offset:1024
    buffer_load_dwordx4 a[204:207], v8, s[40:43], s8 offen offset:1024
    buffer_load_dwordx4 a[208:211], v4, s[40:43], s8 offen offset:2048
    buffer_load_dwordx4 a[212:215], v8, s[40:43], s8 offen offset:2048
    buffer_load_dwordx4 a[216:219], v4, s[40:43], s8 offen offset:3072
    buffer_load_dwordx4 a[220:223], v8, s[40:43], s8 offen offset:3072
    s_add_u32 s8, s8, 4096
    buffer_load_dwordx4 a[224:227], v4, s[40:43], s8 offen offset:0
    buffer_load_dwordx4 a[228:231], v8, s[40:43], s8 offen offset:0
    buffer_load_dwordx4 a[232:235], v4, s[40:43], s8 offen offset:1024
    buffer_load_dwordx4 a[236:239], v8, s[40:43], s8 offen offset:1024
    buffer_load_dwordx4 a[240:243], v4, s[40:43], s8 offen offset:2048
    buffer_load_dwordx4 a[244:247], v8, s[40:43], s8 offen offset:2048
    buffer_load_dwordx4 a[248:251], v4, s[40:43], s8 offen offset:3072
    buffer_load_dwordx4 a[252:255], v8, s[40:43], s8 offen offset:3072
    s_add_u32 s8, s8, 4096
    s_cmp_eq_u32 s3, 0
    s_cbranch_scc0 wc_6_ok
    s_add_u32 s80, s4, 49
    s_lshl_b32 s80, s80, 6
    s_add_u32 s80, s80, 132120576
    v_mov_b32 v17, 0
    s_mov_b32 s82, 0
wc_6:
    buffer_load_dword v16, v17, s[40:43], s80 offen sc1
    s_add_u32 s82, s82, 1
    s_waitcnt vmcnt(0)
    v_readfirstlane_b32 s81, v16
    s_cmp_ge_u32 s81, 32
    s_cbranch_scc1 wc_6_ok
    s_cmp_gt_u32 s82, 0x400000
    s_cbranch_scc1 rec_end2
    s_sleep 6
    s_branch wc_6
wc_6_ok:
    s_barrier
    buffer_load_dwordx4 v[32:35], v4, s[40:43], s6 offen offset:0 sc1
    buffer_load_dwordx4 v[36:39], v4, s[40:43], s6 offen offset:1024 sc1
    buffer_load_dwordx4 v[40:43], v4, s[40:43], s6 offen offset:2048 sc1
    buffer_load_dwordx4 v[44:47], v4, s[40:43], s6 offen offset:3072 sc1
    s_add_u32 s6, s6, 4096
    buffer_load_dwordx4 v[48:51], v4, s[40:43], s6 offen offset:0 sc1
    buffer_load_dwordx4 v[52:55], v4, s[40:43], s6 offen offset:1024 sc1
    buffer_load_dwordx4 v[56:59], v4, s[40:43], s6 offen offset:2048 sc1
    buffer_load_dwordx4 v[60:63], v4, s[40:43], s6 offen offset:3072 sc1
    s_add_u32 s6, s6, 4096
    buffer_load_dwordx4 v[64:67], v4, s[40:43], s6 offen offset:0 sc1
    buffer_load_dwordx4 v[68:71], v4, s[40:43], s6 offen offset:1024 sc1
    buffer_load_dwordx4 v[72:75], v4, s[40:43], s6 offen offset:2048 sc1
    buffer_load_dwordx4 v[76:79], v4, s[40:43], s6 offen offset:3072 sc1
    s_add_u32 s6, s6, 4096
    buffer_load_dwordx4 v[80:83], v4, s[40:43], s6 offen offset:0 sc1
    buffer_load_dwordx4 v[84:87], v4, s[40:43], s6 offen offset:1024 sc1
    buffer_load_dwordx4 v[88:91], v4, s[40:43], s6 offen offset:2048 sc1
    buffer_load_dwordx4 v[92:95], v4, s[40:43], s6 offen offset:3072 sc1
    s_add_u32 s6, s6, 4096
    buffer_load_dwordx4 v[96:99], v4, s[40:43], s6 offen offset:0 sc1
    buffer_load_dwordx4 v[100:103], v4, s[40:43], s6 offen offset:1024 sc1
    buffer_load_dwordx4 v[104:107], v4, s[40:43], s6 offen offset:2048 sc1
    buffer_load_dwordx4 v[108:111], v4, s[40:43], s6 offen offset:3072 sc1
    s_add_u32 s6, s6, 4096
    buffer_load_dwordx4 v[112:115], v4, s[40:43], s6 offen offset:0 sc1
    buffer_load_dwordx4 v[116:119], v4, s[40:43], s6 offen offset:1024 sc1
    buffer_load_dwordx4 v[120:123], v4, s[40:43], s6 offen offset:2048 sc1
    buffer_load_dwordx4 v[124:127], v4, s[40:43], s6 offen offset:3072 sc1
    s_add_u32 s6, s6, 4096
    buffer_load_dwordx4 v[128:131], v4, s[40:43], s6 offen offset:0 sc1
    buffer_load_dwordx4 v[132:135], v4, s[40:43], s6 offen offset:1024 sc1
    buffer_load_dwordx4 v[136:139], v4, s[40:43], s6 offen offset:2048 sc1
    buffer_load_dwordx4 v[140:143], v4, s[40:43], s6 offen offset:3072 sc1
    s_add_u32 s6, s6, 4096
    buffer_load_dwordx4 v[144:147], v4, s[40:43], s6 offen offset:0 sc1
    buffer_load_dwordx4 v[148:151], v4, s[40:43], s6 offen offset:1024 sc1
    buffer_load_dwordx4 v[152:155], v4, s[40:43], s6 offen offset:2048 sc1
    buffer_load_dwordx4 v[156:159], v4, s[40:43], s6 offen offset:3072 sc1
    s_add_u32 s6, s6, 4096
    v_lshlrev_b32 v6, 10, v3
    v_lshl_add_u32 v6, v2, 3, v6
    s_lshl_b32 s9, s10, 14
    s_lshl_b32 s12, s11, 6
    s_add_u32 s9, s9, s12
    s_mov_b32 s13, s9
    buffer_load_dwordx2 v[192:193], v6, s[44:47], s13 offen offset:0
    buffer_load_dwordx2 v[194:195], v6, s[44:47], s13 offen offset:32
    s_waitcnt vmcnt(33)
    v_mfma_f32_16x16x32_bf16 v[160:163], a[0:3], v[32:35], 0
    v_mfma_f32_16x16x32_bf16 v[164:167], a[4:7], v[32:35], 0
    s_waitcnt vmcnt(32)
    v_mfma_f32_16x16x32_bf16 v[160:163], a[8:11], v[36:39], v[160:163]
    v_mfma_f32_16x16x32_bf16 v[164:167], a[12:15], v[36:39], v[164:167]
    s_waitcnt vmcnt(31)
    v_mfma_f32_16x16x32_bf16 v[160:163], a[16:19], v[40:43], v[160:163]
    v_mfma_f32_16x16x32_bf16 v[164:167], a[20:23], v[40:43], v[164:167]
    s_waitcnt vmcnt(30)
    v_mfma_f32_16x16x32_bf16 v[160:163], a[24:27], v[44:47], v[160:163]
    v_mfma_f32_16x16x32_bf16 v[164:167], a[28:31], v[44:47], v[164:167]
    s_waitcnt vmcnt(29)
    v_mfma_f32_16x16x32_bf16 v[160:163], a[32:35], v[48:51], v[160:163]
    v_mfma_f32_16x16x32_bf16 v[164:167], a[36:39], v[48:51], v[164:167]
    s_waitcnt vmcnt(28)
    v_mfma_f32_16x16x32_bf16 v[160:163], a[40:43], v[52:55], v[160:163]
    v_mfma_f32_16x16x32_bf16 v[164:167], a[44:47], v[52:55], v[164:167]
    s_waitcnt vmcnt(27)
    v_mfma_f32_16x16x32_bf16 v[160:163], a[48:51], v[56:59], v[160:163]
    v_mfma_f32_16x16x32_bf16 v[164:167], a[52:55], v[56:59], v[164:167]
    s_waitcnt vmcnt(26)
    v_mfma_f32_16x16x32_bf16 v[160:163], a[56:59], v[60:63], v[160:163]
    v_mfma_f32_16x16x32_bf16 v[164:167], a[60:63], v[60:63], v[164:167]
    s_waitcnt vmcnt(25)
    v_mfma_f32_16x16x32_bf16 v[160:163], a[64:67], v[64:67], v[160:163]
    v_mfma_f32_16x16x32_bf16 v[164:167], a[68:71], v[64:67], v[164:167]
    s_waitcnt vmcnt(24)
    v_mfma_f32_16x16x32_bf16 v[160:163], a[72:75], v[68:71], v[160:163]
    v_mfma_f32_16x16x32_bf16 v[164:167], a[76:79], v[68:71], v[164:167]
    s_waitcnt vmcnt(23)
    v_mfma_f32_16x16x32_bf16 v[160:163], a[80:83], v[72:75], v[160:163]
    v_mfma_f32_16x16x32_bf16 v[164:167], a[84:87], v[72:75], v[164:167]
    s_waitcnt vmcnt(22)
    v_mfma_f32_16x16x32_bf16 v[160:163], a[88:91], v[76:79], v[160:163]
    v_mfma_f32_16x16x32_bf16 v[164:167], a[92:95], v[76:79], v[164:167]
    s_waitcnt vmcnt(21)
    v_mfma_f32_16x16x32_bf16 v[160:163], a[96:99], v[80:83], v[160:163]
    v_mfma_f32_16x16x32_bf16 v[164:167], a[100:103], v[80:83], v[164:167]
    s_waitcnt vmcnt(20)
    v_mfma_f32_16x16x32_bf16 v[160:163], a[104:107], v[84:87], v[160:163]
    v_mfma_f32_16x16x32_bf16 v[164:167], a[108:111], v[84:87], v[164:167]
    s_waitcnt vmcnt(19)
    v_mfma_f32_16x16x32_bf16 v[160:163], a[112:115], v[88:91], v[160:163]
    v_mfma_f32_16x16x32_bf16 v[164:167], a[116:119], v[88:91], v[164:167]
    s_waitcnt vmcnt(18)
    v_mfma_f32_16x16x32_bf16 v[160:163], a[120:123], v[92:95], v[160:163]
    v_mfma_f32_16x16x32_bf16 v[164:167], a[124:127], v[92:95], v[164:167]
    s_waitcnt vmcnt(17)
    v_mfma_f32_16x16x32_bf16 v[160:163], a[128:131], v[96:99], v[160:163]
    v_mfma_f32_16x16x32_bf16 v[164:167], a[132:135], v[96:99], v[164:167]
    s_waitcnt vmcnt(16)
    v_mfma_f32_16x16x32_bf16 v[160:163], a[136:139], v[100:103], v[160:163]
    v_mfma_f32_16x16x32_bf16 v[164:167], a[140:143], v[100:103], v[164:167]
    s_waitcnt vmcnt(15)
    v_mfma_f32_16x16x32_bf16 v[160:163], a[144:147], v[104:107], v[160:163]
    v_mfma_f32_16x16x32_bf16 v[164:167], a[148:151], v[104:107], v[164:167]
    s_waitcnt vmcnt(14)
    v_mfma_f32_16x16x32_bf16 v[160:163], a[152:155], v[108:111], v[160:163]
    v_mfma_f32_16x16x32_bf16 v[164:167], a[156:159], v[108:111], v[164:167]
    s_waitcnt vmcnt(13)
    v_mfma_f32_16x16x32_bf16 v[160:163], a[160:163], v[112:115], v[160:163]
    v_mfma_f32_16x16x32_bf16 v[164:167], a[164:167], v[112:115], v[164:167]
    s_waitcnt vmcnt(12)
    v_mfma_f32_16x16x32_bf16 v[160:163], a[168:171], v[116:119], v[160:163]
    v_mfma_f32_16x16x32_bf16 v[164:167], a[172:175], v[116:119], v[164:167]
    s_waitcnt vmcnt(11)
    v_mfma_f32_16x16x32_bf16 v[160:163], a[176:179], v[120:123], v[160:163]
    v_mfma_f32_16x16x32_bf16 v[164:167], a[180:183], v[120:123], v[164:167]
    s_waitcnt vmcnt(10)
    v_mfma_f32_16x16x32_bf16 v[160:163], a[184:187], v[124:127], v[160:163]
    v_mfma_f32_16x16x32_bf16 v[164:167], a[188:191], v[124:127], v[164:167]
    s_waitcnt vmcnt(9)
    v_mfma_f32_16x16x32_bf16 v[160:163], a[192:195], v[128:131], v[160:163]
    v_mfma_f32_16x16x32_bf16 v[164:167], a[196:199], v[128:131], v[164:167]
    s_waitcnt vmcnt(8)
    v_mfma_f32_16x16x32_bf16 v[160:163], a[200:203], v[132:135], v[160:163]
    v_mfma_f32_16x16x32_bf16 v[164:167], a[204:207], v[132:135], v[164:167]
    s_waitcnt vmcnt(7)
    v_mfma_f32_16x16x32_bf16 v[160:163], a[208:211], v[136:139], v[160:163]
    v_mfma_f32_16x16x32_bf16 v[164:167], a[212:215], v[136:139], v[164:167]
    s_waitcnt vmcnt(6)
    v_mfma_f32_16x16x32_bf16 v[160:163], a[216:219], v[140:143], v[160:163]
    v_mfma_f32_16x16x32_bf16 v[164:167], a[220:223], v[140:143], v[164:167]
    s_waitcnt vmcnt(5)
    v_mfma_f32_16x16x32_bf16 v[160:163], a[224:227], v[144:147], v[160:163]
    v_mfma_f32_16x16x32_bf16 v[164:167], a[228:231], v[144:147], v[164:167]
    s_waitcnt vmcnt(4)
    v_mfma_f32_16x16x32_bf16 v[160:163], a[232:235], v[148:151], v[160:163]
    v_mfma_f32_16x16x32_bf16 v[164:167], a[236:239], v[148:151], v[164:167]
    s_waitcnt vmcnt(3)
    v_mfma_f32_16x16x32_bf16 v[160:163], a[240:243], v[152:155], v[160:163]
    v_mfma_f32_16x16x32_bf16 v[164:167], a[244:247], v[152:155], v[164:167]
    s_waitcnt vmcnt(2)
    v_mfma_f32_16x16x32_bf16 v[160:163], a[248:251], v[156:159], v[160:163]
    v_mfma_f32_16x16x32_bf16 v[164:167], a[252:255], v[156:159], v[164:167]
    s_nop 7
    s_cmp_eq_u32 s3, 0
    s_cbranch_scc1 wo_w0
    s_sub_u32 s9, s3, 1
    s_lshl_b32 s9, s9, 11
    v_add_u32 v5, s9, v4
    ds_write_b128 v5, v[160:163] offset:0
    ds_write_b128 v5, v[164:167] offset:1024
    s_waitcnt lgkmcnt(0)
    s_barrier
    s_branch wo_fin
wo_w0:
    s_barrier
    ds_read_b128 v[32:35], v4 offset:0
    ds_read_b128 v[36:39], v4 offset:2048
    ds_read_b128 v[40:43], v4 offset:4096
    ds_read_b128 v[44:47], v4 offset:1024
    ds_read_b128 v[48:51], v4 offset:3072
    ds_read_b128 v[52:55], v4 offset:5120
    s_waitcnt vmcnt(0) lgkmcnt(0)
    v_add_f32 v32, v32, v36
    v_add_f32 v160, v160, v40
    v_add_f32 v160, v160, v32
    v_add_f32 v33, v33, v37
    v_add_f32 v161, v161, v41
    v_add_f32 v161, v161, v33
    v_add_f32 v34, v34, v38
    v_add_f32 v162, v162, v42
    v_add_f32 v162, v162, v34
    v_add_f32 v35, v35, v39
    v_add_f32 v163, v163, v43
    v_add_f32 v163, v163, v35
    v_add_f32 v44, v44, v48
    v_add_f32 v164, v164, v52
    v_add_f32 v164, v164, v44
    v_add_f32 v45, v45, v49
    v_add_f32 v165, v165, v53
    v_add_f32 v165, v165, v45
    v_add_f32 v46, v46, v50
    v_add_f32 v166, v166, v54
    v_add_f32 v166, v166, v46
    v_add_f32 v47, v47, v51
    v_add_f32 v167, v167, v55
    v_add_f32 v167, v167, v47
    s_add_u32 s13, s9, 117440512
    v_cvt_pk_bf16_f32 v160, v160, v160
    v_lshlrev_b32 v160, 16, v160
    v_cvt_pk_bf16_f32 v161, v161, v161
    v_lshlrev_b32 v161, 16, v161
    v_cvt_pk_bf16_f32 v162, v162, v162
    v_lshlrev_b32 v162, 16, v162
    v_cvt_pk_bf16_f32 v163, v163, v163
    v_lshlrev_b32 v163, 16, v163
    v_lshlrev_b32 v32, 16, v192
    v_and_b32 v33, 0xffff0000, v192
    v_lshlrev_b32 v34, 16, v193
    v_and_b32 v35, 0xffff0000, v193
    v_add_f32 v160, v160, v32
    v_add_f32 v161, v161, v33
    v_add_f32 v162, v162, v34
    v_add_f32 v163, v163, v35
    v_cvt_pk_bf16_f32 v192, v160, v161
    v_cvt_pk_bf16_f32 v193, v162, v163
    buffer_store_dwordx2 v[192:193], v6, s[40:43], s13 offen offset:0 sc0 sc1
    v_cvt_pk_bf16_f32 v164, v164, v164
    v_lshlrev_b32 v164, 16, v164
    v_cvt_pk_bf16_f32 v165, v165, v165
    v_lshlrev_b32 v165, 16, v165
    v_cvt_pk_bf16_f32 v166, v166, v166
    v_lshlrev_b32 v166, 16, v166
    v_cvt_pk_bf16_f32 v167, v167, v167
    v_lshlrev_b32 v167, 16, v167
    v_lshlrev_b32 v32, 16, v194
    v_and_b32 v33, 0xffff0000, v194
    v_lshlrev_b32 v34, 16, v195
    v_and_b32 v35, 0xffff0000, v195
    v_add_f32 v164, v164, v32
    v_add_f32 v165, v165, v33
    v_add_f32 v166, v166, v34
    v_add_f32 v167, v167, v35
    v_cvt_pk_bf16_f32 v194, v164, v165
    v_cvt_pk_bf16_f32 v195, v166, v167
    buffer_store_dwordx2 v[194:195], v6, s[40:43], s13 offen offset:32 sc0 sc1
wo_fin:
    v_add_u32 v5, 0x10000, v4
    s_waitcnt vmcnt(0)
    s_barrier
    s_cmp_eq_u32 s3, 0
    s_cbranch_scc0 sg_7
    s_add_u32 s80, s4, 65
    s_lshl_b32 s80, s80, 6
    s_add_u32 s80, s80, 132120576
    v_mov_b32 v16, 1
    v_mov_b32 v17, 0
    s_mov_b64 exec, 1
    buffer_atomic_add v16, v17, s[40:43], s80 offen
    s_mov_b64 exec, -1
sg_7:
    s_branch worker_loop
worker_s4:
    s_sub_u32 s5, s5, 128
    s_cmp_ge_u32 s5, 56
    s_cbranch_scc1 worker_s5
    s_sub_u32 s4, s4, 2
    s_cmp_ge_u32 s4, 16
    s_cbranch_scc1 worker_loop
    s_mul_hi_u32 s10, s5, 306783379
    s_mul_i32 s11, s10, 14
    s_sub_u32 s11, s5, s11
    s_lshl_b32 s12, s11, 3
    s_lshl_b32 s13, s3, 1
    s_add_u32 s12, s12, s13
    s_lshl_b32 s14, s12, 14
    s_add_u32 s14, s14, 18874368
    v_add_u32 v9, 16384, v4
    v_add_u32 v10, 1835008, v4
    v_add_u32 v11, 1851392, v4
    buffer_load_dwordx4 a[0:3], v4, s[40:43], s14 offen offset:0
    buffer_load_dwordx4 a[4:7], v9, s[40:43], s14 offen offset:0
    buffer_load_dwordx4 a[8:11], v10, s[40:43], s14 offen offset:0
    buffer_load_dwordx4 a[12:15], v11, s[40:43], s14 offen offset:0
    buffer_load_dwordx4 a[16:19], v4, s[40:43], s14 offen offset:1024
    buffer_load_dwordx4 a[20:23], v9, s[40:43], s14 offen offset:1024
    buffer_load_dwordx4 a[24:27], v10, s[40:43], s14 offen offset:1024
    buffer_load_dwordx4 a[28:31], v11, s[40:43], s14 offen offset:1024
    buffer_load_dwordx4 a[32:35], v4, s[40:43], s14 offen offset:2048
    buffer_load_dwordx4 a[36:39], v9, s[40:43], s14 offen offset:2048
    buffer_load_dwordx4 a[40:43], v10, s[40:43], s14 offen offset:2048
    buffer_load_dwordx4 a[44:47], v11, s[40:43], s14 offen offset:2048
    buffer_load_dwordx4 a[48:51], v4, s[40:43], s14 offen offset:3072
    buffer_load_dwordx4 a[52:55], v9, s[40:43], s14 offen offset:3072
    buffer_load_dwordx4 a[56:59], v10, s[40:43], s14 offen offset:3072
    buffer_load_dwordx4 a[60:63], v11, s[40:43], s14 offen offset:3072
    s_add_u32 s14, s14, 4096
    buffer_load_dwordx4 a[64:67], v4, s[40:43], s14 offen offset:0
    buffer_load_dwordx4 a[68:71], v9, s[40:43], s14 offen offset:0
    buffer_load_dwordx4 a[72:75], v10, s[40:43], s14 offen offset:0
    buffer_load_dwordx4 a[76:79], v11, s[40:43], s14 offen offset:0
    buffer_load_dwordx4 a[80:83], v4, s[40:43], s14 offen offset:1024
    buffer_load_dwordx4 a[84:87], v9, s[40:43], s14 offen offset:1024
    buffer_load_dwordx4 a[88:91], v10, s[40:43], s14 offen offset:1024
    buffer_load_dwordx4 a[92:95], v11, s[40:43], s14 offen offset:1024
    buffer_load_dwordx4 a[96:99], v4, s[40:43], s14 offen offset:2048
    buffer_load_dwordx4 a[100:103], v9, s[40:43], s14 offen offset:2048
    buffer_load_dwordx4 a[104:107], v10, s[40:43], s14 offen offset:2048
    buffer_load_dwordx4 a[108:111], v11, s[40:43], s14 offen offset:2048
    buffer_load_dwordx4 a[112:115], v4, s[40:43], s14 offen offset:3072
    buffer_load_dwordx4 a[116:119], v9, s[40:43], s14 offen offset:3072
    buffer_load_dwordx4 a[120:123], v10, s[40:43], s14 offen offset:3072
    buffer_load_dwordx4 a[124:127], v11, s[40:43], s14 offen offset:3072
    s_add_u32 s14, s14, 4096
    buffer_load_dwordx4 a[128:131], v4, s[40:43], s14 offen offset:0
    buffer_load_dwordx4 a[132:135], v9, s[40:43], s14 offen offset:0
    buffer_load_dwordx4 a[136:139], v10, s[40:43], s14 offen offset:0
    buffer_load_dwordx4 a[140:143], v11, s[40:43], s14 offen offset:0
    buffer_load_dwordx4 a[144:147], v4, s[40:43], s14 offen offset:1024
    buffer_load_dwordx4 a[148:151], v9, s[40:43], s14 offen offset:1024
    buffer_load_dwordx4 a[152:155], v10, s[40:43], s14 offen offset:1024
    buffer_load_dwordx4 a[156:159], v11, s[40:43], s14 offen offset:1024
    buffer_load_dwordx4 a[160:163], v4, s[40:43], s14 offen offset:2048
    buffer_load_dwordx4 a[164:167], v9, s[40:43], s14 offen offset:2048
    buffer_load_dwordx4 a[168:171], v10, s[40:43], s14 offen offset:2048
    buffer_load_dwordx4 a[172:175], v11, s[40:43], s14 offen offset:2048
    buffer_load_dwordx4 a[176:179], v4, s[40:43], s14 offen offset:3072
    buffer_load_dwordx4 a[180:183], v9, s[40:43], s14 offen offset:3072
    buffer_load_dwordx4 a[184:187], v10, s[40:43], s14 offen offset:3072
    buffer_load_dwordx4 a[188:191], v11, s[40:43], s14 offen offset:3072
    s_add_u32 s14, s14, 4096
    buffer_load_dwordx4 a[192:195], v4, s[40:43], s14 offen offset:0
    buffer_load_dwordx4 a[196:199], v9, s[40:43], s14 offen offset:0
    buffer_load_dwordx4 a[200:203], v10, s[40:43], s14 offen offset:0
    buffer_load_dwordx4 a[204:207], v11, s[40:43], s14 offen offset:0
    buffer_load_dwordx4 a[208:211], v4, s[40:43], s14 offen offset:1024
    buffer_load_dwordx4 a[212:215], v9, s[40:43], s14 offen offset:1024
    buffer_load_dwordx4 a[216:219], v10, s[40:43], s14 offen offset:1024
    buffer_load_dwordx4 a[220:223], v11, s[40:43], s14 offen offset:1024
    buffer_load_dwordx4 a[224:227], v4, s[40:43], s14 offen offset:2048
    buffer_load_dwordx4 a[228:231], v9, s[40:43], s14 offen offset:2048
    buffer_load_dwordx4 a[232:235], v10, s[40:43], s14 offen offset:2048
    buffer_load_dwordx4 a[236:239], v11, s[40:43], s14 offen offset:2048
    buffer_load_dwordx4 a[240:243], v4, s[40:43], s14 offen offset:3072
    buffer_load_dwordx4 a[244:247], v9, s[40:43], s14 offen offset:3072
    buffer_load_dwordx4 a[248:251], v10, s[40:43], s14 offen offset:3072
    buffer_load_dwordx4 a[252:255], v11, s[40:43], s14 offen offset:3072
    s_cmp_eq_u32 s3, 0
    s_cbranch_scc0 wc_8_ok
    s_add_u32 s80, s4, 65
    s_lshl_b32 s80, s80, 6
    s_add_u32 s80, s80, 132120576
    v_mov_b32 v17, 0
    s_mov_b32 s82, 0
wc_8:
    buffer_load_dword v16, v17, s[40:43], s80 offen sc1
    s_add_u32 s82, s82, 1
    s_waitcnt vmcnt(0)
    v_readfirstlane_b32 s81, v16
    s_cmp_ge_u32 s81, 128
    s_cbranch_scc1 wc_8_ok
    s_cmp_gt_u32 s82, 0x400000
    s_cbranch_scc1 rec_end2
    s_sleep 6
    s_branch wc_8
wc_8_ok:
    s_barrier
    s_mov_b32 s90, -1
    s_barrier
    s_cmp_ge_u32 s3, 2
    s_cbranch_scc1 ffn1_noln
    v_xor_b32 v6, 16, v1
    v_lshlrev_b32 v6, 2, v6
    v_xor_b32 v7, 32, v1
    v_lshlrev_b32 v7, 2, v7
    v_lshlrev_b32 v8, 10, v3
    v_lshl_add_u32 v8, v2, 4, v8
    s_lshl_b32 s6, s4, 17
    s_lshl_b32 s7, s10, 15
    s_add_u32 s6, s6, s7
    s_lshl_b32 s7, s3, 14
    s_add_u32 s6, s6, s7
    s_add_u32 s6, s6, 117440512
    buffer_load_dwordx4 v[32:35], v8, s[40:43], s6 offen offset:0 sc1
    buffer_load_dwordx4 v[36:39], v8, s[40:43], s6 offen offset:64 sc1
    buffer_load_dwordx4 v[40:43], v8, s[40:43], s6 offen offset:128 sc1
    buffer_load_dwordx4 v[44:47], v8, s[40:43], s6 offen offset:192 sc1
    buffer_load_dwordx4 v[48:51], v8, s[40:43], s6 offen offset:256 sc1
    buffer_load_dwordx4 v[52:55], v8, s[40:43], s6 offen offset:320 sc1
    buffer_load_dwordx4 v[56:59], v8, s[40:43], s6 offen offset:384 sc1
    buffer_load_dwordx4 v[60:63], v8, s[40:43], s6 offen offset:448 sc1
    buffer_load_dwordx4 v[64:67], v8, s[40:43], s6 offen offset:512 sc1
    buffer_load_dwordx4 v[68:71], v8, s[40:43], s6 offen offset:576 sc1
    buffer_load_dwordx4 v[72:75], v8, s[40:43], s6 offen offset:640 sc1
    buffer_load_dwordx4 v[76:79], v8, s[40:43], s6 offen offset:704 sc1
    buffer_load_dwordx4 v[80:83], v8, s[40:43], s6 offen offset:768 sc1
    buffer_load_dwordx4 v[84:87], v8, s[40:43], s6 offen offset:832 sc1
    buffer_load_dwordx4 v[88:91], v8, s[40:43], s6 offen offset:896 sc1
    buffer_load_dwordx4 v[92:95], v8, s[40:43], s6 offen offset:960 sc1
    s_waitcnt vmcnt(0)
    v_lshlrev_b32 v96, 16, v32
    v_and_b32 v97, 0xffff0000, v32
    v_lshlrev_b32 v98, 16, v33
    v_and_b32 v99, 0xffff0000, v33
    v_lshlrev_b32 v100, 16, v34
    v_and_b32 v101, 0xffff0000, v34
    v_lshlrev_b32 v102, 16, v35
    v_and_b32 v103, 0xffff0000, v35
    v_lshlrev_b32 v104, 16, v36
    v_and_b32 v105, 0xffff0000, v36
    v_lshlrev_b32 v106, 16, v37
    v_and_b32 v107, 0xffff0000, v37
    v_lshlrev_b32 v108, 16, v38
    v_and_b32 v109, 0xffff0000, v38
    v_lshlrev_b32 v110, 16, v39
    v_and_b32 v111, 0xffff0000, v39
    v_lshlrev_b32 v112, 16, v40
    v_and_b32 v113, 0xffff0000, v40
    v_lshlrev_b32 v114, 16, v41
    v_and_b32 v115, 0xffff0000, v41
    v_lshlrev_b32 v116, 16, v42
    v_and_b32 v117, 0xffff0000, v42
    v_lshlrev_b32 v118, 16, v43
    v_and_b32 v119, 0xffff0000, v43
    v_lshlrev_b32 v120, 16, v44
    v_and_b32 v121, 0xffff0000, v44
    v_lshlrev_b32 v122, 16, v45
    v_and_b32 v123, 0xffff0000, v45
    v_lshlrev_b32 v124, 16, v46
    v_and_b32 v125, 0xffff0000, v46
    v_lshlrev_b32 v126, 16, v47
    v_and_b32 v127, 0xffff0000, v47
    v_lshlrev_b32 v128, 16, v48
    v_and_b32 v129, 0xffff0000, v48
    v_lshlrev_b32 v130, 16, v49
    v_and_b32 v131, 0xffff0000, v49
    v_lshlrev_b32 v132, 16, v50
    v_and_b32 v133, 0xffff0000, v50
    v_lshlrev_b32 v134, 16, v51
    v_and_b32 v135, 0xffff0000, v51
    v_lshlrev_b32 v136, 16, v52
    v_and_b32 v137, 0xffff0000, v52
    v_lshlrev_b32 v138, 16, v53
    v_and_b32 v139, 0xffff0000, v53
    v_lshlrev_b32 v140, 16, v54
    v_and_b32 v141, 0xffff0000, v54
    v_lshlrev_b32 v142, 16, v55
    v_and_b32 v143, 0xffff0000, v55
    v_lshlrev_b32 v144, 16, v56
    v_and_b32 v145, 0xffff0000, v56
    v_lshlrev_b32 v146, 16, v57
    v_and_b32 v147, 0xffff0000, v57
    v_lshlrev_b32 v148, 16, v58
    v_and_b32 v149, 0xffff0000, v58
    v_lshlrev_b32 v150, 16, v59
    v_and_b32 v151, 0xffff0000, v59
    v_lshlrev_b32 v152, 16, v60
    v_and_b32 v153, 0xffff0000, v60
    v_lshlrev_b32 v154, 16, v61
    v_and_b32 v155, 0xffff0000, v61
    v_lshlrev_b32 v156, 16, v62
    v_and_b32 v157, 0xffff0000, v62
    v_lshlrev_b32 v158, 16, v63
    v_and_b32 v159, 0xffff0000, v63
    v_lshlrev_b32 v160, 16, v64
    v_and_b32 v161, 0xffff0000, v64
    v_lshlrev_b32 v162, 16, v65
    v_and_b32 v163, 0xffff0000, v65
    v_lshlrev_b32 v164, 16, v66
    v_and_b32 v165, 0xffff0000, v66
    v_lshlrev_b32 v166, 16, v67
    v_and_b32 v167, 0xffff0000, v67
    v_lshlrev_b32 v168, 16, v68
    v_and_b32 v169, 0xffff0000, v68
    v_lshlrev_b32 v170, 16, v69
    v_and_b32 v171, 0xffff0000, v69
    v_lshlrev_b32 v172, 16, v70
    v_and_b32 v173, 0xffff0000, v70
    v_lshlrev_b32 v174, 16, v71
    v_and_b32 v175, 0xffff0000, v71
    v_lshlrev_b32 v176, 16, v72
    v_and_b32 v177, 0xffff0000, v72
    v_lshlrev_b32 v178, 16, v73
    v_and_b32 v179, 0xffff0000, v73
    v_lshlrev_b32 v180, 16, v74
    v_and_b32 v181, 0xffff0000, v74
    v_lshlrev_b32 v182, 16, v75
    v_and_b32 v183, 0xffff0000, v75
    v_lshlrev_b32 v184, 16, v76
    v_and_b32 v185, 0xffff0000, v76
    v_lshlrev_b32 v186, 16, v77
    v_and_b32 v187, 0xffff0000, v77
    v_lshlrev_b32 v188, 16, v78
    v_and_b32 v189, 0xffff0000, v78
    v_lshlrev_b32 v190, 16, v79
    v_and_b32 v191, 0xffff0000, v79
    v_lshlrev_b32 v192, 16, v80
    v_and_b32 v193, 0xffff0000, v80
    v_lshlrev_b32 v194, 16, v81
    v_and_b32 v195, 0xffff0000, v81
    v_lshlrev_b32 v196, 16, v82
    v_and_b32 v197, 0xffff0000, v82
    v_lshlrev_b32 v198, 16, v83
    v_and_b32 v199, 0xffff0000, v83
    v_lshlrev_b32 v200, 16, v84
    v_and_b32 v201, 0xffff0000, v84
    v_lshlrev_b32 v202, 16, v85
    v_and_b32 v203, 0xffff0000, v85
    v_lshlrev_b32 v204, 16, v86
    v_and_b32 v205, 0xffff0000, v86
    v_lshlrev_b32 v206, 16, v87
    v_and_b32 v207, 0xffff0000, v87
    v_lshlrev_b32 v208, 16, v88
    v_and_b32 v209, 0xffff0000, v88
    v_lshlrev_b32 v210, 16, v89
    v_and_b32 v211, 0xffff0000, v89
    v_lshlrev_b32 v212, 16, v90
    v_and_b32 v213, 0xffff0000, v90
    v_lshlrev_b32 v214, 16, v91
    v_and_b32 v215, 0xffff0000, v91
    v_lshlrev_b32 v216, 16, v92
    v_and_b32 v217, 0xffff0000, v92
    v_lshlrev_b32 v218, 16, v93
    v_and_b32 v219, 0xffff0000, v93
    v_lshlrev_b32 v220, 16, v94
    v_and_b32 v221, 0xffff0000, v94
    v_lshlrev_b32 v222, 16, v95
    v_and_b32 v223, 0xffff0000, v95
    v_add_f32 v16, v96, v97
    v_add_f32 v16, v16, v98
    v_add_f32 v16, v16, v99
    v_add_f32 v16, v16, v100
    v_add_f32 v16, v16, v101
    v_add_f32 v16, v16, v102
    v_add_f32 v16, v16, v103
    v_add_f32 v16, v16, v104
    v_add_f32 v16, v16, v105
    v_add_f32 v16, v16, v106
    v_add_f32 v16, v16, v107
    v_add_f32 v16, v16, v108
    v_add_f32 v16, v16, v109
    v_add_f32 v16, v16, v110
    v_add_f32 v16, v16, v111
    v_add_f32 v16, v16, v112
    v_add_f32 v16, v16, v113
    v_add_f32 v16, v16, v114
    v_add_f32 v16, v16, v115
    v_add_f32 v16, v16, v116
    v_add_f32 v16, v16, v117
    v_add_f32 v16, v16, v118
    v_add_f32 v16, v16, v119
    v_add_f32 v16, v16, v120
    v_add_f32 v16, v16, v121
    v_add_f32 v16, v16, v122
    v_add_f32 v16, v16, v123
    v_add_f32 v16, v16, v124
    v_add_f32 v16, v16, v125
    v_add_f32 v16, v16, v126
    v_add_f32 v16, v16, v127
    v_add_f32 v16, v16, v128
    v_add_f32 v16, v16, v129
    v_add_f32 v16, v16, v130
    v_add_f32 v16, v16, v131
    v_add_f32 v16, v16, v132
    v_add_f32 v16, v16, v133
    v_add_f32 v16, v16, v134
    v_add_f32 v16, v16, v135
    v_add_f32 v16, v16, v136
    v_add_f32 v16, v16, v137
    v_add_f32 v16, v16, v138
    v_add_f32 v16, v16, v139
    v_add_f32 v16, v16, v140
    v_add_f32 v16, v16, v141
    v_add_f32 v16, v16, v142
    v_add_f32 v16, v16, v143
    v_add_f32 v16, v16, v144
    v_add_f32 v16, v16, v145
    v_add_f32 v16, v16, v146
    v_add_f32 v16, v16, v147
    v_add_f32 v16, v16, v148
    v_add_f32 v16, v16, v149
    v_add_f32 v16, v16, v150
    v_add_f32 v16, v16, v151
    v_add_f32 v16, v16, v152
    v_add_f32 v16, v16, v153
    v_add_f32 v16, v16, v154
    v_add_f32 v16, v16, v155
    v_add_f32 v16, v16, v156
    v_add_f32 v16, v16, v157
    v_add_f32 v16, v16, v158
    v_add_f32 v16, v16, v159
    v_add_f32 v16, v16, v160
    v_add_f32 v16, v16, v161
    v_add_f32 v16, v16, v162
    v_add_f32 v16, v16, v163
    v_add_f32 v16, v16, v164
    v_add_f32 v16, v16, v165
    v_add_f32 v16, v16, v166
    v_add_f32 v16, v16, v167
    v_add_f32 v16, v16, v168
    v_add_f32 v16, v16, v169
    v_add_f32 v16, v16, v170
    v_add_f32 v16, v16, v171
    v_add_f32 v16, v16, v172
    v_add_f32 v16, v16, v173
    v_add_f32 v16, v16, v174
    v_add_f32 v16, v16, v175
    v_add_f32 v16, v16, v176
    v_add_f32 v16, v16, v177
    v_add_f32 v16, v16, v178
    v_add_f32 v16, v16, v179
    v_add_f32 v16, v16, v180
    v_add_f32 v16, v16, v181
    v_add_f32 v16, v16, v182
    v_add_f32 v16, v16, v183
    v_add_f32 v16, v16, v184
    v_add_f32 v16, v16, v185
    v_add_f32 v16, v16, v186
    v_add_f32 v16, v16, v187
    v_add_f32 v16, v16, v188
    v_add_f32 v16, v16, v189
    v_add_f32 v16, v16, v190
    v_add_f32 v16, v16, v191
    v_add_f32 v16, v16, v192
    v_add_f32 v16, v16, v193
    v_add_f32 v16, v16, v194
    v_add_f32 v16, v16, v195
    v_add_f32 v16, v16, v196
    v_add_f32 v16, v16, v197
    v_add_f32 v16, v16, v198
    v_add_f32 v16, v16, v199
    v_add_f32 v16, v16, v200
    v_add_f32 v16, v16, v201
    v_add_f32 v16, v16, v202
    v_add_f32 v16, v16, v203
    v_add_f32 v16, v16, v204
    v_add_f32 v16, v16, v205
    v_add_f32 v16, v16, v206
    v_add_f32 v16, v16, v207
    v_add_f32 v16, v16, v208
    v_add_f32 v16, v16, v209
    v_add_f32 v16, v16, v210
    v_add_f32 v16, v16, v211
    v_add_f32 v16, v16, v212
    v_add_f32 v16, v16, v213
    v_add_f32 v16, v16, v214
    v_add_f32 v16, v16, v215
    v_add_f32 v16, v16, v216
    v_add_f32 v16, v16, v217
    v_add_f32 v16, v16, v218
    v_add_f32 v16, v16, v219
    v_add_f32 v16, v16, v220
    v_add_f32 v16, v16, v221
    v_add_f32 v16, v16, v222
    v_add_f32 v16, v16, v223
    ds_bpermute_b32 v17, v6, v16
    s_waitcnt lgkmcnt(0)
    v_add_f32 v16, v16, v17
    ds_bpermute_b32 v17, v7, v16
    s_waitcnt lgkmcnt(0)
    v_add_f32 v16, v16, v17
    v_mul_f32 v16, 0x3b000000, v16
    v_mov_b32 v18, 0
    v_sub_f32 v17, v96, v16
    v_fmac_f32 v18, v17, v17
    v_sub_f32 v17, v97, v16
    v_fmac_f32 v18, v17, v17
    v_sub_f32 v17, v98, v16
    v_fmac_f32 v18, v17, v17
    v_sub_f32 v17, v99, v16
    v_fmac_f32 v18, v17, v17
    v_sub_f32 v17, v100, v16
    v_fmac_f32 v18, v17, v17
    v_sub_f32 v17, v101, v16
    v_fmac_f32 v18, v17, v17
    v_sub_f32 v17, v102, v16
    v_fmac_f32 v18, v17, v17
    v_sub_f32 v17, v103, v16
    v_fmac_f32 v18, v17, v17
    v_sub_f32 v17, v104, v16
    v_fmac_f32 v18, v17, v17
    v_sub_f32 v17, v105, v16
    v_fmac_f32 v18, v17, v17
    v_sub_f32 v17, v106, v16
    v_fmac_f32 v18, v17, v17
    v_sub_f32 v17, v107, v16
    v_fmac_f32 v18, v17, v17
    v_sub_f32 v17, v108, v16
    v_fmac_f32 v18, v17, v17
    v_sub_f32 v17, v109, v16
    v_fmac_f32 v18, v17, v17
    v_sub_f32 v17, v110, v16
    v_fmac_f32 v18, v17, v17
    v_sub_f32 v17, v111, v16
    v_fmac_f32 v18, v17, v17
    v_sub_f32 v17, v112, v16
    v_fmac_f32 v18, v17, v17
    v_sub_f32 v17, v113, v16
    v_fmac_f32 v18, v17, v17
    v_sub_f32 v17, v114, v16
    v_fmac_f32 v18, v17, v17
    v_sub_f32 v17, v115, v16
    v_fmac_f32 v18, v17, v17
    v_sub_f32 v17, v116, v16
    v_fmac_f32 v18, v17, v17
    v_sub_f32 v17, v117, v16
    v_fmac_f32 v18, v17, v17
    v_sub_f32 v17, v118, v16
    v_fmac_f32 v18, v17, v17
    v_sub_f32 v17, v119, v16
    v_fmac_f32 v18, v17, v17
    v_sub_f32 v17, v120, v16
    v_fmac_f32 v18, v17, v17
    v_sub_f32 v17, v121, v16
    v_fmac_f32 v18, v17, v17
    v_sub_f32 v17, v122, v16
    v_fmac_f32 v18, v17, v17
    v_sub_f32 v17, v123, v16
    v_fmac_f32 v18, v17, v17
    v_sub_f32 v17, v124, v16
    v_fmac_f32 v18, v17, v17
    v_sub_f32 v17, v125, v16
    v_fmac_f32 v18, v17, v17
    v_sub_f32 v17, v126, v16
    v_fmac_f32 v18, v17, v17
    v_sub_f32 v17, v127, v16
    v_fmac_f32 v18, v17, v17
    v_sub_f32 v17, v128, v16
    v_fmac_f32 v18, v17, v17
    v_sub_f32 v17, v129, v16
    v_fmac_f32 v18, v17, v17
    v_sub_f32 v17, v130, v16
    v_fmac_f32 v18, v17, v17
    v_sub_f32 v17, v131, v16
    v_fmac_f32 v18, v17, v17
    v_sub_f32 v17, v132, v16
    v_fmac_f32 v18, v17, v17
    v_sub_f32 v17, v133, v16
    v_fmac_f32 v18, v17, v17
    v_sub_f32 v17, v134, v16
    v_fmac_f32 v18, v17, v17
    v_sub_f32 v17, v135, v16
    v_fmac_f32 v18, v17, v17
    v_sub_f32 v17, v136, v16
    v_fmac_f32 v18, v17, v17
    v_sub_f32 v17, v137, v16
    v_fmac_f32 v18, v17, v17
    v_sub_f32 v17, v138, v16
    v_fmac_f32 v18, v17, v17
    v_sub_f32 v17, v139, v16
    v_fmac_f32 v18, v17, v17
    v_sub_f32 v17, v140, v16
    v_fmac_f32 v18, v17, v17
    v_sub_f32 v17, v141, v16
    v_fmac_f32 v18, v17, v17
    v_sub_f32 v17, v142, v16
    v_fmac_f32 v18, v17, v17
    v_sub_f32 v17, v143, v16
    v_fmac_f32 v18, v17, v17
    v_sub_f32 v17, v144, v16
    v_fmac_f32 v18, v17, v17
    v_sub_f32 v17, v145, v16
    v_fmac_f32 v18, v17, v17
    v_sub_f32 v17, v146, v16
    v_fmac_f32 v18, v17, v17
    v_sub_f32 v17, v147, v16
    v_fmac_f32 v18, v17, v17
    v_sub_f32 v17, v148, v16
    v_fmac_f32 v18, v17, v17
    v_sub_f32 v17, v149, v16
    v_fmac_f32 v18, v17, v17
    v_sub_f32 v17, v150, v16
    v_fmac_f32 v18, v17, v17
    v_sub_f32 v17, v151, v16
    v_fmac_f32 v18, v17, v17
    v_sub_f32 v17, v152, v16
    v_fmac_f32 v18, v17, v17
    v_sub_f32 v17, v153, v16
    v_fmac_f32 v18, v17, v17
    v_sub_f32 v17, v154, v16
    v_fmac_f32 v18, v17, v17
    v_sub_f32 v17, v155, v16
    v_fmac_f32 v18, v17, v17
    v_sub_f32 v17, v156, v16
    v_fmac_f32 v18, v17, v17
    v_sub_f32 v17, v157, v16
    v_fmac_f32 v18, v17, v17
    v_sub_f32 v17, v158, v16
    v_fmac_f32 v18, v17, v17
    v_sub_f32 v17, v159, v16
    v_fmac_f32 v18, v17, v17
    v_sub_f32 v17, v160, v16
    v_fmac_f32 v18, v17, v17
    v_sub_f32 v17, v161, v16
    v_fmac_f32 v18, v17, v17
    v_sub_f32 v17, v162, v16
    v_fmac_f32 v18, v17, v17
    v_sub_f32 v17, v163, v16
    v_fmac_f32 v18, v17, v17
    v_sub_f32 v17, v164, v16
    v_fmac_f32 v18, v17, v17
    v_sub_f32 v17, v165, v16
    v_fmac_f32 v18, v17, v17
    v_sub_f32 v17, v166, v16
    v_fmac_f32 v18, v17, v17
    v_sub_f32 v17, v167, v16
    v_fmac_f32 v18, v17, v17
    v_sub_f32 v17, v168, v16
    v_fmac_f32 v18, v17, v17
    v_sub_f32 v17, v169, v16
    v_fmac_f32 v18, v17, v17
    v_sub_f32 v17, v170, v16
    v_fmac_f32 v18, v17, v17
    v_sub_f32 v17, v171, v16
    v_fmac_f32 v18, v17, v17
    v_sub_f32 v17, v172, v16
    v_fmac_f32 v18, v17, v17
    v_sub_f32 v17, v173, v16
    v_fmac_f32 v18, v17, v17
    v_sub_f32 v17, v174, v16
    v_fmac_f32 v18, v17, v17
    v_sub_f32 v17, v175, v16
    v_fmac_f32 v18, v17, v17
    v_sub_f32 v17, v176, v16
    v_fmac_f32 v18, v17, v17
    v_sub_f32 v17, v177, v16
    v_fmac_f32 v18, v17, v17
    v_sub_f32 v17, v178, v16
    v_fmac_f32 v18, v17, v17
    v_sub_f32 v17, v179, v16
    v_fmac_f32 v18, v17, v17
    v_sub_f32 v17, v180, v16
    v_fmac_f32 v18, v17, v17
    v_sub_f32 v17, v181, v16
    v_fmac_f32 v18, v17, v17
    v_sub_f32 v17, v182, v16
    v_fmac_f32 v18, v17, v17
    v_sub_f32 v17, v183, v16
    v_fmac_f32 v18, v17, v17
    v_sub_f32 v17, v184, v16
    v_fmac_f32 v18, v17, v17
    v_sub_f32 v17, v185, v16
    v_fmac_f32 v18, v17, v17
    v_sub_f32 v17, v186, v16
    v_fmac_f32 v18, v17, v17
    v_sub_f32 v17, v187, v16
    v_fmac_f32 v18, v17, v17
    v_sub_f32 v17, v188, v16
    v_fmac_f32 v18, v17, v17
    v_sub_f32 v17, v189, v16
    v_fmac_f32 v18, v17, v17
    v_sub_f32 v17, v190, v16
    v_fmac_f32 v18, v17, v17
    v_sub_f32 v17, v191, v16
    v_fmac_f32 v18, v17, v17
    v_sub_f32 v17, v192, v16
    v_fmac_f32 v18, v17, v17
    v_sub_f32 v17, v193, v16
    v_fmac_f32 v18, v17, v17
    v_sub_f32 v17, v194, v16
    v_fmac_f32 v18, v17, v17
    v_sub_f32 v17, v195, v16
    v_fmac_f32 v18, v17, v17
    v_sub_f32 v17, v196, v16
    v_fmac_f32 v18, v17, v17
    v_sub_f32 v17, v197, v16
    v_fmac_f32 v18, v17, v17
    v_sub_f32 v17, v198, v16
    v_fmac_f32 v18, v17, v17
    v_sub_f32 v17, v199, v16
    v_fmac_f32 v18, v17, v17
    v_sub_f32 v17, v200, v16
    v_fmac_f32 v18, v17, v17
    v_sub_f32 v17, v201, v16
    v_fmac_f32 v18, v17, v17
    v_sub_f32 v17, v202, v16
    v_fmac_f32 v18, v17, v17
    v_sub_f32 v17, v203, v16
    v_fmac_f32 v18, v17, v17
    v_sub_f32 v17, v204, v16
    v_fmac_f32 v18, v17, v17
    v_sub_f32 v17, v205, v16
    v_fmac_f32 v18, v17, v17
    v_sub_f32 v17, v206, v16
    v_fmac_f32 v18, v17, v17
    v_sub_f32 v17, v207, v16
    v_fmac_f32 v18, v17, v17
    v_sub_f32 v17, v208, v16
    v_fmac_f32 v18, v17, v17
    v_sub_f32 v17, v209, v16
    v_fmac_f32 v18, v17, v17
    v_sub_f32 v17, v210, v16
    v_fmac_f32 v18, v17, v17
    v_sub_f32 v17, v211, v16
    v_fmac_f32 v18, v17, v17
    v_sub_f32 v17, v212, v16
    v_fmac_f32 v18, v17, v17
    v_sub_f32 v17, v213, v16
    v_fmac_f32 v18, v17, v17
    v_sub_f32 v17, v214, v16
    v_fmac_f32 v18, v17, v17
    v_sub_f32 v17, v215, v16
    v_fmac_f32 v18, v17, v17
    v_sub_f32 v17, v216, v16
    v_fmac_f32 v18, v17, v17
    v_sub_f32 v17, v217, v16
    v_fmac_f32 v18, v17, v17
    v_sub_f32 v17, v218, v16
    v_fmac_f32 v18, v17, v17
    v_sub_f32 v17, v219, v16
    v_fmac_f32 v18, v17, v17
    v_sub_f32 v17, v220, v16
    v_fmac_f32 v18, v17, v17
    v_sub_f32 v17, v221, v16
    v_fmac_f32 v18, v17, v17
    v_sub_f32 v17, v222, v16
    v_fmac_f32 v18, v17, v17
    v_sub_f32 v17, v223, v16
    v_fmac_f32 v18, v17, v17
    ds_bpermute_b32 v17, v6, v18
    s_waitcnt lgkmcnt(0)
    v_add_f32 v18, v18, v17
    ds_bpermute_b32 v17, v7, v18
    s_waitcnt lgkmcnt(0)
    v_add_f32 v18, v18, v17
    v_mul_f32 v18, 0x3b000000, v18
    v_cvt_pk_bf16_f32 v16, v16, v16
    v_lshlrev_b32 v16, 16, v16
    v_cvt_pk_bf16_f32 v18, v18, v18
    v_lshlrev_b32 v18, 16, v18
    v_add_f32 v18, 0x3727c5ac, v18
    v_cvt_pk_bf16_f32 v18, v18, v18
    v_lshlrev_b32 v18, 16, v18
    v_sqrt_f32 v18, v18
    s_nop 0
    v_cvt_pk_bf16_f32 v18, v18, v18
    v_lshlrev_b32 v18, 16, v18
    v_rcp_f32 v19, v18
    s_nop 0
    v_fma_f32 v20, -v18, v19, 2.0
    v_mul_f32 v19, v19, v20
    v_sub_f32 v96, v96, v16
    v_sub_f32 v97, v97, v16
    v_cvt_pk_bf16_f32 v20, v96, v97
    v_lshlrev_b32 v96, 16, v20
    v_and_b32 v97, 0xffff0000, v20
    v_mul_f32 v96, v96, v19
    v_mul_f32 v97, v97, v19
    v_cvt_pk_bf16_f32 v32, v96, v97
    v_sub_f32 v98, v98, v16
    v_sub_f32 v99, v99, v16
    v_cvt_pk_bf16_f32 v20, v98, v99
    v_lshlrev_b32 v98, 16, v20
    v_and_b32 v99, 0xffff0000, v20
    v_mul_f32 v98, v98, v19
    v_mul_f32 v99, v99, v19
    v_cvt_pk_bf16_f32 v33, v98, v99
    v_sub_f32 v100, v100, v16
    v_sub_f32 v101, v101, v16
    v_cvt_pk_bf16_f32 v20, v100, v101
    v_lshlrev_b32 v100, 16, v20
    v_and_b32 v101, 0xffff0000, v20
    v_mul_f32 v100, v100, v19
    v_mul_f32 v101, v101, v19
    v_cvt_pk_bf16_f32 v34, v100, v101
    v_sub_f32 v102, v102, v16
    v_sub_f32 v103, v103, v16
    v_cvt_pk_bf16_f32 v20, v102, v103
    v_lshlrev_b32 v102, 16, v20
    v_and_b32 v103, 0xffff0000, v20
    v_mul_f32 v102, v102, v19
    v_mul_f32 v103, v103, v19
    v_cvt_pk_bf16_f32 v35, v102, v103
    v_sub_f32 v104, v104, v16
    v_sub_f32 v105, v105, v16
    v_cvt_pk_bf16_f32 v20, v104, v105
    v_lshlrev_b32 v104, 16, v20
    v_and_b32 v105, 0xffff0000, v20
    v_mul_f32 v104, v104, v19
    v_mul_f32 v105, v105, v19
    v_cvt_pk_bf16_f32 v36, v104, v105
    v_sub_f32 v106, v106, v16
    v_sub_f32 v107, v107, v16
    v_cvt_pk_bf16_f32 v20, v106, v107
    v_lshlrev_b32 v106, 16, v20
    v_and_b32 v107, 0xffff0000, v20
    v_mul_f32 v106, v106, v19
    v_mul_f32 v107, v107, v19
    v_cvt_pk_bf16_f32 v37, v106, v107
    v_sub_f32 v108, v108, v16
    v_sub_f32 v109, v109, v16
    v_cvt_pk_bf16_f32 v20, v108, v109
    v_lshlrev_b32 v108, 16, v20
    v_and_b32 v109, 0xffff0000, v20
    v_mul_f32 v108, v108, v19
    v_mul_f32 v109, v109, v19
    v_cvt_pk_bf16_f32 v38, v108, v109
    v_sub_f32 v110, v110, v16
    v_sub_f32 v111, v111, v16
    v_cvt_pk_bf16_f32 v20, v110, v111
    v_lshlrev_b32 v110, 16, v20
    v_and_b32 v111, 0xffff0000, v20
    v_mul_f32 v110, v110, v19
    v_mul_f32 v111, v111, v19
    v_cvt_pk_bf16_f32 v39, v110, v111
    v_sub_f32 v112, v112, v16
    v_sub_f32 v113, v113, v16
    v_cvt_pk_bf16_f32 v20, v112, v113
    v_lshlrev_b32 v112, 16, v20
    v_and_b32 v113, 0xffff0000, v20
    v_mul_f32 v112, v112, v19
    v_mul_f32 v113, v113, v19
    v_cvt_pk_bf16_f32 v40, v112, v113
    v_sub_f32 v114, v114, v16
    v_sub_f32 v115, v115, v16
    v_cvt_pk_bf16_f32 v20, v114, v115
    v_lshlrev_b32 v114, 16, v20
    v_and_b32 v115, 0xffff0000, v20
    v_mul_f32 v114, v114, v19
    v_mul_f32 v115, v115, v19
    v_cvt_pk_bf16_f32 v41, v114, v115
    v_sub_f32 v116, v116, v16
    v_sub_f32 v117, v117, v16
    v_cvt_pk_bf16_f32 v20, v116, v117
    v_lshlrev_b32 v116, 16, v20
    v_and_b32 v117, 0xffff0000, v20
    v_mul_f32 v116, v116, v19
    v_mul_f32 v117, v117, v19
    v_cvt_pk_bf16_f32 v42, v116, v117
    v_sub_f32 v118, v118, v16
    v_sub_f32 v119, v119, v16
    v_cvt_pk_bf16_f32 v20, v118, v119
    v_lshlrev_b32 v118, 16, v20
    v_and_b32 v119, 0xffff0000, v20
    v_mul_f32 v118, v118, v19
    v_mul_f32 v119, v119, v19
    v_cvt_pk_bf16_f32 v43, v118, v119
    v_sub_f32 v120, v120, v16
    v_sub_f32 v121, v121, v16
    v_cvt_pk_bf16_f32 v20, v120, v121
    v_lshlrev_b32 v120, 16, v20
    v_and_b32 v121, 0xffff0000, v20
    v_mul_f32 v120, v120, v19
    v_mul_f32 v121, v121, v19
    v_cvt_pk_bf16_f32 v44, v120, v121
    v_sub_f32 v122, v122, v16
    v_sub_f32 v123, v123, v16
    v_cvt_pk_bf16_f32 v20, v122, v123
    v_lshlrev_b32 v122, 16, v20
    v_and_b32 v123, 0xffff0000, v20
    v_mul_f32 v122, v122, v19
    v_mul_f32 v123, v123, v19
    v_cvt_pk_bf16_f32 v45, v122, v123
    v_sub_f32 v124, v124, v16
    v_sub_f32 v125, v125, v16
    v_cvt_pk_bf16_f32 v20, v124, v125
    v_lshlrev_b32 v124, 16, v20
    v_and_b32 v125, 0xffff0000, v20
    v_mul_f32 v124, v124, v19
    v_mul_f32 v125, v125, v19
    v_cvt_pk_bf16_f32 v46, v124, v125
    v_sub_f32 v126, v126, v16
    v_sub_f32 v127, v127, v16
    v_cvt_pk_bf16_f32 v20, v126, v127
    v_lshlrev_b32 v126, 16, v20
    v_and_b32 v127, 0xffff0000, v20
    v_mul_f32 v126, v126, v19
    v_mul_f32 v127, v127, v19
    v_cvt_pk_bf16_f32 v47, v126, v127
    v_sub_f32 v128, v128, v16
    v_sub_f32 v129, v129, v16
    v_cvt_pk_bf16_f32 v20, v128, v129
    v_lshlrev_b32 v128, 16, v20
    v_and_b32 v129, 0xffff0000, v20
    v_mul_f32 v128, v128, v19
    v_mul_f32 v129, v129, v19
    v_cvt_pk_bf16_f32 v48, v128, v129
    v_sub_f32 v130, v130, v16
    v_sub_f32 v131, v131, v16
    v_cvt_pk_bf16_f32 v20, v130, v131
    v_lshlrev_b32 v130, 16, v20
    v_and_b32 v131, 0xffff0000, v20
    v_mul_f32 v130, v130, v19
    v_mul_f32 v131, v131, v19
    v_cvt_pk_bf16_f32 v49, v130, v131
    v_sub_f32 v132, v132, v16
    v_sub_f32 v133, v133, v16
    v_cvt_pk_bf16_f32 v20, v132, v133
    v_lshlrev_b32 v132, 16, v20
    v_and_b32 v133, 0xffff0000, v20
    v_mul_f32 v132, v132, v19
    v_mul_f32 v133, v133, v19
    v_cvt_pk_bf16_f32 v50, v132, v133
    v_sub_f32 v134, v134, v16
    v_sub_f32 v135, v135, v16
    v_cvt_pk_bf16_f32 v20, v134, v135
    v_lshlrev_b32 v134, 16, v20
    v_and_b32 v135, 0xffff0000, v20
    v_mul_f32 v134, v134, v19
    v_mul_f32 v135, v135, v19
    v_cvt_pk_bf16_f32 v51, v134, v135
    v_sub_f32 v136, v136, v16
    v_sub_f32 v137, v137, v16
    v_cvt_pk_bf16_f32 v20, v136, v137
    v_lshlrev_b32 v136, 16, v20
    v_and_b32 v137, 0xffff0000, v20
    v_mul_f32 v136, v136, v19
    v_mul_f32 v137, v137, v19
    v_cvt_pk_bf16_f32 v52, v136, v137
    v_sub_f32 v138, v138, v16
    v_sub_f32 v139, v139, v16
    v_cvt_pk_bf16_f32 v20, v138, v139
    v_lshlrev_b32 v138, 16, v20
    v_and_b32 v139, 0xffff0000, v20
    v_mul_f32 v138, v138, v19
    v_mul_f32 v139, v139, v19
    v_cvt_pk_bf16_f32 v53, v138, v139
    v_sub_f32 v140, v140, v16
    v_sub_f32 v141, v141, v16
    v_cvt_pk_bf16_f32 v20, v140, v141
    v_lshlrev_b32 v140, 16, v20
    v_and_b32 v141, 0xffff0000, v20
    v_mul_f32 v140, v140, v19
    v_mul_f32 v141, v141, v19
    v_cvt_pk_bf16_f32 v54, v140, v141
    v_sub_f32 v142, v142, v16
    v_sub_f32 v143, v143, v16
    v_cvt_pk_bf16_f32 v20, v142, v143
    v_lshlrev_b32 v142, 16, v20
    v_and_b32 v143, 0xffff0000, v20
    v_mul_f32 v142, v142, v19
    v_mul_f32 v143, v143, v19
    v_cvt_pk_bf16_f32 v55, v142, v143
    v_sub_f32 v144, v144, v16
    v_sub_f32 v145, v145, v16
    v_cvt_pk_bf16_f32 v20, v144, v145
    v_lshlrev_b32 v144, 16, v20
    v_and_b32 v145, 0xffff0000, v20
    v_mul_f32 v144, v144, v19
    v_mul_f32 v145, v145, v19
    v_cvt_pk_bf16_f32 v56, v144, v145
    v_sub_f32 v146, v146, v16
    v_sub_f32 v147, v147, v16
    v_cvt_pk_bf16_f32 v20, v146, v147
    v_lshlrev_b32 v146, 16, v20
    v_and_b32 v147, 0xffff0000, v20
    v_mul_f32 v146, v146, v19
    v_mul_f32 v147, v147, v19
    v_cvt_pk_bf16_f32 v57, v146, v147
    v_sub_f32 v148, v148, v16
    v_sub_f32 v149, v149, v16
    v_cvt_pk_bf16_f32 v20, v148, v149
    v_lshlrev_b32 v148, 16, v20
    v_and_b32 v149, 0xffff0000, v20
    v_mul_f32 v148, v148, v19
    v_mul_f32 v149, v149, v19
    v_cvt_pk_bf16_f32 v58, v148, v149
    v_sub_f32 v150, v150, v16
    v_sub_f32 v151, v151, v16
    v_cvt_pk_bf16_f32 v20, v150, v151
    v_lshlrev_b32 v150, 16, v20
    v_and_b32 v151, 0xffff0000, v20
    v_mul_f32 v150, v150, v19
    v_mul_f32 v151, v151, v19
    v_cvt_pk_bf16_f32 v59, v150, v151
    v_sub_f32 v152, v152, v16
    v_sub_f32 v153, v153, v16
    v_cvt_pk_bf16_f32 v20, v152, v153
    v_lshlrev_b32 v152, 16, v20
    v_and_b32 v153, 0xffff0000, v20
    v_mul_f32 v152, v152, v19
    v_mul_f32 v153, v153, v19
    v_cvt_pk_bf16_f32 v60, v152, v153
    v_sub_f32 v154, v154, v16
    v_sub_f32 v155, v155, v16
    v_cvt_pk_bf16_f32 v20, v154, v155
    v_lshlrev_b32 v154, 16, v20
    v_and_b32 v155, 0xffff0000, v20
    v_mul_f32 v154, v154, v19
    v_mul_f32 v155, v155, v19
    v_cvt_pk_bf16_f32 v61, v154, v155
    v_sub_f32 v156, v156, v16
    v_sub_f32 v157, v157, v16
    v_cvt_pk_bf16_f32 v20, v156, v157
    v_lshlrev_b32 v156, 16, v20
    v_and_b32 v157, 0xffff0000, v20
    v_mul_f32 v156, v156, v19
    v_mul_f32 v157, v157, v19
    v_cvt_pk_bf16_f32 v62, v156, v157
    v_sub_f32 v158, v158, v16
    v_sub_f32 v159, v159, v16
    v_cvt_pk_bf16_f32 v20, v158, v159
    v_lshlrev_b32 v158, 16, v20
    v_and_b32 v159, 0xffff0000, v20
    v_mul_f32 v158, v158, v19
    v_mul_f32 v159, v159, v19
    v_cvt_pk_bf16_f32 v63, v158, v159
    v_sub_f32 v160, v160, v16
    v_sub_f32 v161, v161, v16
    v_cvt_pk_bf16_f32 v20, v160, v161
    v_lshlrev_b32 v160, 16, v20
    v_and_b32 v161, 0xffff0000, v20
    v_mul_f32 v160, v160, v19
    v_mul_f32 v161, v161, v19
    v_cvt_pk_bf16_f32 v64, v160, v161
    v_sub_f32 v162, v162, v16
    v_sub_f32 v163, v163, v16
    v_cvt_pk_bf16_f32 v20, v162, v163
    v_lshlrev_b32 v162, 16, v20
    v_and_b32 v163, 0xffff0000, v20
    v_mul_f32 v162, v162, v19
    v_mul_f32 v163, v163, v19
    v_cvt_pk_bf16_f32 v65, v162, v163
    v_sub_f32 v164, v164, v16
    v_sub_f32 v165, v165, v16
    v_cvt_pk_bf16_f32 v20, v164, v165
    v_lshlrev_b32 v164, 16, v20
    v_and_b32 v165, 0xffff0000, v20
    v_mul_f32 v164, v164, v19
    v_mul_f32 v165, v165, v19
    v_cvt_pk_bf16_f32 v66, v164, v165
    v_sub_f32 v166, v166, v16
    v_sub_f32 v167, v167, v16
    v_cvt_pk_bf16_f32 v20, v166, v167
    v_lshlrev_b32 v166, 16, v20
    v_and_b32 v167, 0xffff0000, v20
    v_mul_f32 v166, v166, v19
    v_mul_f32 v167, v167, v19
    v_cvt_pk_bf16_f32 v67, v166, v167
    v_sub_f32 v168, v168, v16
    v_sub_f32 v169, v169, v16
    v_cvt_pk_bf16_f32 v20, v168, v169
    v_lshlrev_b32 v168, 16, v20
    v_and_b32 v169, 0xffff0000, v20
    v_mul_f32 v168, v168, v19
    v_mul_f32 v169, v169, v19
    v_cvt_pk_bf16_f32 v68, v168, v169
    v_sub_f32 v170, v170, v16
    v_sub_f32 v171, v171, v16
    v_cvt_pk_bf16_f32 v20, v170, v171
    v_lshlrev_b32 v170, 16, v20
    v_and_b32 v171, 0xffff0000, v20
    v_mul_f32 v170, v170, v19
    v_mul_f32 v171, v171, v19
    v_cvt_pk_bf16_f32 v69, v170, v171
    v_sub_f32 v172, v172, v16
    v_sub_f32 v173, v173, v16
    v_cvt_pk_bf16_f32 v20, v172, v173
    v_lshlrev_b32 v172, 16, v20
    v_and_b32 v173, 0xffff0000, v20
    v_mul_f32 v172, v172, v19
    v_mul_f32 v173, v173, v19
    v_cvt_pk_bf16_f32 v70, v172, v173
    v_sub_f32 v174, v174, v16
    v_sub_f32 v175, v175, v16
    v_cvt_pk_bf16_f32 v20, v174, v175
    v_lshlrev_b32 v174, 16, v20
    v_and_b32 v175, 0xffff0000, v20
    v_mul_f32 v174, v174, v19
    v_mul_f32 v175, v175, v19
    v_cvt_pk_bf16_f32 v71, v174, v175
    v_sub_f32 v176, v176, v16
    v_sub_f32 v177, v177, v16
    v_cvt_pk_bf16_f32 v20, v176, v177
    v_lshlrev_b32 v176, 16, v20
    v_and_b32 v177, 0xffff0000, v20
    v_mul_f32 v176, v176, v19
    v_mul_f32 v177, v177, v19
    v_cvt_pk_bf16_f32 v72, v176, v177
    v_sub_f32 v178, v178, v16
    v_sub_f32 v179, v179, v16
    v_cvt_pk_bf16_f32 v20, v178, v179
    v_lshlrev_b32 v178, 16, v20
    v_and_b32 v179, 0xffff0000, v20
    v_mul_f32 v178, v178, v19
    v_mul_f32 v179, v179, v19
    v_cvt_pk_bf16_f32 v73, v178, v179
    v_sub_f32 v180, v180, v16
    v_sub_f32 v181, v181, v16
    v_cvt_pk_bf16_f32 v20, v180, v181
    v_lshlrev_b32 v180, 16, v20
    v_and_b32 v181, 0xffff0000, v20
    v_mul_f32 v180, v180, v19
    v_mul_f32 v181, v181, v19
    v_cvt_pk_bf16_f32 v74, v180, v181
    v_sub_f32 v182, v182, v16
    v_sub_f32 v183, v183, v16
    v_cvt_pk_bf16_f32 v20, v182, v183
    v_lshlrev_b32 v182, 16, v20
    v_and_b32 v183, 0xffff0000, v20
    v_mul_f32 v182, v182, v19
    v_mul_f32 v183, v183, v19
    v_cvt_pk_bf16_f32 v75, v182, v183
    v_sub_f32 v184, v184, v16
    v_sub_f32 v185, v185, v16
    v_cvt_pk_bf16_f32 v20, v184, v185
    v_lshlrev_b32 v184, 16, v20
    v_and_b32 v185, 0xffff0000, v20
    v_mul_f32 v184, v184, v19
    v_mul_f32 v185, v185, v19
    v_cvt_pk_bf16_f32 v76, v184, v185
    v_sub_f32 v186, v186, v16
    v_sub_f32 v187, v187, v16
    v_cvt_pk_bf16_f32 v20, v186, v187
    v_lshlrev_b32 v186, 16, v20
    v_and_b32 v187, 0xffff0000, v20
    v_mul_f32 v186, v186, v19
    v_mul_f32 v187, v187, v19
    v_cvt_pk_bf16_f32 v77, v186, v187
    v_sub_f32 v188, v188, v16
    v_sub_f32 v189, v189, v16
    v_cvt_pk_bf16_f32 v20, v188, v189
    v_lshlrev_b32 v188, 16, v20
    v_and_b32 v189, 0xffff0000, v20
    v_mul_f32 v188, v188, v19
    v_mul_f32 v189, v189, v19
    v_cvt_pk_bf16_f32 v78, v188, v189
    v_sub_f32 v190, v190, v16
    v_sub_f32 v191, v191, v16
    v_cvt_pk_bf16_f32 v20, v190, v191
    v_lshlrev_b32 v190, 16, v20
    v_and_b32 v191, 0xffff0000, v20
    v_mul_f32 v190, v190, v19
    v_mul_f32 v191, v191, v19
    v_cvt_pk_bf16_f32 v79, v190, v191
    v_sub_f32 v192, v192, v16
    v_sub_f32 v193, v193, v16
    v_cvt_pk_bf16_f32 v20, v192, v193
    v_lshlrev_b32 v192, 16, v20
    v_and_b32 v193, 0xffff0000, v20
    v_mul_f32 v192, v192, v19
    v_mul_f32 v193, v193, v19
    v_cvt_pk_bf16_f32 v80, v192, v193
    v_sub_f32 v194, v194, v16
    v_sub_f32 v195, v195, v16
    v_cvt_pk_bf16_f32 v20, v194, v195
    v_lshlrev_b32 v194, 16, v20
    v_and_b32 v195, 0xffff0000, v20
    v_mul_f32 v194, v194, v19
    v_mul_f32 v195, v195, v19
    v_cvt_pk_bf16_f32 v81, v194, v195
    v_sub_f32 v196, v196, v16
    v_sub_f32 v197, v197, v16
    v_cvt_pk_bf16_f32 v20, v196, v197
    v_lshlrev_b32 v196, 16, v20
    v_and_b32 v197, 0xffff0000, v20
    v_mul_f32 v196, v196, v19
    v_mul_f32 v197, v197, v19
    v_cvt_pk_bf16_f32 v82, v196, v197
    v_sub_f32 v198, v198, v16
    v_sub_f32 v199, v199, v16
    v_cvt_pk_bf16_f32 v20, v198, v199
    v_lshlrev_b32 v198, 16, v20
    v_and_b32 v199, 0xffff0000, v20
    v_mul_f32 v198, v198, v19
    v_mul_f32 v199, v199, v19
    v_cvt_pk_bf16_f32 v83, v198, v199
    v_sub_f32 v200, v200, v16
    v_sub_f32 v201, v201, v16
    v_cvt_pk_bf16_f32 v20, v200, v201
    v_lshlrev_b32 v200, 16, v20
    v_and_b32 v201, 0xffff0000, v20
    v_mul_f32 v200, v200, v19
    v_mul_f32 v201, v201, v19
    v_cvt_pk_bf16_f32 v84, v200, v201
    v_sub_f32 v202, v202, v16
    v_sub_f32 v203, v203, v16
    v_cvt_pk_bf16_f32 v20, v202, v203
    v_lshlrev_b32 v202, 16, v20
    v_and_b32 v203, 0xffff0000, v20
    v_mul_f32 v202, v202, v19
    v_mul_f32 v203, v203, v19
    v_cvt_pk_bf16_f32 v85, v202, v203
    v_sub_f32 v204, v204, v16
    v_sub_f32 v205, v205, v16
    v_cvt_pk_bf16_f32 v20, v204, v205
    v_lshlrev_b32 v204, 16, v20
    v_and_b32 v205, 0xffff0000, v20
    v_mul_f32 v204, v204, v19
    v_mul_f32 v205, v205, v19
    v_cvt_pk_bf16_f32 v86, v204, v205
    v_sub_f32 v206, v206, v16
    v_sub_f32 v207, v207, v16
    v_cvt_pk_bf16_f32 v20, v206, v207
    v_lshlrev_b32 v206, 16, v20
    v_and_b32 v207, 0xffff0000, v20
    v_mul_f32 v206, v206, v19
    v_mul_f32 v207, v207, v19
    v_cvt_pk_bf16_f32 v87, v206, v207
    v_sub_f32 v208, v208, v16
    v_sub_f32 v209, v209, v16
    v_cvt_pk_bf16_f32 v20, v208, v209
    v_lshlrev_b32 v208, 16, v20
    v_and_b32 v209, 0xffff0000, v20
    v_mul_f32 v208, v208, v19
    v_mul_f32 v209, v209, v19
    v_cvt_pk_bf16_f32 v88, v208, v209
    v_sub_f32 v210, v210, v16
    v_sub_f32 v211, v211, v16
    v_cvt_pk_bf16_f32 v20, v210, v211
    v_lshlrev_b32 v210, 16, v20
    v_and_b32 v211, 0xffff0000, v20
    v_mul_f32 v210, v210, v19
    v_mul_f32 v211, v211, v19
    v_cvt_pk_bf16_f32 v89, v210, v211
    v_sub_f32 v212, v212, v16
    v_sub_f32 v213, v213, v16
    v_cvt_pk_bf16_f32 v20, v212, v213
    v_lshlrev_b32 v212, 16, v20
    v_and_b32 v213, 0xffff0000, v20
    v_mul_f32 v212, v212, v19
    v_mul_f32 v213, v213, v19
    v_cvt_pk_bf16_f32 v90, v212, v213
    v_sub_f32 v214, v214, v16
    v_sub_f32 v215, v215, v16
    v_cvt_pk_bf16_f32 v20, v214, v215
    v_lshlrev_b32 v214, 16, v20
    v_and_b32 v215, 0xffff0000, v20
    v_mul_f32 v214, v214, v19
    v_mul_f32 v215, v215, v19
    v_cvt_pk_bf16_f32 v91, v214, v215
    v_sub_f32 v216, v216, v16
    v_sub_f32 v217, v217, v16
    v_cvt_pk_bf16_f32 v20, v216, v217
    v_lshlrev_b32 v216, 16, v20
    v_and_b32 v217, 0xffff0000, v20
    v_mul_f32 v216, v216, v19
    v_mul_f32 v217, v217, v19
    v_cvt_pk_bf16_f32 v92, v216, v217
    v_sub_f32 v218, v218, v16
    v_sub_f32 v219, v219, v16
    v_cvt_pk_bf16_f32 v20, v218, v219
    v_lshlrev_b32 v218, 16, v20
    v_and_b32 v219, 0xffff0000, v20
    v_mul_f32 v218, v218, v19
    v_mul_f32 v219, v219, v19
    v_cvt_pk_bf16_f32 v93, v218, v219
    v_sub_f32 v220, v220, v16
    v_sub_f32 v221, v221, v16
    v_cvt_pk_bf16_f32 v20, v220, v221
    v_lshlrev_b32 v220, 16, v20
    v_and_b32 v221, 0xffff0000, v20
    v_mul_f32 v220, v220, v19
    v_mul_f32 v221, v221, v19
    v_cvt_pk_bf16_f32 v94, v220, v221
    v_sub_f32 v222, v222, v16
    v_sub_f32 v223, v223, v16
    v_cvt_pk_bf16_f32 v20, v222, v223
    v_lshlrev_b32 v222, 16, v20
    v_and_b32 v223, 0xffff0000, v20
    v_mul_f32 v222, v222, v19
    v_mul_f32 v223, v223, v19
    v_cvt_pk_bf16_f32 v95, v222, v223
    v_add_u32 v9, s7, v4
    ds_write_b128 v9, v[32:35] offset:0
    ds_write_b128 v9, v[36:39] offset:1024
    ds_write_b128 v9, v[40:43] offset:2048
    ds_write_b128 v9, v[44:47] offset:3072
    ds_write_b128 v9, v[48:51] offset:4096
    ds_write_b128 v9, v[52:55] offset:5120
    ds_write_b128 v9, v[56:59] offset:6144
    ds_write_b128 v9, v[60:63] offset:7168
    ds_write_b128 v9, v[64:67] offset:8192
    ds_write_b128 v9, v[68:71] offset:9216
    ds_write_b128 v9, v[72:75] offset:10240
    ds_write_b128 v9, v[76:79] offset:11264
    ds_write_b128 v9, v[80:83] offset:12288
    ds_write_b128 v9, v[84:87] offset:13312
    ds_write_b128 v9, v[88:91] offset:14336
    ds_write_b128 v9, v[92:95] offset:15360
ffn1_noln:
    s_waitcnt vmcnt(0) lgkmcnt(0)
    s_barrier
    ds_read_b128 v[32:35], v4 offset:0
    ds_read_b128 v[36:39], v4 offset:16384
    ds_read_b128 v[40:43], v4 offset:1024
    ds_read_b128 v[44:47], v4 offset:17408
    ds_read_b128 v[48:51], v4 offset:2048
    ds_read_b128 v[52:55], v4 offset:18432
    ds_read_b128 v[56:59], v4 offset:3072
    ds_read_b128 v[60:63], v4 offset:19456
    ds_read_b128 v[64:67], v4 offset:4096
    ds_read_b128 v[68:71], v4 offset:20480
    ds_read_b128 v[72:75], v4 offset:5120
    ds_read_b128 v[76:79], v4 offset:21504
    ds_read_b128 v[80:83], v4 offset:6144
    ds_read_b128 v[84:87], v4 offset:22528
    ds_read_b128 v[88:91], v4 offset:7168
    ds_read_b128 v[92:95], v4 offset:23552
    ds_read_b128 v[128:131], v4 offset:8192
    ds_read_b128 v[132:135], v4 offset:24576
    ds_read_b128 v[136:139], v4 offset:9216
    ds_read_b128 v[140:143], v4 offset:25600
    ds_read_b128 v[144:147], v4 offset:10240
    ds_read_b128 v[148:151], v4 offset:26624
    ds_read_b128 v[152:155], v4 offset:11264
    ds_read_b128 v[156:159], v4 offset:27648
    ds_read_b128 v[160:163], v4 offset:12288
    ds_read_b128 v[164:167], v4 offset:28672
    ds_read_b128 v[168:171], v4 offset:13312
    ds_read_b128 v[172:175], v4 offset:29696
    ds_read_b128 v[176:179], v4 offset:14336
    ds_read_b128 v[180:183], v4 offset:30720
    ds_read_b128 v[184:187], v4 offset:15360
    ds_read_b128 v[188:191], v4 offset:31744
    s_waitcnt lgkmcnt(15)
    v_mfma_f32_16x16x32_bf16 v[96:99], a[0:3], v[32:35], 0
    v_mfma_f32_16x16x32_bf16 v[100:103], a[4:7], v[32:35], 0
    v_mfma_f32_16x16x32_bf16 v[104:107], a[8:11], v[32:35], 0
    v_mfma_f32_16x16x32_bf16 v[108:111], a[12:15], v[32:35], 0
    v_mfma_f32_16x16x32_bf16 v[112:115], a[0:3], v[36:39], 0
    v_mfma_f32_16x16x32_bf16 v[116:119], a[4:7], v[36:39], 0
    v_mfma_f32_16x16x32_bf16 v[120:123], a[8:11], v[36:39], 0
    v_mfma_f32_16x16x32_bf16 v[124:127], a[12:15], v[36:39], 0
    s_waitcnt lgkmcnt(15)
    v_mfma_f32_16x16x32_bf16 v[96:99], a[16:19], v[40:43], v[96:99]
    v_mfma_f32_16x16x32_bf16 v[100:103], a[20:23], v[40:43], v[100:103]
    v_mfma_f32_16x16x32_bf16 v[104:107], a[24:27], v[40:43], v[104:107]
    v_mfma_f32_16x16x32_bf16 v[108:111], a[28:31], v[40:43], v[108:111]
    v_mfma_f32_16x16x32_bf16 v[112:115], a[16:19], v[44:47], v[112:115]
    v_mfma_f32_16x16x32_bf16 v[116:119], a[20:23], v[44:47], v[116:119]
    v_mfma_f32_16x16x32_bf16 v[120:123], a[24:27], v[44:47], v[120:123]
    v_mfma_f32_16x16x32_bf16 v[124:127], a[28:31], v[44:47], v[124:127]
    s_waitcnt lgkmcnt(15)
    v_mfma_f32_16x16x32_bf16 v[96:99], a[32:35], v[48:51], v[96:99]
    v_mfma_f32_16x16x32_bf16 v[100:103], a[36:39], v[48:51], v[100:103]
    v_mfma_f32_16x16x32_bf16 v[104:107], a[40:43], v[48:51], v[104:107]
    v_mfma_f32_16x16x32_bf16 v[108:111], a[44:47], v[48:51], v[108:111]
    v_mfma_f32_16x16x32_bf16 v[112:115], a[32:35], v[52:55], v[112:115]
    v_mfma_f32_16x16x32_bf16 v[116:119], a[36:39], v[52:55], v[116:119]
    v_mfma_f32_16x16x32_bf16 v[120:123], a[40:43], v[52:55], v[120:123]
    v_mfma_f32_16x16x32_bf16 v[124:127], a[44:47], v[52:55], v[124:127]
    s_waitcnt lgkmcnt(15)
    v_mfma_f32_16x16x32_bf16 v[96:99], a[48:51], v[56:59], v[96:99]
    v_mfma_f32_16x16x32_bf16 v[100:103], a[52:55], v[56:59], v[100:103]
    v_mfma_f32_16x16x32_bf16 v[104:107], a[56:59], v[56:59], v[104:107]
    v_mfma_f32_16x16x32_bf16 v[108:111], a[60:63], v[56:59], v[108:111]
    v_mfma_f32_16x16x32_bf16 v[112:115], a[48:51], v[60:63], v[112:115]
    v_mfma_f32_16x16x32_bf16 v[116:119], a[52:55], v[60:63], v[116:119]
    v_mfma_f32_16x16x32_bf16 v[120:123], a[56:59], v[60:63], v[120:123]
    v_mfma_f32_16x16x32_bf16 v[124:127], a[60:63], v[60:63], v[124:127]
    s_waitcnt lgkmcnt(15)
    v_mfma_f32_16x16x32_bf16 v[96:99], a[64:67], v[64:67], v[96:99]
    v_mfma_f32_16x16x32_bf16 v[100:103], a[68:71], v[64:67], v[100:103]
    v_mfma_f32_16x16x32_bf16 v[104:107], a[72:75], v[64:67], v[104:107]
    v_mfma_f32_16x16x32_bf16 v[108:111], a[76:79], v[64:67], v[108:111]
    v_mfma_f32_16x16x32_bf16 v[112:115], a[64:67], v[68:71], v[112:115]
    v_mfma_f32_16x16x32_bf16 v[116:119], a[68:71], v[68:71], v[116:119]
    v_mfma_f32_16x16x32_bf16 v[120:123], a[72:75], v[68:71], v[120:123]
    v_mfma_f32_16x16x32_bf16 v[124:127], a[76:79], v[68:71], v[124:127]
    s_waitcnt lgkmcnt(15)
    v_mfma_f32_16x16x32_bf16 v[96:99], a[80:83], v[72:75], v[96:99]
    v_mfma_f32_16x16x32_bf16 v[100:103], a[84:87], v[72:75], v[100:103]
    v_mfma_f32_16x16x32_bf16 v[104:107], a[88:91], v[72:75], v[104:107]
    v_mfma_f32_16x16x32_bf16 v[108:111], a[92:95], v[72:75], v[108:111]
    v_mfma_f32_16x16x32_bf16 v[112:115], a[80:83], v[76:79], v[112:115]
    v_mfma_f32_16x16x32_bf16 v[116:119], a[84:87], v[76:79], v[116:119]
    v_mfma_f32_16x16x32_bf16 v[120:123], a[88:91], v[76:79], v[120:123]
    v_mfma_f32_16x16x32_bf16 v[124:127], a[92:95], v[76:79], v[124:127]
    s_waitcnt lgkmcnt(15)
    v_mfma_f32_16x16x32_bf16 v[96:99], a[96:99], v[80:83], v[96:99]
    v_mfma_f32_16x16x32_bf16 v[100:103], a[100:103], v[80:83], v[100:103]
    v_mfma_f32_16x16x32_bf16 v[104:107], a[104:107], v[80:83], v[104:107]
    v_mfma_f32_16x16x32_bf16 v[108:111], a[108:111], v[80:83], v[108:111]
    v_mfma_f32_16x16x32_bf16 v[112:115], a[96:99], v[84:87], v[112:115]
    v_mfma_f32_16x16x32_bf16 v[116:119], a[100:103], v[84:87], v[116:119]
    v_mfma_f32_16x16x32_bf16 v[120:123], a[104:107], v[84:87], v[120:123]
    v_mfma_f32_16x16x32_bf16 v[124:127], a[108:111], v[84:87], v[124:127]
    s_waitcnt lgkmcnt(15)
    v_mfma_f32_16x16x32_bf16 v[96:99], a[112:115], v[88:91], v[96:99]
    v_mfma_f32_16x16x32_bf16 v[100:103], a[116:119], v[88:91], v[100:103]
    v_mfma_f32_16x16x32_bf16 v[104:107], a[120:123], v[88:91], v[104:107]
    v_mfma_f32_16x16x32_bf16 v[108:111], a[124:127], v[88:91], v[108:111]
    v_mfma_f32_16x16x32_bf16 v[112:115], a[112:115], v[92:95], v[112:115]
    v_mfma_f32_16x16x32_bf16 v[116:119], a[116:119], v[92:95], v[116:119]
    v_mfma_f32_16x16x32_bf16 v[120:123], a[120:123], v[92:95], v[120:123]
    v_mfma_f32_16x16x32_bf16 v[124:127], a[124:127], v[92:95], v[124:127]
    s_waitcnt lgkmcnt(14)
    v_mfma_f32_16x16x32_bf16 v[96:99], a[128:131], v[128:131], v[96:99]
    v_mfma_f32_16x16x32_bf16 v[100:103], a[132:135], v[128:131], v[100:103]
    v_mfma_f32_16x16x32_bf16 v[104:107], a[136:139], v[128:131], v[104:107]
    v_mfma_f32_16x16x32_bf16 v[108:111], a[140:143], v[128:131], v[108:111]
    v_mfma_f32_16x16x32_bf16 v[112:115], a[128:131], v[132:135], v[112:115]
    v_mfma_f32_16x16x32_bf16 v[116:119], a[132:135], v[132:135], v[116:119]
    v_mfma_f32_16x16x32_bf16 v[120:123], a[136:139], v[132:135], v[120:123]
    v_mfma_f32_16x16x32_bf16 v[124:127], a[140:143], v[132:135], v[124:127]
    s_waitcnt lgkmcnt(12)
    v_mfma_f32_16x16x32_bf16 v[96:99], a[144:147], v[136:139], v[96:99]
    v_mfma_f32_16x16x32_bf16 v[100:103], a[148:151], v[136:139], v[100:103]
    v_mfma_f32_16x16x32_bf16 v[104:107], a[152:155], v[136:139], v[104:107]
    v_mfma_f32_16x16x32_bf16 v[108:111], a[156:159], v[136:139], v[108:111]
    v_mfma_f32_16x16x32_bf16 v[112:115], a[144:147], v[140:143], v[112:115]
    v_mfma_f32_16x16x32_bf16 v[116:119], a[148:151], v[140:143], v[116:119]
    v_mfma_f32_16x16x32_bf16 v[120:123], a[152:155], v[140:143], v[120:123]
    v_mfma_f32_16x16x32_bf16 v[124:127], a[156:159], v[140:143], v[124:127]
    s_waitcnt lgkmcnt(10)
    v_mfma_f32_16x16x32_bf16 v[96:99], a[160:163], v[144:147], v[96:99]
    v_mfma_f32_16x16x32_bf16 v[100:103], a[164:167], v[144:147], v[100:103]
    v_mfma_f32_16x16x32_bf16 v[104:107], a[168:171], v[144:147], v[104:107]
    v_mfma_f32_16x16x32_bf16 v[108:111], a[172:175], v[144:147], v[108:111]
    v_mfma_f32_16x16x32_bf16 v[112:115], a[160:163], v[148:151], v[112:115]
    v_mfma_f32_16x16x32_bf16 v[116:119], a[164:167], v[148:151], v[116:119]
    v_mfma_f32_16x16x32_bf16 v[120:123], a[168:171], v[148:151], v[120:123]
    v_mfma_f32_16x16x32_bf16 v[124:127], a[172:175], v[148:151], v[124:127]
    s_waitcnt lgkmcnt(8)
    v_mfma_f32_16x16x32_bf16 v[96:99], a[176:179], v[152:155], v[96:99]
    v_mfma_f32_16x16x32_bf16 v[100:103], a[180:183], v[152:155], v[100:103]
    v_mfma_f32_16x16x32_bf16 v[104:107], a[184:187], v[152:155], v[104:107]
    v_mfma_f32_16x16x32_bf16 v[108:111], a[188:191], v[152:155], v[108:111]
    v_mfma_f32_16x16x32_bf16 v[112:115], a[176:179], v[156:159], v[112:115]
    v_mfma_f32_16x16x32_bf16 v[116:119], a[180:183], v[156:159], v[116:119]
    v_mfma_f32_16x16x32_bf16 v[120:123], a[184:187], v[156:159], v[120:123]
    v_mfma_f32_16x16x32_bf16 v[124:127], a[188:191], v[156:159], v[124:127]
    s_waitcnt lgkmcnt(6)
    v_mfma_f32_16x16x32_bf16 v[96:99], a[192:195], v[160:163], v[96:99]
    v_mfma_f32_16x16x32_bf16 v[100:103], a[196:199], v[160:163], v[100:103]
    v_mfma_f32_16x16x32_bf16 v[104:107], a[200:203], v[160:163], v[104:107]
    v_mfma_f32_16x16x32_bf16 v[108:111], a[204:207], v[160:163], v[108:111]
    v_mfma_f32_16x16x32_bf16 v[112:115], a[192:195], v[164:167], v[112:115]
    v_mfma_f32_16x16x32_bf16 v[116:119], a[196:199], v[164:167], v[116:119]
    v_mfma_f32_16x16x32_bf16 v[120:123], a[200:203], v[164:167], v[120:123]
    v_mfma_f32_16x16x32_bf16 v[124:127], a[204:207], v[164:167], v[124:127]
    s_waitcnt lgkmcnt(4)
    v_mfma_f32_16x16x32_bf16 v[96:99], a[208:211], v[168:171], v[96:99]
    v_mfma_f32_16x16x32_bf16 v[100:103], a[212:215], v[168:171], v[100:103]
    v_mfma_f32_16x16x32_bf16 v[104:107], a[216:219], v[168:171], v[104:107]
    v_mfma_f32_16x16x32_bf16 v[108:111], a[220:223], v[168:171], v[108:111]
    v_mfma_f32_16x16x32_bf16 v[112:115], a[208:211], v[172:175], v[112:115]
    v_mfma_f32_16x16x32_bf16 v[116:119], a[212:215], v[172:175], v[116:119]
    v_mfma_f32_16x16x32_bf16 v[120:123], a[216:219], v[172:175], v[120:123]
    v_mfma_f32_16x16x32_bf16 v[124:127], a[220:223], v[172:175], v[124:127]
    s_waitcnt lgkmcnt(2)
    v_mfma_f32_16x16x32_bf16 v[96:99], a[224:227], v[176:179], v[96:99]
    v_mfma_f32_16x16x32_bf16 v[100:103], a[228:231], v[176:179], v[100:103]
    v_mfma_f32_16x16x32_bf16 v[104:107], a[232:235], v[176:179], v[104:107]
    v_mfma_f32_16x16x32_bf16 v[108:111], a[236:239], v[176:179], v[108:111]
    v_mfma_f32_16x16x32_bf16 v[112:115], a[224:227], v[180:183], v[112:115]
    v_mfma_f32_16x16x32_bf16 v[116:119], a[228:231], v[180:183], v[116:119]
    v_mfma_f32_16x16x32_bf16 v[120:123], a[232:235], v[180:183], v[120:123]
    v_mfma_f32_16x16x32_bf16 v[124:127], a[236:239], v[180:183], v[124:127]
    s_waitcnt lgkmcnt(0)
    v_mfma_f32_16x16x32_bf16 v[96:99], a[240:243], v[184:187], v[96:99]
    v_mfma_f32_16x16x32_bf16 v[100:103], a[244:247], v[184:187], v[100:103]
    v_mfma_f32_16x16x32_bf16 v[104:107], a[248:251], v[184:187], v[104:107]
    v_mfma_f32_16x16x32_bf16 v[108:111], a[252:255], v[184:187], v[108:111]
    v_mfma_f32_16x16x32_bf16 v[112:115], a[240:243], v[188:191], v[112:115]
    v_mfma_f32_16x16x32_bf16 v[116:119], a[244:247], v[188:191], v[116:119]
    v_mfma_f32_16x16x32_bf16 v[120:123], a[248:251], v[188:191], v[120:123]
    v_mfma_f32_16x16x32_bf16 v[124:127], a[252:255], v[188:191], v[124:127]
    s_nop 7
    s_lshl_b32 s17, s4, 3
    s_lshl_b32 s18, s10, 1
    s_add_u32 s17, s17, s18
    s_mul_i32 s17, s17, 57344
    s_lshl_b32 s18, s12, 9
    s_add_u32 s17, s17, s18
    s_add_u32 s17, s17, 119537664
    v_cvt_pk_bf16_f32 v96, v96, v96
    v_lshlrev_b32 v96, 16, v96
    v_cvt_pk_bf16_f32 v97, v97, v97
    v_lshlrev_b32 v97, 16, v97
    v_cvt_pk_bf16_f32 v98, v98, v98
    v_lshlrev_b32 v98, 16, v98
    v_cvt_pk_bf16_f32 v99, v99, v99
    v_lshlrev_b32 v99, 16, v99
    v_cvt_pk_bf16_f32 v100, v100, v100
    v_lshlrev_b32 v100, 16, v100
    v_cvt_pk_bf16_f32 v101, v101, v101
    v_lshlrev_b32 v101, 16, v101
    v_cvt_pk_bf16_f32 v102, v102, v102
    v_lshlrev_b32 v102, 16, v102
    v_cvt_pk_bf16_f32 v103, v103, v103
    v_lshlrev_b32 v103, 16, v103
    v_cvt_pk_bf16_f32 v104, v104, v104
    v_lshlrev_b32 v104, 16, v104
    v_cvt_pk_bf16_f32 v105, v105, v105
    v_lshlrev_b32 v105, 16, v105
    v_cvt_pk_bf16_f32 v106, v106, v106
    v_lshlrev_b32 v106, 16, v106
    v_cvt_pk_bf16_f32 v107, v107, v107
    v_lshlrev_b32 v107, 16, v107
    v_cvt_pk_bf16_f32 v108, v108, v108
    v_lshlrev_b32 v108, 16, v108
    v_cvt_pk_bf16_f32 v109, v109, v109
    v_lshlrev_b32 v109, 16, v109
    v_cvt_pk_bf16_f32 v110, v110, v110
    v_lshlrev_b32 v110, 16, v110
    v_cvt_pk_bf16_f32 v111, v111, v111
    v_lshlrev_b32 v111, 16, v111
    v_mul_f32 v96, v96, v104
    v_mul_f32 v97, v97, v105
    v_mul_f32 v98, v98, v106
    v_mul_f32 v99, v99, v107
    v_mul_f32 v100, v100, v108
    v_mul_f32 v101, v101, v109
    v_mul_f32 v102, v102, v110
    v_mul_f32 v103, v103, v111
    v_cvt_pk_bf16_f32 v32, v96, v97
    v_cvt_pk_bf16_f32 v33, v98, v99
    v_cvt_pk_bf16_f32 v34, v100, v101
    v_cvt_pk_bf16_f32 v35, v102, v103
    buffer_store_dwordx4 v[32:35], v4, s[40:43], s17 offen sc0 sc1
    s_add_u32 s17, s17, 57344
    v_cvt_pk_bf16_f32 v112, v112, v112
    v_lshlrev_b32 v112, 16, v112
    v_cvt_pk_bf16_f32 v113, v113, v113
    v_lshlrev_b32 v113, 16, v113
    v_cvt_pk_bf16_f32 v114, v114, v114
    v_lshlrev_b32 v114, 16, v114
    v_cvt_pk_bf16_f32 v115, v115, v115
    v_lshlrev_b32 v115, 16, v115
    v_cvt_pk_bf16_f32 v116, v116, v116
    v_lshlrev_b32 v116, 16, v116
    v_cvt_pk_bf16_f32 v117, v117, v117
    v_lshlrev_b32 v117, 16, v117
    v_cvt_pk_bf16_f32 v118, v118, v118
    v_lshlrev_b32 v118, 16, v118
    v_cvt_pk_bf16_f32 v119, v119, v119
    v_lshlrev_b32 v119, 16, v119
    v_cvt_pk_bf16_f32 v120, v120, v120
    v_lshlrev_b32 v120, 16, v120
    v_cvt_pk_bf16_f32 v121, v121, v121
    v_lshlrev_b32 v121, 16, v121
    v_cvt_pk_bf16_f32 v122, v122, v122
    v_lshlrev_b32 v122, 16, v122
    v_cvt_pk_bf16_f32 v123, v123, v123
    v_lshlrev_b32 v123, 16, v123
    v_cvt_pk_bf16_f32 v124, v124, v124
    v_lshlrev_b32 v124, 16, v124
    v_cvt_pk_bf16_f32 v125, v125, v125
    v_lshlrev_b32 v125, 16, v125
    v_cvt_pk_bf16_f32 v126, v126, v126
    v_lshlrev_b32 v126, 16, v126
    v_cvt_pk_bf16_f32 v127, v127, v127
    v_lshlrev_b32 v127, 16, v127
    v_mul_f32 v112, v112, v120
    v_mul_f32 v113, v113, v121
    v_mul_f32 v114, v114, v122
    v_mul_f32 v115, v115, v123
    v_mul_f32 v116, v116, v124
    v_mul_f32 v117, v117, v125
    v_mul_f32 v118, v118, v126
    v_mul_f32 v119, v119, v127
    v_cvt_pk_bf16_f32 v36, v112, v113
    v_cvt_pk_bf16_f32 v37, v114, v115
    v_cvt_pk_bf16_f32 v38, v116, v117
    v_cvt_pk_bf16_f32 v39, v118, v119
    buffer_store_dwordx4 v[36:39], v4, s[40:43], s17 offen sc0 sc1
    s_add_u32 s17, s17, 57344
    s_waitcnt vmcnt(0)
    s_barrier
    s_cmp_eq_u32 s3, 0
    s_cbranch_scc0 sg_9
    s_add_u32 s80, s4, 81
    s_lshl_b32 s80, s80, 6
    s_add_u32 s80, s80, 132120576
    v_mov_b32 v16, 1
    v_mov_b32 v17, 0
    s_mov_b64 exec, 1
    buffer_atomic_add v16, v17, s[40:43], s80 offen
    s_mov_b64 exec, -1
sg_9:
    s_branch worker_loop
worker_s5:
    s_sub_u32 s5, s5, 56
    s_cmp_ge_u32 s5, 128
    s_cbranch_scc1 worker_s2
    s_sub_u32 s4, s4, 3
    s_cmp_ge_u32 s4, 16
    s_cbranch_scc1 worker_loop
    s_mov_b32 s90, -1
    s_lshr_b32 s10, s5, 4
    s_lshl_b32 s11, s4, 3
    s_add_u32 s10, s10, s11
    s_and_b32 s11, s5, 15
    s_mul_i32 s6, s10, 57344
    s_mul_i32 s7, s3, 14336
    s_add_u32 s6, s6, s7
    s_add_u32 s6, s6, 119537664
    s_mul_i32 s8, s11, 114688
    s_add_u32 s8, s8, s7
    s_add_u32 s8, s8, 23068672
    v_add_u32 v8, 57344, v4
    buffer_load_dwordx4 a[0:3], v4, s[40:43], s8 offen offset:0
    buffer_load_dwordx4 a[4:7], v8, s[40:43], s8 offen offset:0
    buffer_load_dwordx4 a[8:11], v4, s[40:43], s8 offen offset:1024
    buffer_load_dwordx4 a[12:15], v8, s[40:43], s8 offen offset:1024
    buffer_load_dwordx4 a[16:19], v4, s[40:43], s8 offen offset:2048
    buffer_load_dwordx4 a[20:23], v8, s[40:43], s8 offen offset:2048
    buffer_load_dwordx4 a[24:27], v4, s[40:43], s8 offen offset:3072
    buffer_load_dwordx4 a[28:31], v8, s[40:43], s8 offen offset:3072
    s_add_u32 s8, s8, 4096
    buffer_load_dwordx4 a[32:35], v4, s[40:43], s8 offen offset:0
    buffer_load_dwordx4 a[36:39], v8, s[40:43], s8 offen offset:0
    buffer_load_dwordx4 a[40:43], v4, s[40:43], s8 offen offset:1024
    buffer_load_dwordx4 a[44:47], v8, s[40:43], s8 offen offset:1024
    buffer_load_dwordx4 a[48:51], v4, s[40:43], s8 offen offset:2048
    buffer_load_dwordx4 a[52:55], v8, s[40:43], s8 offen offset:2048
    buffer_load_dwordx4 a[56:59], v4, s[40:43], s8 offen offset:3072
    buffer_load_dwordx4 a[60:63], v8, s[40:43], s8 offen offset:3072
    s_add_u32 s8, s8, 4096
    buffer_load_dwordx4 a[64:67], v4, s[40:43], s8 offen offset:0
    buffer_load_dwordx4 a[68:71], v8, s[40:43], s8 offen offset:0
    buffer_load_dwordx4 a[72:75], v4, s[40:43], s8 offen offset:1024
    buffer_load_dwordx4 a[76:79], v8, s[40:43], s8 offen offset:1024
    buffer_load_dwordx4 a[80:83], v4, s[40:43], s8 offen offset:2048
    buffer_load_dwordx4 a[84:87], v8, s[40:43], s8 offen offset:2048
    buffer_load_dwordx4 a[88:91], v4, s[40:43], s8 offen offset:3072
    buffer_load_dwordx4 a[92:95], v8, s[40:43], s8 offen offset:3072
    s_add_u32 s8, s8, 4096
    buffer_load_dwordx4 a[96:99], v4, s[40:43], s8 offen offset:0
    buffer_load_dwordx4 a[100:103], v8, s[40:43], s8 offen offset:0
    buffer_load_dwordx4 a[104:107], v4, s[40:43], s8 offen offset:1024
    buffer_load_dwordx4 a[108:111], v8, s[40:43], s8 offen offset:1024
    s_cmp_eq_u32 s3, 0
    s_cbranch_scc0 wc_10_ok
    s_add_u32 s80, s4, 81
    s_lshl_b32 s80, s80, 6
    s_add_u32 s80, s80, 132120576
    v_mov_b32 v17, 0
    s_mov_b32 s82, 0
wc_10:
    buffer_load_dword v16, v17, s[40:43], s80 offen sc1
    s_add_u32 s82, s82, 1
    s_waitcnt vmcnt(0)
    v_readfirstlane_b32 s81, v16
    s_cmp_ge_u32 s81, 56
    s_cbranch_scc1 wc_10_ok
    s_cmp_gt_u32 s82, 0x400000
    s_cbranch_scc1 rec_end2
    s_sleep 6
    s_branch wc_10
wc_10_ok:
    s_barrier
    buffer_load_dwordx4 v[32:35], v4, s[40:43], s6 offen offset:0 sc1
    buffer_load_dwordx4 v[36:39], v4, s[40:43], s6 offen offset:1024 sc1
    buffer_load_dwordx4 v[40:43], v4, s[40:43], s6 offen offset:2048 sc1
    buffer_load_dwordx4 v[44:47], v4, s[40:43], s6 offen offset:3072 sc1
    s_add_u32 s6, s6, 4096
    buffer_load_dwordx4 v[48:51], v4, s[40:43], s6 offen offset:0 sc1
    buffer_load_dwordx4 v[52:55], v4, s[40:43], s6 offen offset:1024 sc1
    buffer_load_dwordx4 v[56:59], v4, s[40:43], s6 offen offset:2048 sc1
    buffer_load_dwordx4 v[60:63], v4, s[40:43], s6 offen offset:3072 sc1
    s_add_u32 s6, s6, 4096
    buffer_load_dwordx4 v[64:67], v4, s[40:43], s6 offen offset:0 sc1
    buffer_load_dwordx4 v[68:71], v4, s[40:43], s6 offen offset:1024 sc1
    buffer_load_dwordx4 v[72:75], v4, s[40:43], s6 offen offset:2048 sc1
    buffer_load_dwordx4 v[76:79], v4, s[40:43], s6 offen offset:3072 sc1
    s_add_u32 s6, s6, 4096
    buffer_load_dwordx4 v[80:83], v4, s[40:43], s6 offen offset:0 sc1
    buffer_load_dwordx4 v[84:87], v4, s[40:43], s6 offen offset:1024 sc1
    v_lshlrev_b32 v6, 10, v3
    v_lshl_add_u32 v6, v2, 3, v6
    s_lshl_b32 s9, s10, 14
    s_lshl_b32 s12, s11, 6
    s_add_u32 s9, s9, s12
    s_add_u32 s13, s9, 117440512
    buffer_load_dwordx2 v[192:193], v6, s[40:43], s13 offen offset:0 sc1
    buffer_load_dwordx2 v[194:195], v6, s[40:43], s13 offen offset:32 sc1
    s_waitcnt vmcnt(15)
    v_mfma_f32_16x16x32_bf16 v[160:163], a[0:3], v[32:35], 0
    v_mfma_f32_16x16x32_bf16 v[164:167], a[4:7], v[32:35], 0
    s_waitcnt vmcnt(14)
    v_mfma_f32_16x16x32_bf16 v[160:163], a[8:11], v[36:39], v[160:163]
    v_mfma_f32_16x16x32_bf16 v[164:167], a[12:15], v[36:39], v[164:167]
    s_waitcnt vmcnt(13)
    v_mfma_f32_16x16x32_bf16 v[160:163], a[16:19], v[40:43], v[160:163]
    v_mfma_f32_16x16x32_bf16 v[164:167], a[20:23], v[40:43], v[164:167]
    s_waitcnt vmcnt(12)
    v_mfma_f32_16x16x32_bf16 v[160:163], a[24:27], v[44:47], v[160:163]
    v_mfma_f32_16x16x32_bf16 v[164:167], a[28:31], v[44:47], v[164:167]
    s_waitcnt vmcnt(11)
    v_mfma_f32_16x16x32_bf16 v[160:163], a[32:35], v[48:51], v[160:163]
    v_mfma_f32_16x16x32_bf16 v[164:167], a[36:39], v[48:51], v[164:167]
    s_waitcnt vmcnt(10)
    v_mfma_f32_16x16x32_bf16 v[160:163], a[40:43], v[52:55], v[160:163]
    v_mfma_f32_16x16x32_bf16 v[164:167], a[44:47], v[52:55], v[164:167]
    s_waitcnt vmcnt(9)
    v_mfma_f32_16x16x32_bf16 v[160:163], a[48:51], v[56:59], v[160:163]
    v_mfma_f32_16x16x32_bf16 v[164:167], a[52:55], v[56:59], v[164:167]
    s_waitcnt vmcnt(8)
    v_mfma_f32_16x16x32_bf16 v[160:163], a[56:59], v[60:63], v[160:163]
    v_mfma_f32_16x16x32_bf16 v[164:167], a[60:63], v[60:63], v[164:167]
    s_waitcnt vmcnt(7)
    v_mfma_f32_16x16x32_bf16 v[160:163], a[64:67], v[64:67], v[160:163]
    v_mfma_f32_16x16x32_bf16 v[164:167], a[68:71], v[64:67], v[164:167]
    s_waitcnt vmcnt(6)
    v_mfma_f32_16x16x32_bf16 v[160:163], a[72:75], v[68:71], v[160:163]
    v_mfma_f32_16x16x32_bf16 v[164:167], a[76:79], v[68:71], v[164:167]
    s_waitcnt vmcnt(5)
    v_mfma_f32_16x16x32_bf16 v[160:163], a[80:83], v[72:75], v[160:163]
    v_mfma_f32_16x16x32_bf16 v[164:167], a[84:87], v[72:75], v[164:167]
    s_waitcnt vmcnt(4)
    v_mfma_f32_16x16x32_bf16 v[160:163], a[88:91], v[76:79], v[160:163]
    v_mfma_f32_16x16x32_bf16 v[164:167], a[92:95], v[76:79], v[164:167]
    s_waitcnt vmcnt(3)
    v_mfma_f32_16x16x32_bf16 v[160:163], a[96:99], v[80:83], v[160:163]
    v_mfma_f32_16x16x32_bf16 v[164:167], a[100:103], v[80:83], v[164:167]
    s_waitcnt vmcnt(2)
    v_mfma_f32_16x16x32_bf16 v[160:163], a[104:107], v[84:87], v[160:163]
    v_mfma_f32_16x16x32_bf16 v[164:167], a[108:111], v[84:87], v[164:167]
    s_nop 7
    s_cmp_eq_u32 s3, 0
    s_cbranch_scc1 f2_w0
    s_sub_u32 s9, s3, 1
    s_lshl_b32 s9, s9, 11
    v_add_u32 v5, s9, v4
    ds_write_b128 v5, v[160:163] offset:0
    ds_write_b128 v5, v[164:167] offset:1024
    s_waitcnt lgkmcnt(0)
    s_barrier
    s_branch f2_fin
f2_w0:
    s_barrier
    ds_read_b128 v[32:35], v4 offset:0
    ds_read_b128 v[36:39], v4 offset:2048
    ds_read_b128 v[40:43], v4 offset:4096
    ds_read_b128 v[44:47], v4 offset:1024
    ds_read_b128 v[48:51], v4 offset:3072
    ds_read_b128 v[52:55], v4 offset:5120
    s_waitcnt vmcnt(0) lgkmcnt(0)
    v_add_f32 v32, v32, v36
    v_add_f32 v160, v160, v40
    v_add_f32 v160, v160, v32
    v_add_f32 v33, v33, v37
    v_add_f32 v161, v161, v41
    v_add_f32 v161, v161, v33
    v_add_f32 v34, v34, v38
    v_add_f32 v162, v162, v42
    v_add_f32 v162, v162, v34
    v_add_f32 v35, v35, v39
    v_add_f32 v163, v163, v43
    v_add_f32 v163, v163, v35
    v_add_f32 v44, v44, v48
    v_add_f32 v164, v164, v52
    v_add_f32 v164, v164, v44
    v_add_f32 v45, v45, v49
    v_add_f32 v165, v165, v53
    v_add_f32 v165, v165, v45
    v_add_f32 v46, v46, v50
    v_add_f32 v166, v166, v54
    v_add_f32 v166, v166, v46
    v_add_f32 v47, v47, v51
    v_add_f32 v167, v167, v55
    v_add_f32 v167, v167, v47
    s_mov_b32 s13, s9
    v_cvt_pk_bf16_f32 v160, v160, v160
    v_lshlrev_b32 v160, 16, v160
    v_cvt_pk_bf16_f32 v161, v161, v161
    v_lshlrev_b32 v161, 16, v161
    v_cvt_pk_bf16_f32 v162, v162, v162
    v_lshlrev_b32 v162, 16, v162
    v_cvt_pk_bf16_f32 v163, v163, v163
    v_lshlrev_b32 v163, 16, v163
    v_lshlrev_b32 v32, 16, v192
    v_and_b32 v33, 0xffff0000, v192
    v_lshlrev_b32 v34, 16, v193
    v_and_b32 v35, 0xffff0000, v193
    v_add_f32 v160, v160, v32
    v_add_f32 v161, v161, v33
    v_add_f32 v162, v162, v34
    v_add_f32 v163, v163, v35
    v_cvt_pk_bf16_f32 v192, v160, v161
    v_cvt_pk_bf16_f32 v193, v162, v163
    buffer_store_dwordx2 v[192:193], v6, s[52:55], s13 offen offset:0
    v_cvt_pk_bf16_f32 v164, v164, v164
    v_lshlrev_b32 v164, 16, v164
    v_cvt_pk_bf16_f32 v165, v165, v165
    v_lshlrev_b32 v165, 16, v165
    v_cvt_pk_bf16_f32 v166, v166, v166
    v_lshlrev_b32 v166, 16, v166
    v_cvt_pk_bf16_f32 v167, v167, v167
    v_lshlrev_b32 v167, 16, v167
    v_lshlrev_b32 v32, 16, v194
    v_and_b32 v33, 0xffff0000, v194
    v_lshlrev_b32 v34, 16, v195
    v_and_b32 v35, 0xffff0000, v195
    v_add_f32 v164, v164, v32
    v_add_f32 v165, v165, v33
    v_add_f32 v166, v166, v34
    v_add_f32 v167, v167, v35
    v_cvt_pk_bf16_f32 v194, v164, v165
    v_cvt_pk_bf16_f32 v195, v166, v167
    buffer_store_dwordx2 v[194:195], v6, s[52:55], s13 offen offset:32
f2_fin:
    v_add_u32 v5, 0x10000, v4
    s_branch worker_loop
worker_s2:
    s_sub_u32 s5, s5, 128
    s_cmp_ge_u32 s4, 16
    s_cbranch_scc1 worker_loop
    s_cmp_eq_u32 s3, 0
    s_cbranch_scc0 wc_11_ok
    s_add_u32 s80, s4, 17
    s_lshl_b32 s80, s80, 6
    s_add_u32 s80, s80, 132120576
    v_mov_b32 v17, 0
    s_mov_b32 s82, 0
wc_11:
    buffer_load_dword v16, v17, s[40:43], s80 offen sc1
    s_add_u32 s82, s82, 1
    s_waitcnt vmcnt(0)
    v_readfirstlane_b32 s81, v16
    s_cmp_ge_u32 s81, 16
    s_cbranch_scc1 wc_11_ok
    s_cmp_gt_u32 s82, 0x400000
    s_cbranch_scc1 rec_end2
    s_sleep 6
    s_branch wc_11
wc_11_ok:
    s_barrier
    s_cmp_eq_u32 s3, 0
    s_cbranch_scc0 wc_12_ok
    s_add_u32 s80, s4, 1
    s_lshl_b32 s80, s80, 6
    s_add_u32 s80, s80, 132120576
    v_mov_b32 v17, 0
    s_mov_b32 s82, 0
wc_12:
    buffer_load_dword v16, v17, s[40:43], s80 offen sc1
    s_add_u32 s82, s82, 1
    s_waitcnt vmcnt(0)
    v_readfirstlane_b32 s81, v16
    s_cmp_ge_u32 s81, 32
    s_cbranch_scc1 wc_12_ok
    s_cmp_gt_u32 s82, 0x400000
    s_cbranch_scc1 rec_end2
    s_sleep 6
    s_branch wc_12
wc_12_ok:
    s_barrier
    s_lshl_b32 s6, s4, 7
    s_lshl_b32 s7, s5, 2
    s_add_u32 s6, s6, s7
    s_add_u32 s10, s6, s3
    s_lshl_b32 s11, s10, 13
    s_lshl_b32 s12, s10, 12
    s_add_u32 s7, s11, 25165824
    buffer_load_dwordx4 v[32:35], v4, s[40:43], s7 offen offset:0 sc1
    buffer_load_dwordx4 v[36:39], v4, s[40:43], s7 offen offset:1024 sc1
    buffer_load_dwordx4 v[40:43], v4, s[40:43], s7 offen offset:2048 sc1
    buffer_load_dwordx4 v[44:47], v4, s[40:43], s7 offen offset:3072 sc1
    s_add_u32 s7, s11, 25169920
    buffer_load_dwordx4 v[48:51], v4, s[40:43], s7 offen offset:0 sc1
    buffer_load_dwordx4 v[52:55], v4, s[40:43], s7 offen offset:1024 sc1
    buffer_load_dwordx4 v[56:59], v4, s[40:43], s7 offen offset:2048 sc1
    buffer_load_dwordx4 v[60:63], v4, s[40:43], s7 offen offset:3072 sc1
    s_add_u32 s7, s11, 41943040
    buffer_load_dwordx4 v[64:67], v4, s[40:43], s7 offen offset:0 sc1
    buffer_load_dwordx4 v[68:71], v4, s[40:43], s7 offen offset:1024 sc1
    buffer_load_dwordx4 v[72:75], v4, s[40:43], s7 offen offset:2048 sc1
    buffer_load_dwordx4 v[76:79], v4, s[40:43], s7 offen offset:3072 sc1
    s_add_u32 s7, s11, 41947136
    buffer_load_dwordx4 v[80:83], v4, s[40:43], s7 offen offset:0 sc1
    buffer_load_dwordx4 v[84:87], v4, s[40:43], s7 offen offset:1024 sc1
    buffer_load_dwordx4 v[88:91], v4, s[40:43], s7 offen offset:2048 sc1
    buffer_load_dwordx4 v[92:95], v4, s[40:43], s7 offen offset:3072 sc1
    s_add_u32 s7, s11, 58720256
    buffer_load_dwordx4 v[112:115], v4, s[40:43], s7 offen offset:0 sc1
    buffer_load_dwordx4 v[116:119], v4, s[40:43], s7 offen offset:1024 sc1
    buffer_load_dwordx4 v[120:123], v4, s[40:43], s7 offen offset:2048 sc1
    buffer_load_dwordx4 v[124:127], v4, s[40:43], s7 offen offset:3072 sc1
    s_add_u32 s7, s11, 58724352
    buffer_load_dwordx4 v[128:131], v4, s[40:43], s7 offen offset:0 sc1
    buffer_load_dwordx4 v[132:135], v4, s[40:43], s7 offen offset:1024 sc1
    buffer_load_dwordx4 v[136:139], v4, s[40:43], s7 offen offset:2048 sc1
    buffer_load_dwordx4 v[140:143], v4, s[40:43], s7 offen offset:3072 sc1
    s_cmp_eq_u32 s3, 0
    s_cbranch_scc0 wc_13_ok
    s_add_u32 s80, s4, 33
    s_lshl_b32 s80, s80, 6
    s_add_u32 s80, s80, 132120576
    v_mov_b32 v17, 0
    s_mov_b32 s82, 0
wc_13:
    buffer_load_dword v16, v17, s[40:43], s80 offen sc1
    s_add_u32 s82, s82, 1
    s_waitcnt vmcnt(0)
    v_readfirstlane_b32 s81, v16
    s_cmp_ge_u32 s81, 32
    s_cbranch_scc1 wc_13_ok
    s_cmp_gt_u32 s82, 0x400000
    s_cbranch_scc1 rec_end2
    s_sleep 6
    s_branch wc_13
wc_13_ok:
    s_barrier
    s_add_u32 s7, s12, 75497472
    buffer_load_dwordx4 v[96:99], v4, s[40:43], s7 offen offset:0 sc1
    buffer_load_dwordx4 v[100:103], v4, s[40:43], s7 offen offset:1024 sc1
    buffer_load_dwordx4 v[104:107], v4, s[40:43], s7 offen offset:2048 sc1
    buffer_load_dwordx4 v[108:111], v4, s[40:43], s7 offen offset:3072 sc1
    s_add_u32 s7, s11, 83886080
    buffer_load_dwordx4 v[144:147], v4, s[40:43], s7 offen offset:0 sc1
    buffer_load_dwordx4 v[148:151], v4, s[40:43], s7 offen offset:1024 sc1
    buffer_load_dwordx4 v[152:155], v4, s[40:43], s7 offen offset:2048 sc1
    buffer_load_dwordx4 v[156:159], v4, s[40:43], s7 offen offset:3072 sc1
    s_add_u32 s7, s11, 83890176
    buffer_load_dwordx4 v[160:163], v4, s[40:43], s7 offen offset:0 sc1
    buffer_load_dwordx4 v[164:167], v4, s[40:43], s7 offen offset:1024 sc1
    buffer_load_dwordx4 v[168:171], v4, s[40:43], s7 offen offset:2048 sc1
    buffer_load_dwordx4 v[172:175], v4, s[40:43], s7 offen offset:3072 sc1
    s_waitcnt vmcnt(8)
    v_mfma_f32_16x16x32_bf16 v[176:179], v[64:67], v[32:35], 0
    v_mfma_f32_16x16x32_bf16 v[180:183], v[68:71], v[32:35], 0
    v_mfma_f32_16x16x32_bf16 v[184:187], v[96:99], v[32:35], 0
    v_mfma_f32_16x16x32_bf16 v[176:179], v[72:75], v[40:43], v[176:179]
    v_mfma_f32_16x16x32_bf16 v[180:183], v[76:79], v[40:43], v[180:183]
    v_mfma_f32_16x16x32_bf16 v[184:187], v[100:103], v[40:43], v[184:187]
    v_mfma_f32_16x16x32_bf16 v[176:179], v[80:83], v[48:51], v[176:179]
    v_mfma_f32_16x16x32_bf16 v[180:183], v[84:87], v[48:51], v[180:183]
    v_mfma_f32_16x16x32_bf16 v[184:187], v[104:107], v[48:51], v[184:187]
    v_mfma_f32_16x16x32_bf16 v[176:179], v[88:91], v[56:59], v[176:179]
    v_mfma_f32_16x16x32_bf16 v[180:183], v[92:95], v[56:59], v[180:183]
    v_mfma_f32_16x16x32_bf16 v[184:187], v[108:111], v[56:59], v[184:187]
    v_mfma_f32_16x16x32_bf16 v[188:191], v[64:67], v[36:39], 0
    v_mfma_f32_16x16x32_bf16 v[192:195], v[68:71], v[36:39], 0
    v_mfma_f32_16x16x32_bf16 v[196:199], v[96:99], v[36:39], 0
    v_mfma_f32_16x16x32_bf16 v[188:191], v[72:75], v[44:47], v[188:191]
    v_mfma_f32_16x16x32_bf16 v[192:195], v[76:79], v[44:47], v[192:195]
    v_mfma_f32_16x16x32_bf16 v[196:199], v[100:103], v[44:47], v[196:199]
    v_mfma_f32_16x16x32_bf16 v[188:191], v[80:83], v[52:55], v[188:191]
    v_mfma_f32_16x16x32_bf16 v[192:195], v[84:87], v[52:55], v[192:195]
    v_mfma_f32_16x16x32_bf16 v[196:199], v[104:107], v[52:55], v[196:199]
    v_mfma_f32_16x16x32_bf16 v[188:191], v[88:91], v[60:63], v[188:191]
    v_mfma_f32_16x16x32_bf16 v[192:195], v[92:95], v[60:63], v[192:195]
    v_mfma_f32_16x16x32_bf16 v[196:199], v[108:111], v[60:63], v[196:199]
    s_nop 7
    v_mov_b32 v8, 0xce6e6b28
    v_lshlrev_b32 v9, 2, v2
    v_add_u32 v11, 64, v3
    v_cvt_pk_bf16_f32 v176, v176, v176
    v_lshlrev_b32 v176, 16, v176
    v_mul_f32 v176, 0x3db504f3, v176
    v_cvt_pk_bf16_f32 v176, v176, v176
    v_lshlrev_b32 v176, 16, v176
    v_cvt_pk_bf16_f32 v177, v177, v177
    v_lshlrev_b32 v177, 16, v177
    v_mul_f32 v177, 0x3db504f3, v177
    v_cvt_pk_bf16_f32 v177, v177, v177
    v_lshlrev_b32 v177, 16, v177
    v_cvt_pk_bf16_f32 v178, v178, v178
    v_lshlrev_b32 v178, 16, v178
    v_mul_f32 v178, 0x3db504f3, v178
    v_cvt_pk_bf16_f32 v178, v178, v178
    v_lshlrev_b32 v178, 16, v178
    v_cvt_pk_bf16_f32 v179, v179, v179
    v_lshlrev_b32 v179, 16, v179
    v_mul_f32 v179, 0x3db504f3, v179
    v_cvt_pk_bf16_f32 v179, v179, v179
    v_lshlrev_b32 v179, 16, v179
    v_cvt_pk_bf16_f32 v180, v180, v180
    v_lshlrev_b32 v180, 16, v180
    v_mul_f32 v180, 0x3db504f3, v180
    v_cvt_pk_bf16_f32 v180, v180, v180
    v_lshlrev_b32 v180, 16, v180
    v_cvt_pk_bf16_f32 v181, v181, v181
    v_lshlrev_b32 v181, 16, v181
    v_mul_f32 v181, 0x3db504f3, v181
    v_cvt_pk_bf16_f32 v181, v181, v181
    v_lshlrev_b32 v181, 16, v181
    v_cvt_pk_bf16_f32 v182, v182, v182
    v_lshlrev_b32 v182, 16, v182
    v_mul_f32 v182, 0x3db504f3, v182
    v_cvt_pk_bf16_f32 v182, v182, v182
    v_lshlrev_b32 v182, 16, v182
    v_cvt_pk_bf16_f32 v183, v183, v183
    v_lshlrev_b32 v183, 16, v183
    v_mul_f32 v183, 0x3db504f3, v183
    v_cvt_pk_bf16_f32 v183, v183, v183
    v_lshlrev_b32 v183, 16, v183
    v_cvt_pk_bf16_f32 v184, v184, v184
    v_lshlrev_b32 v184, 16, v184
    v_mul_f32 v184, 0x3db504f3, v184
    v_cvt_pk_bf16_f32 v184, v184, v184
    v_lshlrev_b32 v184, 16, v184
    v_cvt_pk_bf16_f32 v185, v185, v185
    v_lshlrev_b32 v185, 16, v185
    v_mul_f32 v185, 0x3db504f3, v185
    v_cvt_pk_bf16_f32 v185, v185, v185
    v_lshlrev_b32 v185, 16, v185
    v_cvt_pk_bf16_f32 v186, v186, v186
    v_lshlrev_b32 v186, 16, v186
    v_mul_f32 v186, 0x3db504f3, v186
    v_cvt_pk_bf16_f32 v186, v186, v186
    v_lshlrev_b32 v186, 16, v186
    v_cvt_pk_bf16_f32 v187, v187, v187
    v_lshlrev_b32 v187, 16, v187
    v_mul_f32 v187, 0x3db504f3, v187
    v_cvt_pk_bf16_f32 v187, v187, v187
    v_lshlrev_b32 v187, 16, v187
    v_add_u32 v10, 64, v9
    v_cmp_le_u32 vcc, v10, v11
    s_nop 1
    v_cndmask_b32 v176, v8, v176, vcc
    v_add_u32 v10, 65, v9
    v_cmp_le_u32 vcc, v10, v11
    s_nop 1
    v_cndmask_b32 v177, v8, v177, vcc
    v_add_u32 v10, 66, v9
    v_cmp_le_u32 vcc, v10, v11
    s_nop 1
    v_cndmask_b32 v178, v8, v178, vcc
    v_add_u32 v10, 67, v9
    v_cmp_le_u32 vcc, v10, v11
    s_nop 1
    v_cndmask_b32 v179, v8, v179, vcc
    v_add_u32 v10, 80, v9
    v_cmp_le_u32 vcc, v10, v11
    s_nop 1
    v_cndmask_b32 v180, v8, v180, vcc
    v_add_u32 v10, 81, v9
    v_cmp_le_u32 vcc, v10, v11
    s_nop 1
    v_cndmask_b32 v181, v8, v181, vcc
    v_add_u32 v10, 82, v9
    v_cmp_le_u32 vcc, v10, v11
    s_nop 1
    v_cndmask_b32 v182, v8, v182, vcc
    v_add_u32 v10, 83, v9
    v_cmp_le_u32 vcc, v10, v11
    s_nop 1
    v_cndmask_b32 v183, v8, v183, vcc
    v_cmp_gt_u32 vcc, 2, v2
    s_nop 1
    v_cndmask_b32 v184, v8, v184, vcc
    v_cndmask_b32 v185, v8, v185, vcc
    v_cndmask_b32 v186, v8, v186, vcc
    v_cndmask_b32 v187, v8, v187, vcc
    v_max3_f32 v12, v176, v177, v178
    v_max3_f32 v12, v12, v179, v180
    v_max3_f32 v12, v12, v181, v182
    v_max3_f32 v12, v12, v183, v184
    v_max3_f32 v12, v12, v185, v186
    v_max_f32 v12, v12, v187
    v_mov_b32 v15, v12
    v_mov_b32 v16, v12
    s_nop 1
    v_permlane32_swap_b32 v15, v16
    s_nop 1
    v_max_f32 v12, v15, v16
    v_mov_b32 v15, v12
    v_mov_b32 v16, v12
    s_nop 1
    v_permlane16_swap_b32 v15, v16
    s_nop 1
    v_max_f32 v12, v15, v16
    v_sub_f32 v176, v176, v12
    v_mul_f32 v176, 0x3fb8aa3b, v176
    v_exp_f32 v176, v176
    v_sub_f32 v177, v177, v12
    v_mul_f32 v177, 0x3fb8aa3b, v177
    v_exp_f32 v177, v177
    v_sub_f32 v178, v178, v12
    v_mul_f32 v178, 0x3fb8aa3b, v178
    v_exp_f32 v178, v178
    v_sub_f32 v179, v179, v12
    v_mul_f32 v179, 0x3fb8aa3b, v179
    v_exp_f32 v179, v179
    v_sub_f32 v180, v180, v12
    v_mul_f32 v180, 0x3fb8aa3b, v180
    v_exp_f32 v180, v180
    v_sub_f32 v181, v181, v12
    v_mul_f32 v181, 0x3fb8aa3b, v181
    v_exp_f32 v181, v181
    v_sub_f32 v182, v182, v12
    v_mul_f32 v182, 0x3fb8aa3b, v182
    v_exp_f32 v182, v182
    v_sub_f32 v183, v183, v12
    v_mul_f32 v183, 0x3fb8aa3b, v183
    v_exp_f32 v183, v183
    v_sub_f32 v184, v184, v12
    v_mul_f32 v184, 0x3fb8aa3b, v184
    v_exp_f32 v184, v184
    v_sub_f32 v185, v185, v12
    v_mul_f32 v185, 0x3fb8aa3b, v185
    v_exp_f32 v185, v185
    v_sub_f32 v186, v186, v12
    v_mul_f32 v186, 0x3fb8aa3b, v186
    v_exp_f32 v186, v186
    v_sub_f32 v187, v187, v12
    v_mul_f32 v187, 0x3fb8aa3b, v187
    v_exp_f32 v187, v187
    s_nop 0
    v_add_f32 v14, v176, v177
    v_add_f32 v14, v14, v178
    v_add_f32 v14, v14, v179
    v_add_f32 v14, v14, v180
    v_add_f32 v14, v14, v181
    v_add_f32 v14, v14, v182
    v_add_f32 v14, v14, v183
    v_add_f32 v14, v14, v184
    v_add_f32 v14, v14, v185
    v_add_f32 v14, v14, v186
    v_add_f32 v14, v14, v187
    v_mov_b32 v15, v14
    v_mov_b32 v16, v14
    s_nop 1
    v_permlane32_swap_b32 v15, v16
    s_nop 1
    v_add_f32 v14, v15, v16
    v_mov_b32 v15, v14
    v_mov_b32 v16, v14
    s_nop 1
    v_permlane16_swap_b32 v15, v16
    s_nop 1
    v_add_f32 v14, v15, v16
    v_rcp_f32 v13, v14
    s_nop 0
    v_fma_f32 v12, -v14, v13, 2.0
    v_mul_f32 v13, v13, v12
    v_mul_f32 v176, v176, v13
    v_mul_f32 v177, v177, v13
    v_mul_f32 v178, v178, v13
    v_mul_f32 v179, v179, v13
    v_mul_f32 v180, v180, v13
    v_mul_f32 v181, v181, v13
    v_mul_f32 v182, v182, v13
    v_mul_f32 v183, v183, v13
    v_mul_f32 v184, v184, v13
    v_mul_f32 v185, v185, v13
    v_mul_f32 v186, v186, v13
    v_mul_f32 v187, v187, v13
    v_cvt_pk_bf16_f32 v200, v176, v177
    v_cvt_pk_bf16_f32 v201, v178, v179
    v_cvt_pk_bf16_f32 v202, v180, v181
    v_cvt_pk_bf16_f32 v203, v182, v183
    v_cvt_pk_bf16_f32 v204, v184, v185
    v_cvt_pk_bf16_f32 v205, v186, v187
    v_mov_b32 v206, 0
    v_mov_b32 v207, 0
    v_cvt_pk_bf16_f32 v188, v188, v188
    v_lshlrev_b32 v188, 16, v188
    v_mul_f32 v188, 0x3db504f3, v188
    v_cvt_pk_bf16_f32 v188, v188, v188
    v_lshlrev_b32 v188, 16, v188
    v_cvt_pk_bf16_f32 v189, v189, v189
    v_lshlrev_b32 v189, 16, v189
    v_mul_f32 v189, 0x3db504f3, v189
    v_cvt_pk_bf16_f32 v189, v189, v189
    v_lshlrev_b32 v189, 16, v189
    v_cvt_pk_bf16_f32 v190, v190, v190
    v_lshlrev_b32 v190, 16, v190
    v_mul_f32 v190, 0x3db504f3, v190
    v_cvt_pk_bf16_f32 v190, v190, v190
    v_lshlrev_b32 v190, 16, v190
    v_cvt_pk_bf16_f32 v191, v191, v191
    v_lshlrev_b32 v191, 16, v191
    v_mul_f32 v191, 0x3db504f3, v191
    v_cvt_pk_bf16_f32 v191, v191, v191
    v_lshlrev_b32 v191, 16, v191
    v_cvt_pk_bf16_f32 v192, v192, v192
    v_lshlrev_b32 v192, 16, v192
    v_mul_f32 v192, 0x3db504f3, v192
    v_cvt_pk_bf16_f32 v192, v192, v192
    v_lshlrev_b32 v192, 16, v192
    v_cvt_pk_bf16_f32 v193, v193, v193
    v_lshlrev_b32 v193, 16, v193
    v_mul_f32 v193, 0x3db504f3, v193
    v_cvt_pk_bf16_f32 v193, v193, v193
    v_lshlrev_b32 v193, 16, v193
    v_cvt_pk_bf16_f32 v194, v194, v194
    v_lshlrev_b32 v194, 16, v194
    v_mul_f32 v194, 0x3db504f3, v194
    v_cvt_pk_bf16_f32 v194, v194, v194
    v_lshlrev_b32 v194, 16, v194
    v_cvt_pk_bf16_f32 v195, v195, v195
    v_lshlrev_b32 v195, 16, v195
    v_mul_f32 v195, 0x3db504f3, v195
    v_cvt_pk_bf16_f32 v195, v195, v195
    v_lshlrev_b32 v195, 16, v195
    v_cvt_pk_bf16_f32 v196, v196, v196
    v_lshlrev_b32 v196, 16, v196
    v_mul_f32 v196, 0x3db504f3, v196
    v_cvt_pk_bf16_f32 v196, v196, v196
    v_lshlrev_b32 v196, 16, v196
    v_cvt_pk_bf16_f32 v197, v197, v197
    v_lshlrev_b32 v197, 16, v197
    v_mul_f32 v197, 0x3db504f3, v197
    v_cvt_pk_bf16_f32 v197, v197, v197
    v_lshlrev_b32 v197, 16, v197
    v_cvt_pk_bf16_f32 v198, v198, v198
    v_lshlrev_b32 v198, 16, v198
    v_mul_f32 v198, 0x3db504f3, v198
    v_cvt_pk_bf16_f32 v198, v198, v198
    v_lshlrev_b32 v198, 16, v198
    v_cvt_pk_bf16_f32 v199, v199, v199
    v_lshlrev_b32 v199, 16, v199
    v_mul_f32 v199, 0x3db504f3, v199
    v_cvt_pk_bf16_f32 v199, v199, v199
    v_lshlrev_b32 v199, 16, v199
    v_add_u32 v10, 49, v9
    v_cmp_le_u32 vcc, v10, v11
    s_nop 1
    v_cndmask_b32 v189, v8, v189, vcc
    v_add_u32 v10, 50, v9
    v_cmp_le_u32 vcc, v10, v11
    s_nop 1
    v_cndmask_b32 v190, v8, v190, vcc
    v_add_u32 v10, 51, v9
    v_cmp_le_u32 vcc, v10, v11
    s_nop 1
    v_cndmask_b32 v191, v8, v191, vcc
    v_add_u32 v10, 64, v9
    v_cmp_le_u32 vcc, v10, v11
    s_nop 1
    v_cndmask_b32 v192, v8, v192, vcc
    v_add_u32 v10, 65, v9
    v_cmp_le_u32 vcc, v10, v11
    s_nop 1
    v_cndmask_b32 v193, v8, v193, vcc
    v_add_u32 v10, 66, v9
    v_cmp_le_u32 vcc, v10, v11
    s_nop 1
    v_cndmask_b32 v194, v8, v194, vcc
    v_add_u32 v10, 67, v9
    v_cmp_le_u32 vcc, v10, v11
    s_nop 1
    v_cndmask_b32 v195, v8, v195, vcc
    v_cmp_gt_u32 vcc, 2, v2
    s_nop 1
    v_cndmask_b32 v196, v8, v196, vcc
    v_cndmask_b32 v197, v8, v197, vcc
    v_cndmask_b32 v198, v8, v198, vcc
    v_cndmask_b32 v199, v8, v199, vcc
    v_max3_f32 v12, v188, v189, v190
    v_max3_f32 v12, v12, v191, v192
    v_max3_f32 v12, v12, v193, v194
    v_max3_f32 v12, v12, v195, v196
    v_max3_f32 v12, v12, v197, v198
    v_max_f32 v12, v12, v199
    v_mov_b32 v15, v12
    v_mov_b32 v16, v12
    s_nop 1
    v_permlane32_swap_b32 v15, v16
    s_nop 1
    v_max_f32 v12, v15, v16
    v_mov_b32 v15, v12
    v_mov_b32 v16, v12
    s_nop 1
    v_permlane16_swap_b32 v15, v16
    s_nop 1
    v_max_f32 v12, v15, v16
    v_sub_f32 v188, v188, v12
    v_mul_f32 v188, 0x3fb8aa3b, v188
    v_exp_f32 v188, v188
    v_sub_f32 v189, v189, v12
    v_mul_f32 v189, 0x3fb8aa3b, v189
    v_exp_f32 v189, v189
    v_sub_f32 v190, v190, v12
    v_mul_f32 v190, 0x3fb8aa3b, v190
    v_exp_f32 v190, v190
    v_sub_f32 v191, v191, v12
    v_mul_f32 v191, 0x3fb8aa3b, v191
    v_exp_f32 v191, v191
    v_sub_f32 v192, v192, v12
    v_mul_f32 v192, 0x3fb8aa3b, v192
    v_exp_f32 v192, v192
    v_sub_f32 v193, v193, v12
    v_mul_f32 v193, 0x3fb8aa3b, v193
    v_exp_f32 v193, v193
    v_sub_f32 v194, v194, v12
    v_mul_f32 v194, 0x3fb8aa3b, v194
    v_exp_f32 v194, v194
    v_sub_f32 v195, v195, v12
    v_mul_f32 v195, 0x3fb8aa3b, v195
    v_exp_f32 v195, v195
    v_sub_f32 v196, v196, v12
    v_mul_f32 v196, 0x3fb8aa3b, v196
    v_exp_f32 v196, v196
    v_sub_f32 v197, v197, v12
    v_mul_f32 v197, 0x3fb8aa3b, v197
    v_exp_f32 v197, v197
    v_sub_f32 v198, v198, v12
    v_mul_f32 v198, 0x3fb8aa3b, v198
    v_exp_f32 v198, v198
    v_sub_f32 v199, v199, v12
    v_mul_f32 v199, 0x3fb8aa3b, v199
    v_exp_f32 v199, v199
    s_nop 0
    v_add_f32 v14, v188, v189
    v_add_f32 v14, v14, v190
    v_add_f32 v14, v14, v191
    v_add_f32 v14, v14, v192
    v_add_f32 v14, v14, v193
    v_add_f32 v14, v14, v194
    v_add_f32 v14, v14, v195
    v_add_f32 v14, v14, v196
    v_add_f32 v14, v14, v197
    v_add_f32 v14, v14, v198
    v_add_f32 v14, v14, v199
    v_mov_b32 v15, v14
    v_mov_b32 v16, v14
    s_nop 1
    v_permlane32_swap_b32 v15, v16
    s_nop 1
    v_add_f32 v14, v15, v16
    v_mov_b32 v15, v14
    v_mov_b32 v16, v14
    s_nop 1
    v_permlane16_swap_b32 v15, v16
    s_nop 1
    v_add_f32 v14, v15, v16
    v_rcp_f32 v13, v14
    s_nop 0
    v_fma_f32 v12, -v14, v13, 2.0
    v_mul_f32 v13, v13, v12
    v_mul_f32 v188, v188, v13
    v_mul_f32 v189, v189, v13
    v_mul_f32 v190, v190, v13
    v_mul_f32 v191, v191, v13
    v_mul_f32 v192, v192, v13
    v_mul_f32 v193, v193, v13
    v_mul_f32 v194, v194, v13
    v_mul_f32 v195, v195, v13
    v_mul_f32 v196, v196, v13
    v_mul_f32 v197, v197, v13
    v_mul_f32 v198, v198, v13
    v_mul_f32 v199, v199, v13
    v_cvt_pk_bf16_f32 v208, v188, v189
    v_cvt_pk_bf16_f32 v209, v190, v191
    v_cvt_pk_bf16_f32 v210, v192, v193
    v_cvt_pk_bf16_f32 v211, v194, v195
    v_cvt_pk_bf16_f32 v212, v196, v197
    v_cvt_pk_bf16_f32 v213, v198, v199
    v_mov_b32 v214, 0
    v_mov_b32 v215, 0
    s_waitcnt vmcnt(0)
    s_nop 1
    v_mfma_f32_16x16x32_bf16 v[32:35], v[112:115], v[200:203], 0
    v_mfma_f32_16x16x32_bf16 v[32:35], v[144:147], v[204:207], v[32:35]
    v_mfma_f32_16x16x32_bf16 v[36:39], v[112:115], v[208:211], 0
    v_mfma_f32_16x16x32_bf16 v[36:39], v[144:147], v[212:215], v[36:39]
    v_mfma_f32_16x16x32_bf16 v[40:43], v[116:119], v[200:203], 0
    v_mfma_f32_16x16x32_bf16 v[40:43], v[148:151], v[204:207], v[40:43]
    v_mfma_f32_16x16x32_bf16 v[44:47], v[116:119], v[208:211], 0
    v_mfma_f32_16x16x32_bf16 v[44:47], v[148:151], v[212:215], v[44:47]
    v_mfma_f32_16x16x32_bf16 v[48:51], v[120:123], v[200:203], 0
    v_mfma_f32_16x16x32_bf16 v[48:51], v[152:155], v[204:207], v[48:51]
    v_mfma_f32_16x16x32_bf16 v[52:55], v[120:123], v[208:211], 0
    v_mfma_f32_16x16x32_bf16 v[52:55], v[152:155], v[212:215], v[52:55]
    v_mfma_f32_16x16x32_bf16 v[56:59], v[124:127], v[200:203], 0
    v_mfma_f32_16x16x32_bf16 v[56:59], v[156:159], v[204:207], v[56:59]
    v_mfma_f32_16x16x32_bf16 v[60:63], v[124:127], v[208:211], 0
    v_mfma_f32_16x16x32_bf16 v[60:63], v[156:159], v[212:215], v[60:63]
    v_mfma_f32_16x16x32_bf16 v[64:67], v[128:131], v[200:203], 0
    v_mfma_f32_16x16x32_bf16 v[64:67], v[160:163], v[204:207], v[64:67]
    v_mfma_f32_16x16x32_bf16 v[68:71], v[128:131], v[208:211], 0
    v_mfma_f32_16x16x32_bf16 v[68:71], v[160:163], v[212:215], v[68:71]
    v_mfma_f32_16x16x32_bf16 v[72:75], v[132:135], v[200:203], 0
    v_mfma_f32_16x16x32_bf16 v[72:75], v[164:167], v[204:207], v[72:75]
    v_mfma_f32_16x16x32_bf16 v[76:79], v[132:135], v[208:211], 0
    v_mfma_f32_16x16x32_bf16 v[76:79], v[164:167], v[212:215], v[76:79]
    v_mfma_f32_16x16x32_bf16 v[80:83], v[136:139], v[200:203], 0
    v_mfma_f32_16x16x32_bf16 v[80:83], v[168:171], v[204:207], v[80:83]
    v_mfma_f32_16x16x32_bf16 v[84:87], v[136:139], v[208:211], 0
    v_mfma_f32_16x16x32_bf16 v[84:87], v[168:171], v[212:215], v[84:87]
    v_mfma_f32_16x16x32_bf16 v[88:91], v[140:143], v[200:203], 0
    v_mfma_f32_16x16x32_bf16 v[88:91], v[172:175], v[204:207], v[88:91]
    v_mfma_f32_16x16x32_bf16 v[92:95], v[140:143], v[208:211], 0
    v_mfma_f32_16x16x32_bf16 v[92:95], v[172:175], v[212:215], v[92:95]
    s_nop 7
    s_lshr_b32 s7, s10, 5
    s_and_b32 s8, s10, 31
    s_lshl_b32 s7, s7, 18
    s_lshl_b32 s8, s8, 12
    s_add_u32 s7, s7, s8
    s_add_u32 s7, s7, 100663296
    s_add_u32 s8, s7, 131072
    v_cvt_pk_bf16_f32 v216, v32, v33
    v_cvt_pk_bf16_f32 v217, v34, v35
    v_cvt_pk_bf16_f32 v218, v40, v41
    v_cvt_pk_bf16_f32 v219, v42, v43
    buffer_store_dwordx4 v[216:219], v4, s[40:43], s7 offen offset:0 sc0 sc1
    v_cvt_pk_bf16_f32 v220, v36, v37
    v_cvt_pk_bf16_f32 v221, v38, v39
    v_cvt_pk_bf16_f32 v222, v44, v45
    v_cvt_pk_bf16_f32 v223, v46, v47
    buffer_store_dwordx4 v[220:223], v4, s[40:43], s8 offen offset:0 sc0 sc1
    v_cvt_pk_bf16_f32 v224, v48, v49
    v_cvt_pk_bf16_f32 v225, v50, v51
    v_cvt_pk_bf16_f32 v226, v56, v57
    v_cvt_pk_bf16_f32 v227, v58, v59
    buffer_store_dwordx4 v[224:227], v4, s[40:43], s7 offen offset:1024 sc0 sc1
    v_cvt_pk_bf16_f32 v228, v52, v53
    v_cvt_pk_bf16_f32 v229, v54, v55
    v_cvt_pk_bf16_f32 v230, v60, v61
    v_cvt_pk_bf16_f32 v231, v62, v63
    buffer_store_dwordx4 v[228:231], v4, s[40:43], s8 offen offset:1024 sc0 sc1
    v_cvt_pk_bf16_f32 v216, v64, v65
    v_cvt_pk_bf16_f32 v217, v66, v67
    v_cvt_pk_bf16_f32 v218, v72, v73
    v_cvt_pk_bf16_f32 v219, v74, v75
    buffer_store_dwordx4 v[216:219], v4, s[40:43], s7 offen offset:2048 sc0 sc1
    v_cvt_pk_bf16_f32 v220, v68, v69
    v_cvt_pk_bf16_f32 v221, v70, v71
    v_cvt_pk_bf16_f32 v222, v76, v77
    v_cvt_pk_bf16_f32 v223, v78, v79
    buffer_store_dwordx4 v[220:223], v4, s[40:43], s8 offen offset:2048 sc0 sc1
    v_cvt_pk_bf16_f32 v224, v80, v81
    v_cvt_pk_bf16_f32 v225, v82, v83
    v_cvt_pk_bf16_f32 v226, v88, v89
    v_cvt_pk_bf16_f32 v227, v90, v91
    buffer_store_dwordx4 v[224:227], v4, s[40:43], s7 offen offset:3072 sc0 sc1
    v_cvt_pk_bf16_f32 v228, v84, v85
    v_cvt_pk_bf16_f32 v229, v86, v87
    v_cvt_pk_bf16_f32 v230, v92, v93
    v_cvt_pk_bf16_f32 v231, v94, v95
    buffer_store_dwordx4 v[228:231], v4, s[40:43], s8 offen offset:3072 sc0 sc1
    s_waitcnt vmcnt(0)
    s_barrier
    s_cmp_eq_u32 s3, 0
    s_cbranch_scc0 sg_14
    s_add_u32 s80, s4, 49
    s_lshl_b32 s80, s80, 6
    s_add_u32 s80, s80, 132120576
    v_mov_b32 v16, 1
    v_mov_b32 v17, 0
    s_mov_b64 exec, 1
    buffer_atomic_add v16, v17, s[40:43], s80 offen
    s_mov_b64 exec, -1
sg_14:
    s_branch worker_loop
worker_fin:
    s_endpgm
.section .rodata,"a"
.p2align 6
.amdhsa_kernel prep_kernel
  .amdhsa_next_free_vgpr 224
  .amdhsa_next_free_sgpr 102
  .amdhsa_accum_offset 224
  .amdhsa_group_segment_fixed_size 0
  .amdhsa_kernarg_size 112
  .amdhsa_user_sgpr_count 2
  .amdhsa_user_sgpr_kernarg_segment_ptr 1
  .amdhsa_system_sgpr_workgroup_id_x 1
.end_amdhsa_kernel
.p2align 6
.amdhsa_kernel rec_kernel
  .amdhsa_next_free_vgpr 512
  .amdhsa_next_free_sgpr 102
  .amdhsa_accum_offset 256
  .amdhsa_group_segment_fixed_size 0
  .amdhsa_kernarg_size 112
  .amdhsa_user_sgpr_count 2
  .amdhsa_user_sgpr_kernarg_segment_ptr 1
  .amdhsa_system_sgpr_workgroup_id_x 1
.end_amdhsa_kernel
```
